```python
import torch

def _softmax(x, axis=-1):
    return torch.softmax(x, dim=axis)
def _gelu(x):
    return torch.nn.functional.gelu(x, approximate="tanh")
def _silu(x):
    return torch.nn.functional.silu(x)
def _sigmoid(x):
    return torch.sigmoid(x)
def _layernorm(x, axis=-1, eps=1e-5):
    m = x.mean(dim=axis, keepdim=True)
    v = x.var(dim=axis, keepdim=True, unbiased=False)
    return (x - m) / torch.sqrt(v + eps)
def _scatter_add(tgt, idx, src, axis=0):
    return tgt.clone().index_add_(axis, idx, src)
def _segment_sum(src, seg, n):
    out = torch.zeros((n,) + src.shape[1:], dtype=src.dtype)
    return out.index_add_(0, seg, src)
def _pad(x, pw):
    flat = tuple(v for pair in reversed(pw) for v in pair)
    return torch.nn.functional.pad(x, flat)

kernel_name = 'concat_heads__sliding_block__sliding_block__prompt'

def setup_inputs():

    _w = (lambda a: (lambda t: t.to(torch.bfloat16) if t.is_floating_point() else t)(torch.as_tensor(a)))
    def _A_setup():
        B, S, D = 1, 2048, 1024
        return {
            "x": _w((lambda *s: torch.randn(*s, dtype=torch.bfloat16) * 0.2)(B, S, D)),
            "wqkv": _w((lambda *s: torch.randn(*s, dtype=torch.bfloat16) * 0.2)(D, 3 * D)),
            "wo": _w((lambda *s: torch.randn(*s, dtype=torch.bfloat16) * 0.05)(D, D)),
        }
    _A_in = _A_setup()

    def _B_setup():
        B, S, D = 1, 2048, 1024
        return {
            "x": _w((lambda *s: torch.randn(*s, dtype=torch.bfloat16) * 0.2)(B, S, D)),
            "wqkv": _w((lambda *s: torch.randn(*s, dtype=torch.bfloat16) * 0.2)(D, 3 * D)),
            "wo": _w((lambda *s: torch.randn(*s, dtype=torch.bfloat16) * 0.05)(D, D)),
        }
    _B_in = _B_setup()

    return {
        "A_x": _A_in["x"],
        "A_wqkv": _A_in["wqkv"],
        "A_wo": _A_in["wo"],
        "B_x": _B_in["x"],
        "B_wqkv": _B_in["wqkv"],
        "B_wo": _B_in["wo"],
    }

def reference(A_x, A_wqkv, A_wo, B_x, B_wqkv, B_wo):
    def _A_ref(x, wqkv, wo):
        B, S, D = x.shape
        H = 32; Dh = D // H; W = 256
        qkv = (lambda x, *d: x.permute(*d))((x @ wqkv).reshape(B, S, 3, H, Dh), 2, 0, 3, 1, 4)
        q, k, v = qkv[0], qkv[1], qkv[2]
        scores = torch.einsum("bhqd,bhkd->bhqk", q, k) * (Dh ** -0.5)
        idx = torch.arange(S)
        mask = (idx[:, None] - idx[None, :] >= 0) & (idx[:, None] - idx[None, :] < W)
        scores = torch.where(mask[None, None], scores, -1e9)
        p = _softmax(scores, axis=-1)
        o = torch.einsum("bhqk,bhkd->bhqd", p, v)
        return (lambda x, *d: x.permute(*d))(o, 0, 2, 1, 3).reshape(B, S, D) @ wo

    def _B_ref(x, wqkv, wo):
        B, S, D = x.shape
        H = 32; Dh = D // H; W = 256
        qkv = (lambda x, *d: x.permute(*d))((x @ wqkv).reshape(B, S, 3, H, Dh), 2, 0, 3, 1, 4)
        q, k, v = qkv[0], qkv[1], qkv[2]
        scores = torch.einsum("bhqd,bhkd->bhqk", q, k) * (Dh ** -0.5)
        idx = torch.arange(S)
        mask = (idx[:, None] - idx[None, :] >= 0) & (idx[:, None] - idx[None, :] < W)
        scores = torch.where(mask[None, None], scores, -1e9)
        p = _softmax(scores, axis=-1)
        o = torch.einsum("bhqk,bhkd->bhqd", p, v)
        return (lambda x, *d: x.permute(*d))(o, 0, 2, 1, 3).reshape(B, S, D) @ wo

    a = _A_ref(A_x, A_wqkv, A_wo)
    b = _B_ref(B_x, B_wqkv, B_wo)
    return torch.concatenate([a, b], axis=-1)
```

```asm
; @launch grid=(256,1,1) block=(512,1,1) lds=163840
.amdgcn_target "amdgcn-amd-amdhsa--gfx950"
.text
.globl concat_heads__sliding_block__sliding_block__prompt_kernel
.p2align 8
.type concat_heads__sliding_block__sliding_block__prompt_kernel,@function
concat_heads__sliding_block__sliding_block__prompt_kernel:
    s_cmp_ge_u32 s2, 256
    s_cbranch_scc1 L_end
    s_load_dwordx16 s[16:31], s[0:1], 0
    s_load_dwordx2 s[32:33], s[0:1], 64
    v_lshrrev_b32 v1, 6, v0
    v_and_b32 v0, 63, v0
    s_and_b32 s64, s2, 7
    v_readfirstlane_b32 s63, v1
    s_lshr_b32 s65, s2, 3
    s_lshr_b32 s60, s64, 2
    s_and_b32 s66, s64, 3
    s_lshr_b32 s61, s65, 2
    s_and_b32 s67, s65, 3
    s_lshl_b32 s62, s66, 2
    s_add_u32 s62, s62, s67
    s_lshr_b32 s79, s65, 4
    s_lshl_b32 s67, s66, 1
    s_add_u32 s79, s79, s67
    s_and_b32 s80, s65, 15
    s_and_b32 s74, s63, 1
    s_waitcnt lgkmcnt(0)
    s_cmp_eq_u32 s60, 0
    s_cselect_b32 s36, s16, s22
    s_cselect_b32 s37, s17, s23
    s_cselect_b32 s40, s18, s24
    s_cselect_b32 s41, s19, s25
    s_cselect_b32 s48, s20, s26
    s_cselect_b32 s49, s21, s27
    s_lshl_b32 s64, s61, 19
    s_add_u32 s36, s36, s64
    s_addc_u32 s37, s37, 0
    s_mov_b32 s38, 0x80000
    s_mov_b32 s39, 0x20000
    s_mov_b32 s42, 0x600000
    s_mov_b32 s43, 0x20000
    s_cmp_lt_u32 s63, 4
    s_cbranch_scc1 L_compute
L_loader:
    s_sub_u32 s67, s63, 4
    v_lshrrev_b32 v10, 3, v0
    v_and_b32 v11, 7, v0
    v_lshrrev_b32 v12, 1, v10
    v_xor_b32 v13, v11, v12
    v_xor_b32 v14, 4, v13
    s_lshl_b32 s64, s67, 16
    v_lshlrev_b32 v15, 11, v10
    v_add_u32 v15, s64, v15
    v_lshl_add_u32 v2, v13, 4, v15
    v_lshl_add_u32 v3, v14, 4, v15
    v_add_u32 v3, 15360, v3
    v_add_u32 v4, 30720, v2
    v_add_u32 v5, 30720, v3
    s_lshl_b32 s82, s67, 12
    s_mov_b32 s70, 0
    s_add_u32 m0, s82, 0
    s_nop 0
    buffer_load_dwordx4 v2, s[36:39], s70 offen offset:0 lds
    buffer_load_dwordx4 v3, s[36:39], s70 offen offset:1024 lds
    buffer_load_dwordx4 v4, s[36:39], s70 offen offset:2048 lds
    buffer_load_dwordx4 v5, s[36:39], s70 offen offset:3072 lds
    v_and_b32 v12, 1, v12
    s_and_b32 s64, s67, 1
    s_lshl_b32 s64, s64, 1
    v_or_b32 v12, s64, v12
    v_lshlrev_b32 v12, 1, v12
    v_xor_b32 v13, v11, v12
    s_mul_i32 s64, s67, 49152
    s_lshl_b32 s65, s62, 7
    s_add_u32 s64, s64, s65
    v_mul_u32_u24 v15, 6144, v10
    v_add_u32 v15, s64, v15
    v_lshl_add_u32 v6, v13, 4, v15
    v_add_u32 v7, 1024, v6
    v_add_u32 v8, 2048, v6
    s_mul_i32 s83, s67, 3072
    s_lshl_b32 s68, s67, 11
    s_lshl_b32 s69, s67, 10
    s_mov_b32 s70, 262144
    s_add_u32 m0, s82, 16384
    s_nop 0
    buffer_load_dwordx4 v2, s[36:39], s70 offen offset:0 lds
    buffer_load_dwordx4 v3, s[36:39], s70 offen offset:1024 lds
    buffer_load_dwordx4 v4, s[36:39], s70 offen offset:2048 lds
    buffer_load_dwordx4 v5, s[36:39], s70 offen offset:3072 lds
    s_mov_b32 s71, 0
    s_add_u32 m0, s83, 98304
    s_nop 0
    buffer_load_dwordx4 v6, s[40:43], s71 offen offset:0 lds
    buffer_load_dwordx4 v7, s[40:43], s71 offen offset:1024 lds
    buffer_load_dwordx4 v8, s[40:43], s71 offen offset:2048 lds
    s_mov_b32 s71, 196608
    s_add_u32 m0, s83, 110592
    s_nop 0
    buffer_load_dwordx4 v6, s[40:43], s71 offen offset:0 lds
    buffer_load_dwordx4 v7, s[40:43], s71 offen offset:1024 lds
    buffer_load_dwordx4 v8, s[40:43], s71 offen offset:2048 lds
    s_mov_b32 s70, 128
    s_add_u32 m0, s82, 32768
    s_nop 0
    buffer_load_dwordx4 v2, s[36:39], s70 offen offset:0 lds
    buffer_load_dwordx4 v3, s[36:39], s70 offen offset:1024 lds
    buffer_load_dwordx4 v4, s[36:39], s70 offen offset:2048 lds
    buffer_load_dwordx4 v5, s[36:39], s70 offen offset:3072 lds
    s_add_u32 s64, s32, 25165824
    s_addc_u32 s65, s33, 0
    s_load_dword s77, s[64:65], 0
    s_mov_b32 s44, s32
    s_mov_b32 s45, s33
    s_mov_b32 s46, 27262976
    s_mov_b32 s47, 0x20000
    s_mov_b32 s50, 0x200000
    s_mov_b32 s51, 0x20000
    s_mov_b32 s52, s28
    s_mov_b32 s53, s29
    s_mov_b32 s54, 0x800000
    s_mov_b32 s55, 0x20000
    s_mov_b32 s56, s30
    s_mov_b32 s57, s31
    s_mov_b32 s58, 256
    s_mov_b32 s59, 0x20000
    s_lshl_b32 s67, s62, 1
    s_add_u32 s67, s67, s74
    s_lshl_b32 s66, s60, 5
    s_add_u32 s66, s66, s67
    s_lshl_b32 s66, s66, 6
    s_lshl_b32 s78, s61, 3
    s_add_u32 s66, s66, s78
    s_lshl_b32 s78, s66, 12
    s_lshl_b32 s66, s60, 3
    s_add_u32 s66, s66, s61
    s_lshl_b32 s89, s66, 19
    s_lshl_b32 s96, s67, 10
    s_add_u32 s89, s89, s96
    s_add_u32 s89, s89, 16777216
    s_lshl_b32 s96, s66, 11
    s_lshl_b32 s67, s67, 3
    s_add_u32 s96, s96, s67
    s_add_u32 s96, s96, 25231360
    s_mov_b32 s34, 562036736
    s_mov_b32 s35, 1568669696
    s_waitcnt lgkmcnt(0)
    s_add_u32 s77, s77, 1
    s_xor_b32 s81, s77, 1540483477
    s_lshr_b32 s64, s2, 3
    s_lshl_b32 s64, s64, 2
    s_add_u32 s64, s64, s63
    s_sub_u32 s64, s64, 4
    s_mul_i32 s65, s64, 6144
    s_or_b32 s66, s62, 3
    s_lshl_b32 s66, s66, 7
    s_add_u32 s65, s65, s66
    s_add_u32 s16, s40, s65
    s_addc_u32 s17, s41, 0
    s_lshl_b32 s65, s64, 15
    s_lshl_b32 s66, s61, 19
    s_sub_u32 s18, s36, s66
    s_subb_u32 s19, s37, 0
    s_add_u32 s18, s18, s65
    s_addc_u32 s19, s19, 0
    s_lshl_b32 s65, s64, 14
    s_add_u32 s20, s48, s65
    s_addc_u32 s21, s49, 0
    s_mul_i32 s65, s64, 0
    s_add_u32 s65, s65, 1572864
    s_add_u32 s24, s48, s65
    s_addc_u32 s25, s49, 0
    s_waitcnt vmcnt(7)
    s_barrier
    s_mov_b32 s70, 262272
    s_add_u32 m0, s82, 49152
    s_nop 0
    buffer_load_dwordx4 v2, s[36:39], s70 offen offset:0 lds
    buffer_load_dwordx4 v3, s[36:39], s70 offen offset:1024 lds
    buffer_load_dwordx4 v4, s[36:39], s70 offen offset:2048 lds
    buffer_load_dwordx4 v5, s[36:39], s70 offen offset:3072 lds
    s_mov_b32 s71, 393216
    s_add_u32 m0, s83, 122880
    s_nop 0
    buffer_load_dwordx4 v6, s[40:43], s71 offen offset:0 lds
    buffer_load_dwordx4 v7, s[40:43], s71 offen offset:1024 lds
    buffer_load_dwordx4 v8, s[40:43], s71 offen offset:2048 lds
    s_mov_b32 s71, 589824
    s_add_u32 m0, s83, 135168
    s_nop 0
    buffer_load_dwordx4 v6, s[40:43], s71 offen offset:0 lds
    buffer_load_dwordx4 v7, s[40:43], s71 offen offset:1024 lds
    buffer_load_dwordx4 v8, s[40:43], s71 offen offset:2048 lds
    s_load_dword s22, s[16:17], 0
    s_load_dword s22, s[16:17], 64
    s_load_dword s22, s[16:17], 2048
    s_load_dword s22, s[16:17], 2112
    s_load_dword s22, s[16:17], 4096
    s_load_dword s22, s[16:17], 4160
    s_add_u32 s16, s16, 786432
    s_addc_u32 s17, s17, 0
    s_load_dword s22, s[18:19], 384
    s_load_dword s22, s[18:19], 448
    s_load_dword s22, s[18:19], 2432
    s_load_dword s22, s[18:19], 2496
    s_load_dword s22, s[18:19], 4480
    s_load_dword s22, s[18:19], 4544
    s_load_dword s22, s[18:19], 6528
    s_load_dword s22, s[18:19], 6592
    s_load_dword s22, s[18:19], 8576
    s_load_dword s22, s[18:19], 8640
    s_load_dword s22, s[18:19], 10624
    s_load_dword s22, s[18:19], 10688
    s_load_dword s22, s[18:19], 12672
    s_load_dword s22, s[18:19], 12736
    s_load_dword s22, s[18:19], 14720
    s_load_dword s22, s[18:19], 14784
    s_waitcnt vmcnt(14)
    s_barrier
    s_mov_b32 s70, 256
    s_add_u32 m0, s82, 65536
    s_nop 0
    buffer_load_dwordx4 v2, s[36:39], s70 offen offset:0 lds
    buffer_load_dwordx4 v3, s[36:39], s70 offen offset:1024 lds
    buffer_load_dwordx4 v4, s[36:39], s70 offen offset:2048 lds
    buffer_load_dwordx4 v5, s[36:39], s70 offen offset:3072 lds
    s_mov_b32 s70, 262400
    s_add_u32 m0, s82, 81920
    s_nop 0
    buffer_load_dwordx4 v2, s[36:39], s70 offen offset:0 lds
    buffer_load_dwordx4 v3, s[36:39], s70 offen offset:1024 lds
    buffer_load_dwordx4 v4, s[36:39], s70 offen offset:2048 lds
    buffer_load_dwordx4 v5, s[36:39], s70 offen offset:3072 lds
    s_load_dword s22, s[16:17], 0
    s_load_dword s22, s[16:17], 64
    s_load_dword s22, s[16:17], 2048
    s_load_dword s22, s[16:17], 2112
    s_load_dword s22, s[16:17], 4096
    s_load_dword s22, s[16:17], 4160
    s_add_u32 s16, s16, 786432
    s_addc_u32 s17, s17, 0
    s_load_dword s22, s[18:19], 16768
    s_load_dword s22, s[18:19], 16832
    s_load_dword s22, s[18:19], 18816
    s_load_dword s22, s[18:19], 18880
    s_load_dword s22, s[18:19], 20864
    s_load_dword s22, s[18:19], 20928
    s_load_dword s22, s[18:19], 22912
    s_load_dword s22, s[18:19], 22976
    s_load_dword s22, s[18:19], 24960
    s_load_dword s22, s[18:19], 25024
    s_load_dword s22, s[18:19], 27008
    s_load_dword s22, s[18:19], 27072
    s_load_dword s22, s[18:19], 29056
    s_load_dword s22, s[18:19], 29120
    s_load_dword s22, s[18:19], 31104
    s_load_dword s22, s[18:19], 31168
    s_waitcnt vmcnt(11)
    s_barrier
    s_mov_b32 s71, 786432
    s_add_u32 m0, s83, 147456
    s_nop 0
    buffer_load_dwordx4 v6, s[40:43], s71 offen offset:0 lds
    buffer_load_dwordx4 v7, s[40:43], s71 offen offset:1024 lds
    buffer_load_dwordx4 v8, s[40:43], s71 offen offset:2048 lds
    s_mov_b32 s71, 983040
    s_add_u32 m0, s83, 98304
    s_nop 0
    buffer_load_dwordx4 v6, s[40:43], s71 offen offset:0 lds
    buffer_load_dwordx4 v7, s[40:43], s71 offen offset:1024 lds
    buffer_load_dwordx4 v8, s[40:43], s71 offen offset:2048 lds
    s_mov_b32 s70, 384
    s_add_u32 m0, s82, 0
    s_nop 0
    buffer_load_dwordx4 v2, s[36:39], s70 offen offset:0 lds
    buffer_load_dwordx4 v3, s[36:39], s70 offen offset:1024 lds
    buffer_load_dwordx4 v4, s[36:39], s70 offen offset:2048 lds
    buffer_load_dwordx4 v5, s[36:39], s70 offen offset:3072 lds
    s_load_dword s22, s[16:17], 0
    s_load_dword s22, s[16:17], 64
    s_load_dword s22, s[16:17], 2048
    s_load_dword s22, s[16:17], 2112
    s_load_dword s22, s[16:17], 4096
    s_load_dword s22, s[16:17], 4160
    s_add_u32 s16, s16, 786432
    s_addc_u32 s17, s17, 0
    s_waitcnt vmcnt(18)
    s_barrier
    s_mov_b32 s70, 262528
    s_add_u32 m0, s82, 16384
    s_nop 0
    buffer_load_dwordx4 v2, s[36:39], s70 offen offset:0 lds
    buffer_load_dwordx4 v3, s[36:39], s70 offen offset:1024 lds
    buffer_load_dwordx4 v4, s[36:39], s70 offen offset:2048 lds
    buffer_load_dwordx4 v5, s[36:39], s70 offen offset:3072 lds
    s_mov_b32 s71, 1179648
    s_add_u32 m0, s83, 110592
    s_nop 0
    buffer_load_dwordx4 v6, s[40:43], s71 offen offset:0 lds
    buffer_load_dwordx4 v7, s[40:43], s71 offen offset:1024 lds
    buffer_load_dwordx4 v8, s[40:43], s71 offen offset:2048 lds
    s_mov_b32 s71, 1376256
    s_add_u32 m0, s83, 122880
    s_nop 0
    buffer_load_dwordx4 v6, s[40:43], s71 offen offset:0 lds
    buffer_load_dwordx4 v7, s[40:43], s71 offen offset:1024 lds
    buffer_load_dwordx4 v8, s[40:43], s71 offen offset:2048 lds
    s_waitcnt vmcnt(17)
    s_barrier
    s_mov_b32 s70, 512
    s_add_u32 m0, s82, 32768
    s_nop 0
    buffer_load_dwordx4 v2, s[36:39], s70 offen offset:0 lds
    buffer_load_dwordx4 v3, s[36:39], s70 offen offset:1024 lds
    buffer_load_dwordx4 v4, s[36:39], s70 offen offset:2048 lds
    buffer_load_dwordx4 v5, s[36:39], s70 offen offset:3072 lds
    s_mov_b32 s71, 1572864
    s_add_u32 m0, s83, 135168
    s_nop 0
    buffer_load_dwordx4 v6, s[40:43], s71 offen offset:0 lds
    buffer_load_dwordx4 v7, s[40:43], s71 offen offset:1024 lds
    buffer_load_dwordx4 v8, s[40:43], s71 offen offset:2048 lds
    s_load_dword s22, s[16:17], 0
    s_load_dword s22, s[16:17], 64
    s_load_dword s22, s[16:17], 2048
    s_load_dword s22, s[16:17], 2112
    s_load_dword s22, s[16:17], 4096
    s_load_dword s22, s[16:17], 4160
    s_add_u32 s16, s16, 786432
    s_addc_u32 s17, s17, 0
    s_waitcnt vmcnt(21)
    s_barrier
    s_mov_b32 s70, 262656
    s_add_u32 m0, s82, 49152
    s_nop 0
    buffer_load_dwordx4 v2, s[36:39], s70 offen offset:0 lds
    buffer_load_dwordx4 v3, s[36:39], s70 offen offset:1024 lds
    buffer_load_dwordx4 v4, s[36:39], s70 offen offset:2048 lds
    buffer_load_dwordx4 v5, s[36:39], s70 offen offset:3072 lds
    s_mov_b32 s71, 1769472
    s_add_u32 m0, s83, 147456
    s_nop 0
    buffer_load_dwordx4 v6, s[40:43], s71 offen offset:0 lds
    buffer_load_dwordx4 v7, s[40:43], s71 offen offset:1024 lds
    buffer_load_dwordx4 v8, s[40:43], s71 offen offset:2048 lds
    s_waitcnt vmcnt(17)
    s_barrier
    s_mov_b32 s70, 640
    s_add_u32 m0, s82, 65536
    s_nop 0
    buffer_load_dwordx4 v2, s[36:39], s70 offen offset:0 lds
    buffer_load_dwordx4 v3, s[36:39], s70 offen offset:1024 lds
    buffer_load_dwordx4 v4, s[36:39], s70 offen offset:2048 lds
    buffer_load_dwordx4 v5, s[36:39], s70 offen offset:3072 lds
    s_mov_b32 s71, 1966080
    s_add_u32 m0, s83, 98304
    s_nop 0
    buffer_load_dwordx4 v6, s[40:43], s71 offen offset:0 lds
    buffer_load_dwordx4 v7, s[40:43], s71 offen offset:1024 lds
    buffer_load_dwordx4 v8, s[40:43], s71 offen offset:2048 lds
    s_load_dword s22, s[18:19], 1408
    s_load_dword s22, s[18:19], 1472
    s_load_dword s22, s[18:19], 3456
    s_load_dword s22, s[18:19], 3520
    s_waitcnt vmcnt(21)
    s_barrier
    s_mov_b32 s70, 262784
    s_add_u32 m0, s82, 81920
    s_nop 0
    buffer_load_dwordx4 v2, s[36:39], s70 offen offset:0 lds
    buffer_load_dwordx4 v3, s[36:39], s70 offen offset:1024 lds
    buffer_load_dwordx4 v4, s[36:39], s70 offen offset:2048 lds
    buffer_load_dwordx4 v5, s[36:39], s70 offen offset:3072 lds
    s_mov_b32 s71, 2162688
    s_add_u32 m0, s83, 110592
    s_nop 0
    buffer_load_dwordx4 v6, s[40:43], s71 offen offset:0 lds
    buffer_load_dwordx4 v7, s[40:43], s71 offen offset:1024 lds
    buffer_load_dwordx4 v8, s[40:43], s71 offen offset:2048 lds
    s_load_dword s22, s[18:19], 5504
    s_load_dword s22, s[18:19], 5568
    s_load_dword s22, s[18:19], 7552
    s_load_dword s22, s[18:19], 7616
    s_waitcnt vmcnt(17)
    s_barrier
    s_mov_b32 s70, 768
    s_add_u32 m0, s82, 0
    s_nop 0
    buffer_load_dwordx4 v2, s[36:39], s70 offen offset:0 lds
    buffer_load_dwordx4 v3, s[36:39], s70 offen offset:1024 lds
    buffer_load_dwordx4 v4, s[36:39], s70 offen offset:2048 lds
    buffer_load_dwordx4 v5, s[36:39], s70 offen offset:3072 lds
    s_mov_b32 s71, 2359296
    s_add_u32 m0, s83, 122880
    s_nop 0
    buffer_load_dwordx4 v6, s[40:43], s71 offen offset:0 lds
    buffer_load_dwordx4 v7, s[40:43], s71 offen offset:1024 lds
    buffer_load_dwordx4 v8, s[40:43], s71 offen offset:2048 lds
    s_load_dword s22, s[16:17], 0
    s_load_dword s22, s[16:17], 64
    s_load_dword s22, s[16:17], 2048
    s_load_dword s22, s[16:17], 2112
    s_load_dword s22, s[16:17], 4096
    s_load_dword s22, s[16:17], 4160
    s_add_u32 s16, s16, 786432
    s_addc_u32 s17, s17, 0
    s_load_dword s22, s[18:19], 9600
    s_load_dword s22, s[18:19], 9664
    s_load_dword s22, s[18:19], 11648
    s_load_dword s22, s[18:19], 11712
    s_waitcnt vmcnt(21)
    s_barrier
    s_mov_b32 s70, 262912
    s_add_u32 m0, s82, 16384
    s_nop 0
    buffer_load_dwordx4 v2, s[36:39], s70 offen offset:0 lds
    buffer_load_dwordx4 v3, s[36:39], s70 offen offset:1024 lds
    buffer_load_dwordx4 v4, s[36:39], s70 offen offset:2048 lds
    buffer_load_dwordx4 v5, s[36:39], s70 offen offset:3072 lds
    s_mov_b32 s71, 2555904
    s_add_u32 m0, s83, 135168
    s_nop 0
    buffer_load_dwordx4 v6, s[40:43], s71 offen offset:0 lds
    buffer_load_dwordx4 v7, s[40:43], s71 offen offset:1024 lds
    buffer_load_dwordx4 v8, s[40:43], s71 offen offset:2048 lds
    s_load_dword s22, s[18:19], 13696
    s_load_dword s22, s[18:19], 13760
    s_load_dword s22, s[18:19], 15744
    s_load_dword s22, s[18:19], 15808
    s_waitcnt vmcnt(17)
    s_barrier
    s_mov_b32 s70, 896
    s_add_u32 m0, s82, 32768
    s_nop 0
    buffer_load_dwordx4 v2, s[36:39], s70 offen offset:0 lds
    buffer_load_dwordx4 v3, s[36:39], s70 offen offset:1024 lds
    buffer_load_dwordx4 v4, s[36:39], s70 offen offset:2048 lds
    buffer_load_dwordx4 v5, s[36:39], s70 offen offset:3072 lds
    s_mov_b32 s71, 2752512
    s_add_u32 m0, s83, 147456
    s_nop 0
    buffer_load_dwordx4 v6, s[40:43], s71 offen offset:0 lds
    buffer_load_dwordx4 v7, s[40:43], s71 offen offset:1024 lds
    buffer_load_dwordx4 v8, s[40:43], s71 offen offset:2048 lds
    s_load_dword s22, s[18:19], 17792
    s_load_dword s22, s[18:19], 17856
    s_load_dword s22, s[18:19], 19840
    s_load_dword s22, s[18:19], 19904
    s_waitcnt vmcnt(21)
    s_barrier
    s_mov_b32 s70, 263040
    s_add_u32 m0, s82, 49152
    s_nop 0
    buffer_load_dwordx4 v2, s[36:39], s70 offen offset:0 lds
    buffer_load_dwordx4 v3, s[36:39], s70 offen offset:1024 lds
    buffer_load_dwordx4 v4, s[36:39], s70 offen offset:2048 lds
    buffer_load_dwordx4 v5, s[36:39], s70 offen offset:3072 lds
    s_mov_b32 s71, 2949120
    s_add_u32 m0, s83, 98304
    s_nop 0
    buffer_load_dwordx4 v6, s[40:43], s71 offen offset:0 lds
    buffer_load_dwordx4 v7, s[40:43], s71 offen offset:1024 lds
    buffer_load_dwordx4 v8, s[40:43], s71 offen offset:2048 lds
    s_load_dword s22, s[18:19], 21888
    s_load_dword s22, s[18:19], 21952
    s_load_dword s22, s[18:19], 23936
    s_load_dword s22, s[18:19], 24000
    s_waitcnt vmcnt(17)
    s_barrier
    s_mov_b32 s70, 1024
    s_add_u32 m0, s82, 65536
    s_nop 0
    buffer_load_dwordx4 v2, s[36:39], s70 offen offset:0 lds
    buffer_load_dwordx4 v3, s[36:39], s70 offen offset:1024 lds
    buffer_load_dwordx4 v4, s[36:39], s70 offen offset:2048 lds
    buffer_load_dwordx4 v5, s[36:39], s70 offen offset:3072 lds
    s_mov_b32 s71, 3145728
    s_add_u32 m0, s83, 110592
    s_nop 0
    buffer_load_dwordx4 v6, s[40:43], s71 offen offset:0 lds
    buffer_load_dwordx4 v7, s[40:43], s71 offen offset:1024 lds
    buffer_load_dwordx4 v8, s[40:43], s71 offen offset:2048 lds
    s_load_dword s22, s[16:17], 0
    s_load_dword s22, s[16:17], 64
    s_load_dword s22, s[16:17], 2048
    s_load_dword s22, s[16:17], 2112
    s_load_dword s22, s[16:17], 4096
    s_load_dword s22, s[16:17], 4160
    s_add_u32 s16, s16, 786432
    s_addc_u32 s17, s17, 0
    s_load_dword s22, s[18:19], 25984
    s_load_dword s22, s[18:19], 26048
    s_load_dword s22, s[18:19], 28032
    s_load_dword s22, s[18:19], 28096
    s_waitcnt vmcnt(21)
    s_barrier
    s_mov_b32 s70, 263168
    s_add_u32 m0, s82, 81920
    s_nop 0
    buffer_load_dwordx4 v2, s[36:39], s70 offen offset:0 lds
    buffer_load_dwordx4 v3, s[36:39], s70 offen offset:1024 lds
    buffer_load_dwordx4 v4, s[36:39], s70 offen offset:2048 lds
    buffer_load_dwordx4 v5, s[36:39], s70 offen offset:3072 lds
    s_mov_b32 s71, 3342336
    s_add_u32 m0, s83, 122880
    s_nop 0
    buffer_load_dwordx4 v6, s[40:43], s71 offen offset:0 lds
    buffer_load_dwordx4 v7, s[40:43], s71 offen offset:1024 lds
    buffer_load_dwordx4 v8, s[40:43], s71 offen offset:2048 lds
    s_load_dword s22, s[18:19], 30080
    s_load_dword s22, s[18:19], 30144
    s_load_dword s22, s[18:19], 32128
    s_load_dword s22, s[18:19], 32192
    s_waitcnt vmcnt(17)
    s_barrier
    s_mov_b32 s70, 1152
    s_add_u32 m0, s82, 0
    s_nop 0
    buffer_load_dwordx4 v2, s[36:39], s70 offen offset:0 lds
    buffer_load_dwordx4 v3, s[36:39], s70 offen offset:1024 lds
    buffer_load_dwordx4 v4, s[36:39], s70 offen offset:2048 lds
    buffer_load_dwordx4 v5, s[36:39], s70 offen offset:3072 lds
    s_mov_b32 s71, 3538944
    s_add_u32 m0, s83, 135168
    s_nop 0
    buffer_load_dwordx4 v6, s[40:43], s71 offen offset:0 lds
    buffer_load_dwordx4 v7, s[40:43], s71 offen offset:1024 lds
    buffer_load_dwordx4 v8, s[40:43], s71 offen offset:2048 lds
    s_load_dword s22, s[20:21], 384
    s_load_dword s22, s[20:21], 448
    s_load_dword s22, s[20:21], 1408
    s_load_dword s22, s[20:21], 1472
    s_waitcnt vmcnt(21)
    s_barrier
    s_mov_b32 s70, 263296
    s_add_u32 m0, s82, 16384
    s_nop 0
    buffer_load_dwordx4 v2, s[36:39], s70 offen offset:0 lds
    buffer_load_dwordx4 v3, s[36:39], s70 offen offset:1024 lds
    buffer_load_dwordx4 v4, s[36:39], s70 offen offset:2048 lds
    buffer_load_dwordx4 v5, s[36:39], s70 offen offset:3072 lds
    s_mov_b32 s71, 3735552
    s_add_u32 m0, s83, 147456
    s_nop 0
    buffer_load_dwordx4 v6, s[40:43], s71 offen offset:0 lds
    buffer_load_dwordx4 v7, s[40:43], s71 offen offset:1024 lds
    buffer_load_dwordx4 v8, s[40:43], s71 offen offset:2048 lds
    s_load_dword s22, s[20:21], 2432
    s_load_dword s22, s[20:21], 2496
    s_load_dword s22, s[20:21], 3456
    s_load_dword s22, s[20:21], 3520
    s_waitcnt vmcnt(17)
    s_barrier
    s_mov_b32 s70, 1280
    s_add_u32 m0, s82, 32768
    s_nop 0
    buffer_load_dwordx4 v2, s[36:39], s70 offen offset:0 lds
    buffer_load_dwordx4 v3, s[36:39], s70 offen offset:1024 lds
    buffer_load_dwordx4 v4, s[36:39], s70 offen offset:2048 lds
    buffer_load_dwordx4 v5, s[36:39], s70 offen offset:3072 lds
    s_mov_b32 s71, 3932160
    s_add_u32 m0, s83, 98304
    s_nop 0
    buffer_load_dwordx4 v6, s[40:43], s71 offen offset:0 lds
    buffer_load_dwordx4 v7, s[40:43], s71 offen offset:1024 lds
    buffer_load_dwordx4 v8, s[40:43], s71 offen offset:2048 lds
    s_load_dword s22, s[16:17], 0
    s_load_dword s22, s[16:17], 64
    s_load_dword s22, s[16:17], 2048
    s_load_dword s22, s[16:17], 2112
    s_load_dword s22, s[16:17], 4096
    s_load_dword s22, s[16:17], 4160
    s_add_u32 s16, s16, 786432
    s_addc_u32 s17, s17, 0
    s_load_dword s22, s[20:21], 4480
    s_load_dword s22, s[20:21], 4544
    s_load_dword s22, s[20:21], 5504
    s_load_dword s22, s[20:21], 5568
    s_waitcnt vmcnt(21)
    s_barrier
    s_mov_b32 s70, 263424
    s_add_u32 m0, s82, 49152
    s_nop 0
    buffer_load_dwordx4 v2, s[36:39], s70 offen offset:0 lds
    buffer_load_dwordx4 v3, s[36:39], s70 offen offset:1024 lds
    buffer_load_dwordx4 v4, s[36:39], s70 offen offset:2048 lds
    buffer_load_dwordx4 v5, s[36:39], s70 offen offset:3072 lds
    s_mov_b32 s71, 4128768
    s_add_u32 m0, s83, 110592
    s_nop 0
    buffer_load_dwordx4 v6, s[40:43], s71 offen offset:0 lds
    buffer_load_dwordx4 v7, s[40:43], s71 offen offset:1024 lds
    buffer_load_dwordx4 v8, s[40:43], s71 offen offset:2048 lds
    s_load_dword s22, s[20:21], 6528
    s_load_dword s22, s[20:21], 6592
    s_load_dword s22, s[20:21], 7552
    s_load_dword s22, s[20:21], 7616
    s_waitcnt vmcnt(17)
    s_barrier
    s_mov_b32 s70, 1408
    s_add_u32 m0, s82, 65536
    s_nop 0
    buffer_load_dwordx4 v2, s[36:39], s70 offen offset:0 lds
    buffer_load_dwordx4 v3, s[36:39], s70 offen offset:1024 lds
    buffer_load_dwordx4 v4, s[36:39], s70 offen offset:2048 lds
    buffer_load_dwordx4 v5, s[36:39], s70 offen offset:3072 lds
    s_mov_b32 s71, 4325376
    s_add_u32 m0, s83, 122880
    s_nop 0
    buffer_load_dwordx4 v6, s[40:43], s71 offen offset:0 lds
    buffer_load_dwordx4 v7, s[40:43], s71 offen offset:1024 lds
    buffer_load_dwordx4 v8, s[40:43], s71 offen offset:2048 lds
    s_load_dword s22, s[20:21], 8576
    s_load_dword s22, s[20:21], 8640
    s_load_dword s22, s[20:21], 9600
    s_load_dword s22, s[20:21], 9664
    v_lshlrev_b32 v1, 4, v0
    v_and_b32 v192, 0x33, v0
    v_bfe_u32 v193, v0, 2, 1
    v_lshl_or_b32 v192, v193, 3, v192
    v_bfe_u32 v193, v0, 3, 1
    v_lshl_or_b32 v192, v193, 2, v192
    s_lshl_b32 s26, s74, 14
    v_lshlrev_b32 v190, 4, v192
    v_add_u32 v191, s26, v1
    s_add_u32 s26, s26, 98304
    v_add_u32 v190, s26, v190
    s_lshl_b32 s26, s74, 14
    s_add_u32 s27, s26, 0xffff0000
    s_waitcnt vmcnt(21)
    s_barrier
    s_mov_b32 s70, 263552
    s_add_u32 m0, s82, 81920
    s_nop 0
    buffer_load_dwordx4 v2, s[36:39], s70 offen offset:0 lds
    buffer_load_dwordx4 v3, s[36:39], s70 offen offset:1024 lds
    buffer_load_dwordx4 v4, s[36:39], s70 offen offset:2048 lds
    buffer_load_dwordx4 v5, s[36:39], s70 offen offset:3072 lds
    s_mov_b32 s71, 4521984
    s_add_u32 m0, s83, 135168
    s_nop 0
    buffer_load_dwordx4 v6, s[40:43], s71 offen offset:0 lds
    buffer_load_dwordx4 v7, s[40:43], s71 offen offset:1024 lds
    buffer_load_dwordx4 v8, s[40:43], s71 offen offset:2048 lds
    s_load_dword s22, s[20:21], 10624
    s_load_dword s22, s[20:21], 10688
    s_load_dword s22, s[20:21], 11648
    s_load_dword s22, s[20:21], 11712
    v_add_u32 v196, s27, v190
    s_add_u32 s27, s26, 34816
    v_add_u32 v197, s27, v191
    s_add_u32 s27, s26, 131072
    v_mov_b32 v198, s27
    v_lshrrev_b32 v192, 2, v0
    v_lshrrev_b32 v193, 4, v0
    v_xor_b32 v192, v192, v193
    v_and_b32 v192, 1, v192
    v_subrev_u32 v192, 1, v192
    v_and_b32 v184, 0x3f803f80, v192
    v_mov_b32 v185, v184
    s_waitcnt vmcnt(17)
    s_barrier
    s_mov_b32 s70, 1536
    s_add_u32 m0, s82, 0
    s_nop 0
    buffer_load_dwordx4 v2, s[36:39], s70 offen offset:0 lds
    buffer_load_dwordx4 v3, s[36:39], s70 offen offset:1024 lds
    buffer_load_dwordx4 v4, s[36:39], s70 offen offset:2048 lds
    buffer_load_dwordx4 v5, s[36:39], s70 offen offset:3072 lds
    s_mov_b32 s71, 4718592
    s_add_u32 m0, s83, 147456
    s_nop 0
    buffer_load_dwordx4 v6, s[40:43], s71 offen offset:0 lds
    buffer_load_dwordx4 v7, s[40:43], s71 offen offset:1024 lds
    buffer_load_dwordx4 v8, s[40:43], s71 offen offset:2048 lds
    s_load_dword s22, s[16:17], 0
    s_load_dword s22, s[16:17], 64
    s_load_dword s22, s[16:17], 2048
    s_load_dword s22, s[16:17], 2112
    s_load_dword s22, s[16:17], 4096
    s_load_dword s22, s[16:17], 4160
    s_add_u32 s16, s16, 786432
    s_addc_u32 s17, s17, 0
    s_load_dword s22, s[20:21], 12672
    s_load_dword s22, s[20:21], 12736
    s_load_dword s22, s[20:21], 13696
    s_load_dword s22, s[20:21], 13760
    v_mov_b32 v186, v184
    v_mov_b32 v187, v184
    v_and_b32 v192, 31, v0
    v_lshrrev_b32 v88, 5, v0
    v_lshlrev_b32 v88, 3, v88
    v_sub_u32 v192, v192, v88
    s_mov_b32 s27, 0xff800000
    v_subrev_u32 v88, 0, v192
    v_ashrrev_i32 v88, 31, v88
    v_and_b32 v88, s27, v88
    v_subrev_u32 v89, 1, v192
    v_ashrrev_i32 v89, 31, v89
    s_waitcnt vmcnt(21)
    s_barrier
    s_mov_b32 s70, 263680
    s_add_u32 m0, s82, 16384
    s_nop 0
    buffer_load_dwordx4 v2, s[36:39], s70 offen offset:0 lds
    buffer_load_dwordx4 v3, s[36:39], s70 offen offset:1024 lds
    buffer_load_dwordx4 v4, s[36:39], s70 offen offset:2048 lds
    buffer_load_dwordx4 v5, s[36:39], s70 offen offset:3072 lds
    s_mov_b32 s71, 4915200
    s_add_u32 m0, s83, 98304
    s_nop 0
    buffer_load_dwordx4 v6, s[40:43], s71 offen offset:0 lds
    buffer_load_dwordx4 v7, s[40:43], s71 offen offset:1024 lds
    buffer_load_dwordx4 v8, s[40:43], s71 offen offset:2048 lds
    s_load_dword s22, s[20:21], 14720
    s_load_dword s22, s[20:21], 14784
    s_load_dword s22, s[20:21], 15744
    s_load_dword s22, s[20:21], 15808
    v_and_b32 v89, s27, v89
    v_subrev_u32 v90, 2, v192
    v_ashrrev_i32 v90, 31, v90
    v_and_b32 v90, s27, v90
    v_subrev_u32 v91, 3, v192
    v_ashrrev_i32 v91, 31, v91
    v_and_b32 v91, s27, v91
    v_subrev_u32 v92, 4, v192
    v_ashrrev_i32 v92, 31, v92
    v_and_b32 v92, s27, v92
    v_subrev_u32 v93, 5, v192
    v_ashrrev_i32 v93, 31, v93
    s_waitcnt vmcnt(17)
    s_barrier
    s_mov_b32 s70, 1664
    s_add_u32 m0, s82, 32768
    s_nop 0
    buffer_load_dwordx4 v2, s[36:39], s70 offen offset:0 lds
    buffer_load_dwordx4 v3, s[36:39], s70 offen offset:1024 lds
    buffer_load_dwordx4 v4, s[36:39], s70 offen offset:2048 lds
    buffer_load_dwordx4 v5, s[36:39], s70 offen offset:3072 lds
    s_mov_b32 s71, 5111808
    s_add_u32 m0, s83, 110592
    s_nop 0
    buffer_load_dwordx4 v6, s[40:43], s71 offen offset:0 lds
    buffer_load_dwordx4 v7, s[40:43], s71 offen offset:1024 lds
    buffer_load_dwordx4 v8, s[40:43], s71 offen offset:2048 lds
    v_and_b32 v93, s27, v93
    v_subrev_u32 v94, 6, v192
    v_ashrrev_i32 v94, 31, v94
    v_and_b32 v94, s27, v94
    v_subrev_u32 v95, 7, v192
    v_ashrrev_i32 v95, 31, v95
    v_and_b32 v95, s27, v95
    v_subrev_u32 v96, 16, v192
    v_ashrrev_i32 v96, 31, v96
    v_and_b32 v96, s27, v96
    v_subrev_u32 v97, 17, v192
    v_ashrrev_i32 v97, 31, v97
    s_waitcnt vmcnt(21)
    s_barrier
    s_mov_b32 s70, 263808
    s_add_u32 m0, s82, 49152
    s_nop 0
    buffer_load_dwordx4 v2, s[36:39], s70 offen offset:0 lds
    buffer_load_dwordx4 v3, s[36:39], s70 offen offset:1024 lds
    buffer_load_dwordx4 v4, s[36:39], s70 offen offset:2048 lds
    buffer_load_dwordx4 v5, s[36:39], s70 offen offset:3072 lds
    s_mov_b32 s71, 5309440
    s_add_u32 m0, s68, 122880
    s_nop 0
    buffer_load_dwordx4 v7, s[40:43], s71 offen offset:0 lds
    buffer_load_dwordx4 v8, s[40:43], s71 offen offset:1024 lds
    v_and_b32 v97, s27, v97
    v_subrev_u32 v98, 18, v192
    v_ashrrev_i32 v98, 31, v98
    v_and_b32 v98, s27, v98
    v_subrev_u32 v99, 19, v192
    v_ashrrev_i32 v99, 31, v99
    v_and_b32 v99, s27, v99
    v_subrev_u32 v100, 20, v192
    v_ashrrev_i32 v100, 31, v100
    v_and_b32 v100, s27, v100
    v_subrev_u32 v101, 21, v192
    v_ashrrev_i32 v101, 31, v101
    s_waitcnt vmcnt(16)
    s_barrier
    s_mov_b32 s70, 1792
    s_add_u32 m0, s82, 65536
    s_nop 0
    buffer_load_dwordx4 v2, s[36:39], s70 offen offset:0 lds
    buffer_load_dwordx4 v3, s[36:39], s70 offen offset:1024 lds
    buffer_load_dwordx4 v4, s[36:39], s70 offen offset:2048 lds
    buffer_load_dwordx4 v5, s[36:39], s70 offen offset:3072 lds
    s_mov_b32 s71, 5506048
    s_add_u32 m0, s68, 131072
    s_nop 0
    buffer_load_dwordx4 v7, s[40:43], s71 offen offset:0 lds
    buffer_load_dwordx4 v8, s[40:43], s71 offen offset:1024 lds
    v_and_b32 v101, s27, v101
    v_subrev_u32 v102, 22, v192
    v_ashrrev_i32 v102, 31, v102
    v_and_b32 v102, s27, v102
    v_subrev_u32 v103, 23, v192
    v_ashrrev_i32 v103, 31, v103
    v_and_b32 v103, s27, v103
    s_mov_b32 s27, 0xff800000
    v_xor_b32 v136, s27, v88
    v_xor_b32 v137, s27, v89
    v_xor_b32 v138, s27, v90
    v_xor_b32 v139, s27, v91
    s_waitcnt vmcnt(19)
    s_barrier
    s_mov_b32 s70, 263936
    s_add_u32 m0, s82, 81920
    s_nop 0
    buffer_load_dwordx4 v2, s[36:39], s70 offen offset:0 lds
    buffer_load_dwordx4 v3, s[36:39], s70 offen offset:1024 lds
    buffer_load_dwordx4 v4, s[36:39], s70 offen offset:2048 lds
    buffer_load_dwordx4 v5, s[36:39], s70 offen offset:3072 lds
    s_mov_b32 s71, 5702656
    s_add_u32 m0, s68, 139264
    s_nop 0
    buffer_load_dwordx4 v7, s[40:43], s71 offen offset:0 lds
    buffer_load_dwordx4 v8, s[40:43], s71 offen offset:1024 lds
    v_xor_b32 v140, s27, v92
    v_xor_b32 v141, s27, v93
    v_xor_b32 v142, s27, v94
    v_xor_b32 v143, s27, v95
    v_xor_b32 v144, s27, v96
    v_xor_b32 v145, s27, v97
    v_xor_b32 v146, s27, v98
    v_xor_b32 v147, s27, v99
    v_xor_b32 v148, s27, v100
    v_xor_b32 v149, s27, v101
    v_xor_b32 v150, s27, v102
    v_xor_b32 v151, s27, v103
    s_waitcnt vmcnt(14)
    s_barrier
    s_mov_b32 s70, 1920
    s_add_u32 m0, s82, 0
    s_nop 0
    buffer_load_dwordx4 v2, s[36:39], s70 offen offset:0 lds
    buffer_load_dwordx4 v3, s[36:39], s70 offen offset:1024 lds
    buffer_load_dwordx4 v4, s[36:39], s70 offen offset:2048 lds
    buffer_load_dwordx4 v5, s[36:39], s70 offen offset:3072 lds
    s_mov_b32 s71, 5899264
    s_add_u32 m0, s68, 147456
    s_nop 0
    buffer_load_dwordx4 v7, s[40:43], s71 offen offset:0 lds
    buffer_load_dwordx4 v8, s[40:43], s71 offen offset:1024 lds
    v_lshrrev_b32 v192, 3, v0
    v_and_b32 v188, 7, v0
    v_bfe_u32 v189, v0, 4, 2
    v_lshlrev_b32 v189, 1, v189
    v_xor_b32 v188, v188, v189
    s_lshr_b32 s26, s63, 2
    s_lshl_b32 s26, s26, 20
    s_and_b32 s27, s63, 3
    s_lshl_b32 s27, s27, 14
    s_add_u32 s26, s26, s27
    s_lshl_b32 s27, s80, 7
    s_add_u32 s26, s26, s27
    s_waitcnt vmcnt(18)
    s_barrier
    s_mov_b32 s70, 264064
    s_add_u32 m0, s82, 16384
    s_nop 0
    buffer_load_dwordx4 v2, s[36:39], s70 offen offset:0 lds
    buffer_load_dwordx4 v3, s[36:39], s70 offen offset:1024 lds
    buffer_load_dwordx4 v4, s[36:39], s70 offen offset:2048 lds
    buffer_load_dwordx4 v5, s[36:39], s70 offen offset:3072 lds
    s_mov_b32 s71, 6095872
    s_add_u32 m0, s68, 98304
    s_nop 0
    buffer_load_dwordx4 v7, s[40:43], s71 offen offset:0 lds
    buffer_load_dwordx4 v8, s[40:43], s71 offen offset:1024 lds
    v_lshlrev_b32 v192, 11, v192
    v_add_u32 v192, s26, v192
    v_lshl_add_u32 v188, v188, 4, v192
    v_xor_b32 v195, 0x100000, v188
    v_and_b32 v189, 15, v0
    v_lshrrev_b32 v192, 5, v0
    v_lshl_add_u32 v189, v192, 4, v189
    v_lshlrev_b32 v189, 4, v189
    v_bfe_u32 v192, v0, 4, 1
    v_lshl_add_u32 v189, v192, 15, v189
    v_add_u32 v192, 155648, v1
    s_waitcnt vmcnt(14)
    s_barrier
    s_waitcnt vmcnt(12)
    s_barrier
    s_mov_b32 s71, 5898240
    s_add_u32 m0, s69, 131072
    s_nop 0
    buffer_load_dwordx4 v6, s[40:43], s71 offen lds
    s_mov_b32 s71, 6094848
    s_add_u32 m0, s69, 135168
    s_nop 0
    buffer_load_dwordx4 v6, s[40:43], s71 offen lds
    s_waitcnt vmcnt(4)
    s_barrier
    s_mov_b32 s71, 5505024
    s_add_u32 m0, s69, 139264
    s_nop 0
    buffer_load_dwordx4 v6, s[40:43], s71 offen lds
    s_mov_b32 s71, 5701632
    s_add_u32 m0, s69, 143360
    s_nop 0
    buffer_load_dwordx4 v6, s[40:43], s71 offen lds
    s_waitcnt vmcnt(4)
    s_barrier
    s_mov_b32 s71, 5111808
    s_add_u32 m0, s69, 147456
    s_nop 0
    buffer_load_dwordx4 v6, s[40:43], s71 offen lds
    s_mov_b32 s71, 5308416
    s_add_u32 m0, s69, 151552
    s_nop 0
    buffer_load_dwordx4 v6, s[40:43], s71 offen lds
    s_waitcnt vmcnt(4)
    s_barrier
    s_lshl_b32 s82, s63, 10
    ds_write_b128 v192, v[88:91] offset:0
    ds_write_b128 v192, v[92:95] offset:1024
    ds_write_b128 v192, v[96:99] offset:2048
    ds_write_b128 v192, v[100:103] offset:3072
    ds_write_b128 v192, v[136:139] offset:4096
    ds_write_b128 v192, v[140:143] offset:5120
    ds_write_b128 v192, v[144:147] offset:6144
    ds_write_b128 v192, v[148:151] offset:7168
    s_waitcnt lgkmcnt(0)
    s_waitcnt vmcnt(2)
    s_barrier
    s_waitcnt vmcnt(0)
    s_barrier
    s_barrier
    s_branch L_attn
L_compute:
    s_lshr_b32 s73, s63, 1
    v_and_b32 v5, 15, v0
    v_lshrrev_b32 v6, 4, v0
    v_bfe_u32 v7, v0, 1, 3
    v_xor_b32 v7, v7, v6
    v_lshlrev_b32 v7, 4, v7
    v_lshl_add_u32 v7, v5, 7, v7
    s_lshl_b32 s64, s73, 14
    v_add_u32 v1, s64, v7
    v_xor_b32 v2, 64, v1
    v_bfe_u32 v5, v0, 2, 2
    v_lshlrev_b32 v3, 7, v5
    v_and_b32 v5, 3, v0
    v_lshl_add_u32 v3, v5, 3, v3
    v_mul_u32_u24 v5, 3072, v6
    v_add_u32 v3, v3, v5
    v_bfe_u32 v5, v0, 3, 2
    s_lshl_b32 s64, s74, 1
    v_xor_b32 v5, s64, v5
    v_lshl_add_u32 v3, v5, 5, v3
    v_add_u32 v3, 98304, v3
    v_xor_b32 v4, 32, v3
    s_and_b32 s64, s62, 3
    s_lshl_b32 s64, s64, 6
    s_lshl_b32 s65, s63, 4
    s_add_u32 s64, s64, s65
    s_lshl_b32 s64, s64, 11
    v_lshlrev_b32 v5, 11, v0
    v_add_u32 v5, s64, v5
    v_mov_b32 v11, 0x7f000000
    v_cmp_lt_u32 vcc, 15, v0
    v_and_b32 v9, 1, v0
    v_lshrrev_b32 v10, 1, v0
    v_cndmask_b32 v5, v5, v11, vcc
    s_lshl_b32 s64, s61, 3
    s_lshl_b32 s65, s63, 1
    s_add_u32 s64, s64, s65
    v_add_u32 v6, s64, v9
    v_mul_u32_u24 v6, 6144, v6
    v_lshl_add_u32 v6, v10, 11, v6
    s_lshl_b32 s64, s62, 7
    v_add_u32 v6, s64, v6
    v_cmp_lt_u32 vcc, 5, v0
    s_movk_i32 s70, 512
    s_mov_b32 s71, 1572864
    v_cndmask_b32 v6, v6, v11, vcc
    s_getpc_b64 s[92:93]
    s_mov_b32 s94, (L_codeend - L_pcref)
    s_mov_b32 s95, 0x20000
    s_lshr_b32 s64, s2, 3
    s_and_b32 s64, s64, 7
    s_lshl_b32 s64, s64, 2
    s_add_u32 s64, s64, s63
    s_mul_i32 s64, s64, 2048
    v_lshlrev_b32 v12, 7, v0
    v_add_u32 v12, s64, v12
    v_cmp_lt_u32 vcc, 15, v0
    s_nop 1
    v_cndmask_b32 v12, v12, v11, vcc
    s_and_b32 s64, s79, 1
    s_lshl_b32 s64, s64, 9
    s_mul_i32 s65, s63, 10
    s_add_u32 s64, s64, s65
    s_lshl_b32 s64, s64, 11
    s_lshl_b32 s65, s80, 7
    s_add_u32 s88, s64, s65
    v_cmp_lt_u32 vcc, 9, v0
    v_lshlrev_b32 v0, 11, v0
    s_nop 0
    v_cndmask_b32 v0, v0, v11, vcc
L_pcref:
    s_add_u32 s64, s32, 25165824
    s_addc_u32 s65, s33, 0
    s_load_dword s77, s[64:65], 0
    s_mov_b32 s44, s32
    s_mov_b32 s45, s33
    s_mov_b32 s46, 27262976
    s_mov_b32 s47, 0x20000
    s_mov_b32 s50, 0x200000
    s_mov_b32 s51, 0x20000
    s_mov_b32 s52, s28
    s_mov_b32 s53, s29
    s_mov_b32 s54, 0x800000
    s_mov_b32 s55, 0x20000
    s_mov_b32 s56, s30
    s_mov_b32 s57, s31
    s_mov_b32 s58, 256
    s_mov_b32 s59, 0x20000
    s_lshl_b32 s67, s62, 1
    s_add_u32 s67, s67, s74
    s_lshl_b32 s66, s60, 5
    s_add_u32 s66, s66, s67
    s_lshl_b32 s66, s66, 6
    s_lshl_b32 s78, s61, 3
    s_add_u32 s66, s66, s78
    s_lshl_b32 s78, s66, 12
    s_lshl_b32 s66, s60, 3
    s_add_u32 s66, s66, s61
    s_lshl_b32 s89, s66, 19
    s_lshl_b32 s96, s67, 10
    s_add_u32 s89, s89, s96
    s_add_u32 s89, s89, 16777216
    s_lshl_b32 s96, s66, 11
    s_lshl_b32 s67, s67, 3
    s_add_u32 s96, s96, s67
    s_add_u32 s96, s96, 25231360
    s_mov_b32 s34, 562036736
    s_mov_b32 s35, 1568669696
    s_waitcnt lgkmcnt(0)
    s_add_u32 s77, s77, 1
    s_xor_b32 s81, s77, 1540483477
    v_mov_b32 v64, 0
    v_mov_b32 v65, 0
    v_mov_b32 v66, 0
    v_mov_b32 v67, 0
    v_mov_b32 v68, 0
    v_mov_b32 v69, 0
    v_mov_b32 v70, 0
    v_mov_b32 v71, 0
    v_mov_b32 v72, 0
    v_mov_b32 v73, 0
    v_mov_b32 v74, 0
    v_mov_b32 v75, 0
    v_mov_b32 v76, 0
    v_mov_b32 v77, 0
    v_mov_b32 v78, 0
    v_mov_b32 v79, 0
    v_mov_b32 v80, 0
    v_mov_b32 v81, 0
    v_mov_b32 v82, 0
    v_mov_b32 v83, 0
    v_mov_b32 v84, 0
    v_mov_b32 v85, 0
    v_mov_b32 v86, 0
    v_mov_b32 v87, 0
    v_mov_b32 v88, 0
    v_mov_b32 v89, 0
    v_mov_b32 v90, 0
    v_mov_b32 v91, 0
    v_mov_b32 v92, 0
    v_mov_b32 v93, 0
    v_mov_b32 v94, 0
    v_mov_b32 v95, 0
    v_mov_b32 v96, 0
    v_mov_b32 v97, 0
    v_mov_b32 v98, 0
    v_mov_b32 v99, 0
    v_mov_b32 v100, 0
    v_mov_b32 v101, 0
    v_mov_b32 v102, 0
    v_mov_b32 v103, 0
    v_mov_b32 v104, 0
    v_mov_b32 v105, 0
    v_mov_b32 v106, 0
    v_mov_b32 v107, 0
    v_mov_b32 v108, 0
    v_mov_b32 v109, 0
    v_mov_b32 v110, 0
    v_mov_b32 v111, 0
    v_mov_b32 v112, 0
    v_mov_b32 v113, 0
    v_mov_b32 v114, 0
    v_mov_b32 v115, 0
    v_mov_b32 v116, 0
    v_mov_b32 v117, 0
    v_mov_b32 v118, 0
    v_mov_b32 v119, 0
    v_mov_b32 v120, 0
    v_mov_b32 v121, 0
    v_mov_b32 v122, 0
    v_mov_b32 v123, 0
    v_mov_b32 v124, 0
    v_mov_b32 v125, 0
    v_mov_b32 v126, 0
    v_mov_b32 v127, 0
    v_mov_b32 v128, 0
    v_mov_b32 v129, 0
    v_mov_b32 v130, 0
    v_mov_b32 v131, 0
    v_mov_b32 v132, 0
    v_mov_b32 v133, 0
    v_mov_b32 v134, 0
    v_mov_b32 v135, 0
    v_mov_b32 v136, 0
    v_mov_b32 v137, 0
    v_mov_b32 v138, 0
    v_mov_b32 v139, 0
    v_mov_b32 v140, 0
    v_mov_b32 v141, 0
    v_mov_b32 v142, 0
    v_mov_b32 v143, 0
    v_mov_b32 v144, 0
    v_mov_b32 v145, 0
    v_mov_b32 v146, 0
    v_mov_b32 v147, 0
    v_mov_b32 v148, 0
    v_mov_b32 v149, 0
    v_mov_b32 v150, 0
    v_mov_b32 v151, 0
    v_mov_b32 v152, 0
    v_mov_b32 v153, 0
    v_mov_b32 v154, 0
    v_mov_b32 v155, 0
    v_mov_b32 v156, 0
    v_mov_b32 v157, 0
    v_mov_b32 v158, 0
    v_mov_b32 v159, 0
    v_mov_b32 v160, 0
    v_mov_b32 v161, 0
    v_mov_b32 v162, 0
    v_mov_b32 v163, 0
    v_mov_b32 v164, 0
    v_mov_b32 v165, 0
    v_mov_b32 v166, 0
    v_mov_b32 v167, 0
    v_mov_b32 v168, 0
    v_mov_b32 v169, 0
    v_mov_b32 v170, 0
    v_mov_b32 v171, 0
    v_mov_b32 v172, 0
    v_mov_b32 v173, 0
    v_mov_b32 v174, 0
    v_mov_b32 v175, 0
    v_mov_b32 v176, 0
    v_mov_b32 v177, 0
    v_mov_b32 v178, 0
    v_mov_b32 v179, 0
    v_mov_b32 v180, 0
    v_mov_b32 v181, 0
    v_mov_b32 v182, 0
    v_mov_b32 v183, 0
    v_mov_b32 v184, 0
    v_mov_b32 v185, 0
    v_mov_b32 v186, 0
    v_mov_b32 v187, 0
    v_mov_b32 v188, 0
    v_mov_b32 v189, 0
    v_mov_b32 v190, 0
    v_mov_b32 v191, 0
    v_mov_b32 v192, 0
    v_mov_b32 v193, 0
    v_mov_b32 v194, 0
    v_mov_b32 v195, 0
    v_mov_b32 v196, 0
    v_mov_b32 v197, 0
    v_mov_b32 v198, 0
    v_mov_b32 v199, 0
    v_mov_b32 v200, 0
    v_mov_b32 v201, 0
    v_mov_b32 v202, 0
    v_mov_b32 v203, 0
    v_mov_b32 v204, 0
    v_mov_b32 v205, 0
    v_mov_b32 v206, 0
    v_mov_b32 v207, 0
    v_mov_b32 v208, 0
    v_mov_b32 v209, 0
    v_mov_b32 v210, 0
    v_mov_b32 v211, 0
    v_mov_b32 v212, 0
    v_mov_b32 v213, 0
    v_mov_b32 v214, 0
    v_mov_b32 v215, 0
    v_mov_b32 v216, 0
    v_mov_b32 v217, 0
    v_mov_b32 v218, 0
    v_mov_b32 v219, 0
    v_mov_b32 v220, 0
    v_mov_b32 v221, 0
    v_mov_b32 v222, 0
    v_mov_b32 v223, 0
    v_mov_b32 v224, 0
    v_mov_b32 v225, 0
    v_mov_b32 v226, 0
    v_mov_b32 v227, 0
    v_mov_b32 v228, 0
    v_mov_b32 v229, 0
    v_mov_b32 v230, 0
    v_mov_b32 v231, 0
    v_mov_b32 v232, 0
    v_mov_b32 v233, 0
    v_mov_b32 v234, 0
    v_mov_b32 v235, 0
    v_mov_b32 v236, 0
    v_mov_b32 v237, 0
    v_mov_b32 v238, 0
    v_mov_b32 v239, 0
    v_mov_b32 v240, 0
    v_mov_b32 v241, 0
    v_mov_b32 v242, 0
    v_mov_b32 v243, 0
    v_mov_b32 v244, 0
    v_mov_b32 v245, 0
    v_mov_b32 v246, 0
    v_mov_b32 v247, 0
    v_mov_b32 v248, 0
    v_mov_b32 v249, 0
    v_mov_b32 v250, 0
    v_mov_b32 v251, 0
    v_mov_b32 v252, 0
    v_mov_b32 v253, 0
    v_mov_b32 v254, 0
    v_mov_b32 v255, 0
    s_mov_b32 s68, 0
    s_mov_b32 s69, 0
    s_mov_b32 s72, 13
    s_barrier
    buffer_load_dword v7, v12, s[92:95], 0 offen
    ds_read_b64_tr_b16 v[40:41], v3 offset:1024
    ds_read_b64_tr_b16 v[42:43], v3 offset:1536
    ds_read_b128 v[8:11], v1 offset:0
    ds_read_b64_tr_b16 v[44:45], v4 offset:1024
    ds_read_b64_tr_b16 v[46:47], v4 offset:1536
    ds_read_b128 v[12:15], v1 offset:2048
    ds_read_b64_tr_b16 v[48:49], v3 offset:2048
    ds_read_b64_tr_b16 v[50:51], v3 offset:2560
    ds_read_b128 v[16:19], v1 offset:4096
    ds_read_b128 v[20:23], v1 offset:6144
    ds_read_b128 v[24:27], v1 offset:8192
    ds_read_b128 v[28:31], v1 offset:10240
    ds_read_b128 v[32:35], v1 offset:12288
    ds_read_b128 v[36:39], v1 offset:14336
L_cloop:
    s_waitcnt lgkmcnt(4)
    v_mfma_f32_16x16x32_bf16 v[64:67], v[40:43], v[8:11], v[64:67]
    ds_read_b64_tr_b16 v[52:53], v4 offset:2048
    v_mfma_f32_16x16x32_bf16 v[68:71], v[44:47], v[8:11], v[68:71]
    ds_read_b64_tr_b16 v[54:55], v4 offset:2560
    v_mfma_f32_16x16x32_bf16 v[72:75], v[8:11], v[48:51], v[72:75]
    ds_read_b64_tr_b16 v[56:57], v3 offset:0
    v_mfma_f32_16x16x32_bf16 v[88:91], v[40:43], v[12:15], v[88:91]
    ds_read_b64_tr_b16 v[58:59], v3 offset:512
    v_mfma_f32_16x16x32_bf16 v[92:95], v[44:47], v[12:15], v[92:95]
    ds_read_b64_tr_b16 v[60:61], v4 offset:0
    v_mfma_f32_16x16x32_bf16 v[96:99], v[12:15], v[48:51], v[96:99]
    ds_read_b64_tr_b16 v[62:63], v4 offset:512
    v_mfma_f32_16x16x32_bf16 v[112:115], v[40:43], v[16:19], v[112:115]
    s_add_u32 s64, s69, 12288
    v_mfma_f32_16x16x32_bf16 v[116:119], v[44:47], v[16:19], v[116:119]
    s_cmp_eq_u32 s64, 61440
    v_mfma_f32_16x16x32_bf16 v[120:123], v[16:19], v[48:51], v[120:123]
    s_cselect_b32 s64, 0, s64
    v_mfma_f32_16x16x32_bf16 v[136:139], v[40:43], v[20:23], v[136:139]
    s_sub_u32 s76, s64, s69
    v_mfma_f32_16x16x32_bf16 v[140:143], v[44:47], v[20:23], v[140:143]
    s_mov_b32 s69, s64
    v_mfma_f32_16x16x32_bf16 v[144:147], v[20:23], v[48:51], v[144:147]
    s_waitcnt lgkmcnt(6)
    v_mfma_f32_16x16x32_bf16 v[160:163], v[40:43], v[24:27], v[160:163]
    v_add_u32 v3, s76, v3
    v_mfma_f32_16x16x32_bf16 v[164:167], v[44:47], v[24:27], v[164:167]
    v_add_u32 v4, s76, v4
    v_mfma_f32_16x16x32_bf16 v[168:171], v[24:27], v[48:51], v[168:171]
    v_mfma_f32_16x16x32_bf16 v[184:187], v[40:43], v[28:31], v[184:187]
    v_mfma_f32_16x16x32_bf16 v[188:191], v[44:47], v[28:31], v[188:191]
    v_mfma_f32_16x16x32_bf16 v[192:195], v[28:31], v[48:51], v[192:195]
    v_mfma_f32_16x16x32_bf16 v[208:211], v[40:43], v[32:35], v[208:211]
    v_mfma_f32_16x16x32_bf16 v[212:215], v[44:47], v[32:35], v[212:215]
    v_mfma_f32_16x16x32_bf16 v[216:219], v[32:35], v[48:51], v[216:219]
    v_mfma_f32_16x16x32_bf16 v[232:235], v[40:43], v[36:39], v[232:235]
    v_mfma_f32_16x16x32_bf16 v[236:239], v[44:47], v[36:39], v[236:239]
    v_mfma_f32_16x16x32_bf16 v[240:243], v[36:39], v[48:51], v[240:243]
    s_waitcnt lgkmcnt(0)
    s_barrier
    v_mfma_f32_16x16x32_bf16 v[76:79], v[8:11], v[52:55], v[76:79]
    ds_read_b64_tr_b16 v[40:41], v3 offset:1024
    v_mfma_f32_16x16x32_bf16 v[80:83], v[56:59], v[8:11], v[80:83]
    ds_read_b64_tr_b16 v[42:43], v3 offset:1536
    v_mfma_f32_16x16x32_bf16 v[84:87], v[60:63], v[8:11], v[84:87]
    ds_read_b128 v[8:11], v2 offset:0
    v_mfma_f32_16x16x32_bf16 v[100:103], v[12:15], v[52:55], v[100:103]
    ds_read_b64_tr_b16 v[44:45], v4 offset:1024
    v_mfma_f32_16x16x32_bf16 v[104:107], v[56:59], v[12:15], v[104:107]
    ds_read_b64_tr_b16 v[46:47], v4 offset:1536
    v_mfma_f32_16x16x32_bf16 v[108:111], v[60:63], v[12:15], v[108:111]
    ds_read_b128 v[12:15], v2 offset:2048
    v_mfma_f32_16x16x32_bf16 v[124:127], v[16:19], v[52:55], v[124:127]
    ds_read_b64_tr_b16 v[48:49], v3 offset:2048
    v_mfma_f32_16x16x32_bf16 v[128:131], v[56:59], v[16:19], v[128:131]
    ds_read_b64_tr_b16 v[50:51], v3 offset:2560
    v_mfma_f32_16x16x32_bf16 v[132:135], v[60:63], v[16:19], v[132:135]
    ds_read_b128 v[16:19], v2 offset:4096
    v_mfma_f32_16x16x32_bf16 v[148:151], v[20:23], v[52:55], v[148:151]
    v_mfma_f32_16x16x32_bf16 v[152:155], v[56:59], v[20:23], v[152:155]
    v_mfma_f32_16x16x32_bf16 v[156:159], v[60:63], v[20:23], v[156:159]
    ds_read_b128 v[20:23], v2 offset:6144
    v_mfma_f32_16x16x32_bf16 v[172:175], v[24:27], v[52:55], v[172:175]
    v_mfma_f32_16x16x32_bf16 v[176:179], v[56:59], v[24:27], v[176:179]
    v_mfma_f32_16x16x32_bf16 v[180:183], v[60:63], v[24:27], v[180:183]
    ds_read_b128 v[24:27], v2 offset:8192
    v_mfma_f32_16x16x32_bf16 v[196:199], v[28:31], v[52:55], v[196:199]
    v_mfma_f32_16x16x32_bf16 v[200:203], v[56:59], v[28:31], v[200:203]
    v_mfma_f32_16x16x32_bf16 v[204:207], v[60:63], v[28:31], v[204:207]
    ds_read_b128 v[28:31], v2 offset:10240
    v_mfma_f32_16x16x32_bf16 v[220:223], v[32:35], v[52:55], v[220:223]
    v_mfma_f32_16x16x32_bf16 v[224:227], v[56:59], v[32:35], v[224:227]
    v_mfma_f32_16x16x32_bf16 v[228:231], v[60:63], v[32:35], v[228:231]
    ds_read_b128 v[32:35], v2 offset:12288
    v_mfma_f32_16x16x32_bf16 v[244:247], v[36:39], v[52:55], v[244:247]
    v_mfma_f32_16x16x32_bf16 v[248:251], v[56:59], v[36:39], v[248:251]
    v_mfma_f32_16x16x32_bf16 v[252:255], v[60:63], v[36:39], v[252:255]
    ds_read_b128 v[36:39], v2 offset:14336
    s_waitcnt lgkmcnt(4)
    v_mfma_f32_16x16x32_bf16 v[64:67], v[40:43], v[8:11], v[64:67]
    ds_read_b64_tr_b16 v[52:53], v4 offset:2048
    v_mfma_f32_16x16x32_bf16 v[68:71], v[44:47], v[8:11], v[68:71]
    ds_read_b64_tr_b16 v[54:55], v4 offset:2560
    v_mfma_f32_16x16x32_bf16 v[72:75], v[8:11], v[48:51], v[72:75]
    ds_read_b64_tr_b16 v[56:57], v3 offset:0
    v_mfma_f32_16x16x32_bf16 v[88:91], v[40:43], v[12:15], v[88:91]
    ds_read_b64_tr_b16 v[58:59], v3 offset:512
    v_mfma_f32_16x16x32_bf16 v[92:95], v[44:47], v[12:15], v[92:95]
    ds_read_b64_tr_b16 v[60:61], v4 offset:0
    v_mfma_f32_16x16x32_bf16 v[96:99], v[12:15], v[48:51], v[96:99]
    ds_read_b64_tr_b16 v[62:63], v4 offset:512
    v_mfma_f32_16x16x32_bf16 v[112:115], v[40:43], v[16:19], v[112:115]
    s_add_u32 s64, s69, 12288
    v_mfma_f32_16x16x32_bf16 v[116:119], v[44:47], v[16:19], v[116:119]
    s_cmp_eq_u32 s64, 61440
    v_mfma_f32_16x16x32_bf16 v[120:123], v[16:19], v[48:51], v[120:123]
    s_cselect_b32 s64, 0, s64
    v_mfma_f32_16x16x32_bf16 v[136:139], v[40:43], v[20:23], v[136:139]
    s_sub_u32 s76, s64, s69
    v_mfma_f32_16x16x32_bf16 v[140:143], v[44:47], v[20:23], v[140:143]
    s_mov_b32 s69, s64
    v_mfma_f32_16x16x32_bf16 v[144:147], v[20:23], v[48:51], v[144:147]
    s_waitcnt lgkmcnt(6)
    v_mfma_f32_16x16x32_bf16 v[160:163], v[40:43], v[24:27], v[160:163]
    v_add_u32 v3, s76, v3
    v_mfma_f32_16x16x32_bf16 v[164:167], v[44:47], v[24:27], v[164:167]
    v_add_u32 v4, s76, v4
    v_mfma_f32_16x16x32_bf16 v[168:171], v[24:27], v[48:51], v[168:171]
    s_add_u32 s64, s68, 32768
    v_mfma_f32_16x16x32_bf16 v[184:187], v[40:43], v[28:31], v[184:187]
    s_cmp_eq_u32 s64, 98304
    v_mfma_f32_16x16x32_bf16 v[188:191], v[44:47], v[28:31], v[188:191]
    s_cselect_b32 s64, 0, s64
    v_mfma_f32_16x16x32_bf16 v[192:195], v[28:31], v[48:51], v[192:195]
    s_sub_u32 s75, s64, s68
    v_mfma_f32_16x16x32_bf16 v[208:211], v[40:43], v[32:35], v[208:211]
    s_mov_b32 s68, s64
    v_mfma_f32_16x16x32_bf16 v[212:215], v[44:47], v[32:35], v[212:215]
    v_add_u32 v1, s75, v1
    v_mfma_f32_16x16x32_bf16 v[216:219], v[32:35], v[48:51], v[216:219]
    v_add_u32 v2, s75, v2
    v_mfma_f32_16x16x32_bf16 v[232:235], v[40:43], v[36:39], v[232:235]
    v_mfma_f32_16x16x32_bf16 v[236:239], v[44:47], v[36:39], v[236:239]
    v_mfma_f32_16x16x32_bf16 v[240:243], v[36:39], v[48:51], v[240:243]
    s_waitcnt lgkmcnt(0)
    s_barrier
    v_mfma_f32_16x16x32_bf16 v[76:79], v[8:11], v[52:55], v[76:79]
    ds_read_b64_tr_b16 v[40:41], v3 offset:1024
    v_mfma_f32_16x16x32_bf16 v[80:83], v[56:59], v[8:11], v[80:83]
    ds_read_b64_tr_b16 v[42:43], v3 offset:1536
    v_mfma_f32_16x16x32_bf16 v[84:87], v[60:63], v[8:11], v[84:87]
    ds_read_b128 v[8:11], v1 offset:0
    v_mfma_f32_16x16x32_bf16 v[100:103], v[12:15], v[52:55], v[100:103]
    ds_read_b64_tr_b16 v[44:45], v4 offset:1024
    v_mfma_f32_16x16x32_bf16 v[104:107], v[56:59], v[12:15], v[104:107]
    ds_read_b64_tr_b16 v[46:47], v4 offset:1536
    v_mfma_f32_16x16x32_bf16 v[108:111], v[60:63], v[12:15], v[108:111]
    ds_read_b128 v[12:15], v1 offset:2048
    v_mfma_f32_16x16x32_bf16 v[124:127], v[16:19], v[52:55], v[124:127]
    ds_read_b64_tr_b16 v[48:49], v3 offset:2048
    v_mfma_f32_16x16x32_bf16 v[128:131], v[56:59], v[16:19], v[128:131]
    ds_read_b64_tr_b16 v[50:51], v3 offset:2560
    v_mfma_f32_16x16x32_bf16 v[132:135], v[60:63], v[16:19], v[132:135]
    ds_read_b128 v[16:19], v1 offset:4096
    v_mfma_f32_16x16x32_bf16 v[148:151], v[20:23], v[52:55], v[148:151]
    v_mfma_f32_16x16x32_bf16 v[152:155], v[56:59], v[20:23], v[152:155]
    v_mfma_f32_16x16x32_bf16 v[156:159], v[60:63], v[20:23], v[156:159]
    ds_read_b128 v[20:23], v1 offset:6144
    v_mfma_f32_16x16x32_bf16 v[172:175], v[24:27], v[52:55], v[172:175]
    v_mfma_f32_16x16x32_bf16 v[176:179], v[56:59], v[24:27], v[176:179]
    v_mfma_f32_16x16x32_bf16 v[180:183], v[60:63], v[24:27], v[180:183]
    ds_read_b128 v[24:27], v1 offset:8192
    v_mfma_f32_16x16x32_bf16 v[196:199], v[28:31], v[52:55], v[196:199]
    v_mfma_f32_16x16x32_bf16 v[200:203], v[56:59], v[28:31], v[200:203]
    v_mfma_f32_16x16x32_bf16 v[204:207], v[60:63], v[28:31], v[204:207]
    ds_read_b128 v[28:31], v1 offset:10240
    v_mfma_f32_16x16x32_bf16 v[220:223], v[32:35], v[52:55], v[220:223]
    s_sub_u32 s72, s72, 1
    v_mfma_f32_16x16x32_bf16 v[224:227], v[56:59], v[32:35], v[224:227]
    s_cmp_lg_u32 s72, 0
    v_mfma_f32_16x16x32_bf16 v[228:231], v[60:63], v[32:35], v[228:231]
    ds_read_b128 v[32:35], v1 offset:12288
    v_mfma_f32_16x16x32_bf16 v[244:247], v[36:39], v[52:55], v[244:247]
    v_mfma_f32_16x16x32_bf16 v[248:251], v[56:59], v[36:39], v[248:251]
    v_mfma_f32_16x16x32_bf16 v[252:255], v[60:63], v[36:39], v[252:255]
    ds_read_b128 v[36:39], v1 offset:14336
    s_cbranch_scc1 L_cloop
    v_mbcnt_lo_u32_b32 v0, -1, 0
    v_mbcnt_hi_u32_b32 v0, -1, v0
    v_add_u32 v1, 0xffff8000, v1
    v_add_u32 v2, 0xffff8000, v2
    v_add_u32 v3, 0xffffd000, v3
    v_add_u32 v4, 0xffffd000, v4
    s_waitcnt lgkmcnt(4)
    v_mfma_f32_16x16x32_bf16 v[64:67], v[40:43], v[8:11], v[64:67]
    ds_read_b64_tr_b16 v[52:53], v4 offset:14336
    v_mfma_f32_16x16x32_bf16 v[68:71], v[44:47], v[8:11], v[68:71]
    ds_read_b64_tr_b16 v[54:55], v4 offset:14848
    v_mfma_f32_16x16x32_bf16 v[88:91], v[40:43], v[12:15], v[88:91]
    v_mfma_f32_16x16x32_bf16 v[92:95], v[44:47], v[12:15], v[92:95]
    v_mfma_f32_16x16x32_bf16 v[112:115], v[40:43], v[16:19], v[112:115]
    v_mfma_f32_16x16x32_bf16 v[116:119], v[44:47], v[16:19], v[116:119]
    v_add_u32 v56, 0x10000, v1
    v_add_u32 v57, 0x10000, v2
    v_lshrrev_b32 v59, 4, v0
    v_lshlrev_b32 v59, 10, v59
    v_sub_u32 v3, v3, v59
    v_sub_u32 v4, v4, v59
    v_sub_u32 v60, v3, v59
    v_sub_u32 v61, v4, v59
    v_lshlrev_b32 v58, 4, v0
    v_mfma_f32_16x16x32_bf16 v[136:139], v[40:43], v[20:23], v[136:139]
    v_mfma_f32_16x16x32_bf16 v[140:143], v[44:47], v[20:23], v[140:143]
    s_waitcnt lgkmcnt(2)
    v_mfma_f32_16x16x32_bf16 v[160:163], v[40:43], v[24:27], v[160:163]
    v_mfma_f32_16x16x32_bf16 v[164:167], v[44:47], v[24:27], v[164:167]
    v_mfma_f32_16x16x32_bf16 v[184:187], v[40:43], v[28:31], v[184:187]
    v_mfma_f32_16x16x32_bf16 v[188:191], v[44:47], v[28:31], v[188:191]
    v_mfma_f32_16x16x32_bf16 v[208:211], v[40:43], v[32:35], v[208:211]
    v_mfma_f32_16x16x32_bf16 v[212:215], v[44:47], v[32:35], v[212:215]
    v_mfma_f32_16x16x32_bf16 v[232:235], v[40:43], v[36:39], v[232:235]
    v_mfma_f32_16x16x32_bf16 v[236:239], v[44:47], v[36:39], v[236:239]
    s_waitcnt lgkmcnt(0)
    s_barrier
    v_mfma_f32_16x16x32_bf16 v[72:75], v[8:11], v[48:51], v[72:75]
    ds_read_b64_tr_b16 v[40:41], v3 offset:24576
    v_mfma_f32_16x16x32_bf16 v[76:79], v[8:11], v[52:55], v[76:79]
    ds_read_b128 v[8:11], v2 offset:32768
    v_mfma_f32_16x16x32_bf16 v[96:99], v[12:15], v[48:51], v[96:99]
    ds_read_b64_tr_b16 v[42:43], v3 offset:25088
    v_mfma_f32_16x16x32_bf16 v[100:103], v[12:15], v[52:55], v[100:103]
    ds_read_b128 v[12:15], v2 offset:34816
    v_mfma_f32_16x16x32_bf16 v[120:123], v[16:19], v[48:51], v[120:123]
    ds_read_b64_tr_b16 v[44:45], v4 offset:24576
    v_mfma_f32_16x16x32_bf16 v[124:127], v[16:19], v[52:55], v[124:127]
    ds_read_b128 v[16:19], v2 offset:36864
    v_mfma_f32_16x16x32_bf16 v[144:147], v[20:23], v[48:51], v[144:147]
    ds_read_b64_tr_b16 v[46:47], v4 offset:25088
    v_mfma_f32_16x16x32_bf16 v[148:151], v[20:23], v[52:55], v[148:151]
    ds_read_b128 v[20:23], v2 offset:38912
    v_mfma_f32_16x16x32_bf16 v[168:171], v[24:27], v[48:51], v[168:171]
    v_mfma_f32_16x16x32_bf16 v[172:175], v[24:27], v[52:55], v[172:175]
    ds_read_b128 v[24:27], v2 offset:40960
    v_mfma_f32_16x16x32_bf16 v[192:195], v[28:31], v[48:51], v[192:195]
    v_mfma_f32_16x16x32_bf16 v[196:199], v[28:31], v[52:55], v[196:199]
    ds_read_b128 v[28:31], v2 offset:43008
    v_mfma_f32_16x16x32_bf16 v[216:219], v[32:35], v[48:51], v[216:219]
    v_mfma_f32_16x16x32_bf16 v[220:223], v[32:35], v[52:55], v[220:223]
    ds_read_b128 v[32:35], v2 offset:45056
    v_mfma_f32_16x16x32_bf16 v[240:243], v[36:39], v[48:51], v[240:243]
    v_mfma_f32_16x16x32_bf16 v[244:247], v[36:39], v[52:55], v[244:247]
    ds_read_b128 v[36:39], v2 offset:47104
    s_waitcnt lgkmcnt(4)
    v_mfma_f32_16x16x32_bf16 v[64:67], v[40:43], v[8:11], v[64:67]
    ds_read_b64_tr_b16 v[48:49], v3 offset:25600
    v_mfma_f32_16x16x32_bf16 v[68:71], v[44:47], v[8:11], v[68:71]
    ds_read_b64_tr_b16 v[50:51], v3 offset:26112
    v_mfma_f32_16x16x32_bf16 v[88:91], v[40:43], v[12:15], v[88:91]
    ds_read_b64_tr_b16 v[52:53], v4 offset:25600
    v_mfma_f32_16x16x32_bf16 v[92:95], v[44:47], v[12:15], v[92:95]
    ds_read_b64_tr_b16 v[54:55], v4 offset:26112
    v_mfma_f32_16x16x32_bf16 v[112:115], v[40:43], v[16:19], v[112:115]
    v_mfma_f32_16x16x32_bf16 v[116:119], v[44:47], v[16:19], v[116:119]
    v_mfma_f32_16x16x32_bf16 v[136:139], v[40:43], v[20:23], v[136:139]
    v_mfma_f32_16x16x32_bf16 v[140:143], v[44:47], v[20:23], v[140:143]
    s_waitcnt lgkmcnt(4)
    v_mfma_f32_16x16x32_bf16 v[160:163], v[40:43], v[24:27], v[160:163]
    v_mfma_f32_16x16x32_bf16 v[164:167], v[44:47], v[24:27], v[164:167]
    v_mfma_f32_16x16x32_bf16 v[184:187], v[40:43], v[28:31], v[184:187]
    v_mfma_f32_16x16x32_bf16 v[188:191], v[44:47], v[28:31], v[188:191]
    v_mfma_f32_16x16x32_bf16 v[208:211], v[40:43], v[32:35], v[208:211]
    v_mfma_f32_16x16x32_bf16 v[212:215], v[44:47], v[32:35], v[212:215]
    v_mfma_f32_16x16x32_bf16 v[232:235], v[40:43], v[36:39], v[232:235]
    v_mfma_f32_16x16x32_bf16 v[236:239], v[44:47], v[36:39], v[236:239]
    s_waitcnt lgkmcnt(0)
    s_barrier
    v_mfma_f32_16x16x32_bf16 v[72:75], v[8:11], v[48:51], v[72:75]
    ds_read_b64_tr_b16 v[40:41], v3 offset:32768
    v_mfma_f32_16x16x32_bf16 v[76:79], v[8:11], v[52:55], v[76:79]
    ds_read_b128 v[8:11], v56 offset:0
    v_mfma_f32_16x16x32_bf16 v[96:99], v[12:15], v[48:51], v[96:99]
    ds_read_b64_tr_b16 v[42:43], v3 offset:33280
    v_mfma_f32_16x16x32_bf16 v[100:103], v[12:15], v[52:55], v[100:103]
    ds_read_b128 v[12:15], v56 offset:2048
    v_mfma_f32_16x16x32_bf16 v[120:123], v[16:19], v[48:51], v[120:123]
    ds_read_b64_tr_b16 v[44:45], v4 offset:32768
    v_mfma_f32_16x16x32_bf16 v[124:127], v[16:19], v[52:55], v[124:127]
    ds_read_b128 v[16:19], v56 offset:4096
    v_mfma_f32_16x16x32_bf16 v[144:147], v[20:23], v[48:51], v[144:147]
    ds_read_b64_tr_b16 v[46:47], v4 offset:33280
    v_mfma_f32_16x16x32_bf16 v[148:151], v[20:23], v[52:55], v[148:151]
    ds_read_b128 v[20:23], v56 offset:6144
    v_mfma_f32_16x16x32_bf16 v[168:171], v[24:27], v[48:51], v[168:171]
    v_mfma_f32_16x16x32_bf16 v[172:175], v[24:27], v[52:55], v[172:175]
    ds_read_b128 v[24:27], v56 offset:8192
    v_mfma_f32_16x16x32_bf16 v[192:195], v[28:31], v[48:51], v[192:195]
    v_mfma_f32_16x16x32_bf16 v[196:199], v[28:31], v[52:55], v[196:199]
    ds_read_b128 v[28:31], v56 offset:10240
    v_mfma_f32_16x16x32_bf16 v[216:219], v[32:35], v[48:51], v[216:219]
    v_mfma_f32_16x16x32_bf16 v[220:223], v[32:35], v[52:55], v[220:223]
    ds_read_b128 v[32:35], v56 offset:12288
    v_mfma_f32_16x16x32_bf16 v[240:243], v[36:39], v[48:51], v[240:243]
    v_mfma_f32_16x16x32_bf16 v[244:247], v[36:39], v[52:55], v[244:247]
    ds_read_b128 v[36:39], v56 offset:14336
    s_waitcnt lgkmcnt(4)
    v_mfma_f32_16x16x32_bf16 v[64:67], v[40:43], v[8:11], v[64:67]
    ds_read_b64_tr_b16 v[48:49], v3 offset:33792
    v_mfma_f32_16x16x32_bf16 v[68:71], v[44:47], v[8:11], v[68:71]
    ds_read_b64_tr_b16 v[50:51], v3 offset:34304
    v_mfma_f32_16x16x32_bf16 v[88:91], v[40:43], v[12:15], v[88:91]
    ds_read_b64_tr_b16 v[52:53], v4 offset:33792
    v_mfma_f32_16x16x32_bf16 v[92:95], v[44:47], v[12:15], v[92:95]
    ds_read_b64_tr_b16 v[54:55], v4 offset:34304
    v_mfma_f32_16x16x32_bf16 v[112:115], v[40:43], v[16:19], v[112:115]
    v_mfma_f32_16x16x32_bf16 v[116:119], v[44:47], v[16:19], v[116:119]
    v_mfma_f32_16x16x32_bf16 v[136:139], v[40:43], v[20:23], v[136:139]
    v_mfma_f32_16x16x32_bf16 v[140:143], v[44:47], v[20:23], v[140:143]
    s_waitcnt lgkmcnt(4)
    v_mfma_f32_16x16x32_bf16 v[160:163], v[40:43], v[24:27], v[160:163]
    v_mfma_f32_16x16x32_bf16 v[164:167], v[44:47], v[24:27], v[164:167]
    v_mfma_f32_16x16x32_bf16 v[184:187], v[40:43], v[28:31], v[184:187]
    v_mfma_f32_16x16x32_bf16 v[188:191], v[44:47], v[28:31], v[188:191]
    v_mfma_f32_16x16x32_bf16 v[208:211], v[40:43], v[32:35], v[208:211]
    v_mfma_f32_16x16x32_bf16 v[212:215], v[44:47], v[32:35], v[212:215]
    v_mfma_f32_16x16x32_bf16 v[232:235], v[40:43], v[36:39], v[232:235]
    v_mfma_f32_16x16x32_bf16 v[236:239], v[44:47], v[36:39], v[236:239]
    s_waitcnt lgkmcnt(0)
    s_barrier
    v_mfma_f32_16x16x32_bf16 v[72:75], v[8:11], v[48:51], v[72:75]
    ds_read_b64_tr_b16 v[40:41], v3 offset:40960
    v_mfma_f32_16x16x32_bf16 v[76:79], v[8:11], v[52:55], v[76:79]
    ds_read_b128 v[8:11], v57 offset:0
    v_mfma_f32_16x16x32_bf16 v[96:99], v[12:15], v[48:51], v[96:99]
    ds_read_b64_tr_b16 v[42:43], v3 offset:41472
    v_mfma_f32_16x16x32_bf16 v[100:103], v[12:15], v[52:55], v[100:103]
    ds_read_b128 v[12:15], v57 offset:2048
    v_mfma_f32_16x16x32_bf16 v[120:123], v[16:19], v[48:51], v[120:123]
    ds_read_b64_tr_b16 v[44:45], v4 offset:40960
    v_mfma_f32_16x16x32_bf16 v[124:127], v[16:19], v[52:55], v[124:127]
    ds_read_b128 v[16:19], v57 offset:4096
    v_mfma_f32_16x16x32_bf16 v[144:147], v[20:23], v[48:51], v[144:147]
    ds_read_b64_tr_b16 v[46:47], v4 offset:41472
    v_mfma_f32_16x16x32_bf16 v[148:151], v[20:23], v[52:55], v[148:151]
    ds_read_b128 v[20:23], v57 offset:6144
    v_mfma_f32_16x16x32_bf16 v[168:171], v[24:27], v[48:51], v[168:171]
    v_mfma_f32_16x16x32_bf16 v[172:175], v[24:27], v[52:55], v[172:175]
    ds_read_b128 v[24:27], v57 offset:8192
    v_mfma_f32_16x16x32_bf16 v[192:195], v[28:31], v[48:51], v[192:195]
    v_mfma_f32_16x16x32_bf16 v[196:199], v[28:31], v[52:55], v[196:199]
    ds_read_b128 v[28:31], v57 offset:10240
    v_mfma_f32_16x16x32_bf16 v[216:219], v[32:35], v[48:51], v[216:219]
    v_mfma_f32_16x16x32_bf16 v[220:223], v[32:35], v[52:55], v[220:223]
    ds_read_b128 v[32:35], v57 offset:12288
    v_mfma_f32_16x16x32_bf16 v[240:243], v[36:39], v[48:51], v[240:243]
    v_mfma_f32_16x16x32_bf16 v[244:247], v[36:39], v[52:55], v[244:247]
    ds_read_b128 v[36:39], v57 offset:14336
    s_waitcnt lgkmcnt(4)
    v_mfma_f32_16x16x32_bf16 v[64:67], v[40:43], v[8:11], v[64:67]
    ds_read_b64_tr_b16 v[48:49], v3 offset:41984
    v_mfma_f32_16x16x32_bf16 v[68:71], v[44:47], v[8:11], v[68:71]
    ds_read_b64_tr_b16 v[50:51], v3 offset:42496
    v_mfma_f32_16x16x32_bf16 v[88:91], v[40:43], v[12:15], v[88:91]
    ds_read_b64_tr_b16 v[52:53], v4 offset:41984
    v_mfma_f32_16x16x32_bf16 v[92:95], v[44:47], v[12:15], v[92:95]
    ds_read_b64_tr_b16 v[54:55], v4 offset:42496
    v_mfma_f32_16x16x32_bf16 v[112:115], v[40:43], v[16:19], v[112:115]
    v_mfma_f32_16x16x32_bf16 v[116:119], v[44:47], v[16:19], v[116:119]
    v_mfma_f32_16x16x32_bf16 v[136:139], v[40:43], v[20:23], v[136:139]
    v_mfma_f32_16x16x32_bf16 v[140:143], v[44:47], v[20:23], v[140:143]
    s_waitcnt lgkmcnt(4)
    v_mfma_f32_16x16x32_bf16 v[160:163], v[40:43], v[24:27], v[160:163]
    v_mfma_f32_16x16x32_bf16 v[164:167], v[44:47], v[24:27], v[164:167]
    v_mfma_f32_16x16x32_bf16 v[184:187], v[40:43], v[28:31], v[184:187]
    v_mfma_f32_16x16x32_bf16 v[188:191], v[44:47], v[28:31], v[188:191]
    v_mfma_f32_16x16x32_bf16 v[208:211], v[40:43], v[32:35], v[208:211]
    v_mfma_f32_16x16x32_bf16 v[212:215], v[44:47], v[32:35], v[212:215]
    v_mfma_f32_16x16x32_bf16 v[232:235], v[40:43], v[36:39], v[232:235]
    v_mfma_f32_16x16x32_bf16 v[236:239], v[44:47], v[36:39], v[236:239]
    s_waitcnt lgkmcnt(0)
    s_barrier
    v_mfma_f32_16x16x32_bf16 v[72:75], v[8:11], v[48:51], v[72:75]
    ds_read_b64_tr_b16 v[40:41], v3 offset:49152
    v_mfma_f32_16x16x32_bf16 v[76:79], v[8:11], v[52:55], v[76:79]
    ds_read_b128 v[8:11], v1 offset:0
    v_mfma_f32_16x16x32_bf16 v[96:99], v[12:15], v[48:51], v[96:99]
    ds_read_b64_tr_b16 v[42:43], v3 offset:49664
    v_mfma_f32_16x16x32_bf16 v[100:103], v[12:15], v[52:55], v[100:103]
    ds_read_b128 v[12:15], v1 offset:2048
    v_mfma_f32_16x16x32_bf16 v[120:123], v[16:19], v[48:51], v[120:123]
    ds_read_b64_tr_b16 v[44:45], v4 offset:49152
    v_mfma_f32_16x16x32_bf16 v[124:127], v[16:19], v[52:55], v[124:127]
    ds_read_b128 v[16:19], v1 offset:4096
    v_mfma_f32_16x16x32_bf16 v[144:147], v[20:23], v[48:51], v[144:147]
    ds_read_b64_tr_b16 v[46:47], v4 offset:49664
    v_mfma_f32_16x16x32_bf16 v[148:151], v[20:23], v[52:55], v[148:151]
    ds_read_b128 v[20:23], v1 offset:6144
    v_mfma_f32_16x16x32_bf16 v[168:171], v[24:27], v[48:51], v[168:171]
    v_mfma_f32_16x16x32_bf16 v[172:175], v[24:27], v[52:55], v[172:175]
    ds_read_b128 v[24:27], v1 offset:8192
    v_mfma_f32_16x16x32_bf16 v[192:195], v[28:31], v[48:51], v[192:195]
    v_mfma_f32_16x16x32_bf16 v[196:199], v[28:31], v[52:55], v[196:199]
    ds_read_b128 v[28:31], v1 offset:10240
    v_mfma_f32_16x16x32_bf16 v[216:219], v[32:35], v[48:51], v[216:219]
    v_mfma_f32_16x16x32_bf16 v[220:223], v[32:35], v[52:55], v[220:223]
    ds_read_b128 v[32:35], v1 offset:12288
    v_mfma_f32_16x16x32_bf16 v[240:243], v[36:39], v[48:51], v[240:243]
    v_mfma_f32_16x16x32_bf16 v[244:247], v[36:39], v[52:55], v[244:247]
    ds_read_b128 v[36:39], v1 offset:14336
    s_waitcnt lgkmcnt(4)
    v_mfma_f32_16x16x32_bf16 v[64:67], v[40:43], v[8:11], v[64:67]
    ds_read_b64_tr_b16 v[48:49], v3 offset:50176
    v_mfma_f32_16x16x32_bf16 v[68:71], v[44:47], v[8:11], v[68:71]
    ds_read_b64_tr_b16 v[50:51], v3 offset:50688
    v_mfma_f32_16x16x32_bf16 v[88:91], v[40:43], v[12:15], v[88:91]
    ds_read_b64_tr_b16 v[52:53], v4 offset:50176
    v_mfma_f32_16x16x32_bf16 v[92:95], v[44:47], v[12:15], v[92:95]
    ds_read_b64_tr_b16 v[54:55], v4 offset:50688
    v_mfma_f32_16x16x32_bf16 v[112:115], v[40:43], v[16:19], v[112:115]
    v_mfma_f32_16x16x32_bf16 v[116:119], v[44:47], v[16:19], v[116:119]
    v_mfma_f32_16x16x32_bf16 v[136:139], v[40:43], v[20:23], v[136:139]
    v_mfma_f32_16x16x32_bf16 v[140:143], v[44:47], v[20:23], v[140:143]
    s_waitcnt lgkmcnt(4)
    v_mfma_f32_16x16x32_bf16 v[160:163], v[40:43], v[24:27], v[160:163]
    v_mfma_f32_16x16x32_bf16 v[164:167], v[44:47], v[24:27], v[164:167]
    v_mfma_f32_16x16x32_bf16 v[184:187], v[40:43], v[28:31], v[184:187]
    v_mfma_f32_16x16x32_bf16 v[188:191], v[44:47], v[28:31], v[188:191]
    v_mfma_f32_16x16x32_bf16 v[208:211], v[40:43], v[32:35], v[208:211]
    v_mfma_f32_16x16x32_bf16 v[212:215], v[44:47], v[32:35], v[212:215]
    v_mfma_f32_16x16x32_bf16 v[232:235], v[40:43], v[36:39], v[232:235]
    v_mfma_f32_16x16x32_bf16 v[236:239], v[44:47], v[36:39], v[236:239]
    s_waitcnt lgkmcnt(0)
    s_barrier
    v_mfma_f32_16x16x32_bf16 v[72:75], v[8:11], v[48:51], v[72:75]
    ds_read_b64_tr_b16 v[40:41], v3 offset:0
    v_mfma_f32_16x16x32_bf16 v[76:79], v[8:11], v[52:55], v[76:79]
    ds_read_b128 v[8:11], v2 offset:0
    v_mfma_f32_16x16x32_bf16 v[96:99], v[12:15], v[48:51], v[96:99]
    ds_read_b64_tr_b16 v[42:43], v3 offset:512
    v_mfma_f32_16x16x32_bf16 v[100:103], v[12:15], v[52:55], v[100:103]
    ds_read_b128 v[12:15], v2 offset:2048
    v_mfma_f32_16x16x32_bf16 v[120:123], v[16:19], v[48:51], v[120:123]
    ds_read_b64_tr_b16 v[44:45], v4 offset:0
    v_mfma_f32_16x16x32_bf16 v[124:127], v[16:19], v[52:55], v[124:127]
    ds_read_b128 v[16:19], v2 offset:4096
    v_mfma_f32_16x16x32_bf16 v[144:147], v[20:23], v[48:51], v[144:147]
    ds_read_b64_tr_b16 v[46:47], v4 offset:512
    v_mfma_f32_16x16x32_bf16 v[148:151], v[20:23], v[52:55], v[148:151]
    ds_read_b128 v[20:23], v2 offset:6144
    v_mfma_f32_16x16x32_bf16 v[168:171], v[24:27], v[48:51], v[168:171]
    v_mfma_f32_16x16x32_bf16 v[172:175], v[24:27], v[52:55], v[172:175]
    ds_read_b128 v[24:27], v2 offset:8192
    v_mfma_f32_16x16x32_bf16 v[192:195], v[28:31], v[48:51], v[192:195]
    v_mfma_f32_16x16x32_bf16 v[196:199], v[28:31], v[52:55], v[196:199]
    ds_read_b128 v[28:31], v2 offset:10240
    v_mfma_f32_16x16x32_bf16 v[216:219], v[32:35], v[48:51], v[216:219]
    v_mfma_f32_16x16x32_bf16 v[220:223], v[32:35], v[52:55], v[220:223]
    ds_read_b128 v[32:35], v2 offset:12288
    v_mfma_f32_16x16x32_bf16 v[240:243], v[36:39], v[48:51], v[240:243]
    v_mfma_f32_16x16x32_bf16 v[244:247], v[36:39], v[52:55], v[244:247]
    ds_read_b128 v[36:39], v2 offset:14336
    s_waitcnt lgkmcnt(4)
    v_mfma_f32_16x16x32_bf16 v[64:67], v[40:43], v[8:11], v[64:67]
    ds_read_b64_tr_b16 v[48:49], v3 offset:1024
    v_mfma_f32_16x16x32_bf16 v[68:71], v[44:47], v[8:11], v[68:71]
    ds_read_b64_tr_b16 v[50:51], v3 offset:1536
    v_mfma_f32_16x16x32_bf16 v[88:91], v[40:43], v[12:15], v[88:91]
    ds_read_b64_tr_b16 v[52:53], v4 offset:1024
    v_mfma_f32_16x16x32_bf16 v[92:95], v[44:47], v[12:15], v[92:95]
    ds_read_b64_tr_b16 v[54:55], v4 offset:1536
    v_mfma_f32_16x16x32_bf16 v[112:115], v[40:43], v[16:19], v[112:115]
    v_mfma_f32_16x16x32_bf16 v[116:119], v[44:47], v[16:19], v[116:119]
    v_mfma_f32_16x16x32_bf16 v[136:139], v[40:43], v[20:23], v[136:139]
    v_mfma_f32_16x16x32_bf16 v[140:143], v[44:47], v[20:23], v[140:143]
    s_waitcnt lgkmcnt(4)
    v_mfma_f32_16x16x32_bf16 v[160:163], v[40:43], v[24:27], v[160:163]
    v_mfma_f32_16x16x32_bf16 v[164:167], v[44:47], v[24:27], v[164:167]
    v_mfma_f32_16x16x32_bf16 v[184:187], v[40:43], v[28:31], v[184:187]
    v_mfma_f32_16x16x32_bf16 v[188:191], v[44:47], v[28:31], v[188:191]
    v_mfma_f32_16x16x32_bf16 v[208:211], v[40:43], v[32:35], v[208:211]
    v_mfma_f32_16x16x32_bf16 v[212:215], v[44:47], v[32:35], v[212:215]
    v_mfma_f32_16x16x32_bf16 v[232:235], v[40:43], v[36:39], v[232:235]
    v_mfma_f32_16x16x32_bf16 v[236:239], v[44:47], v[36:39], v[236:239]
    s_waitcnt lgkmcnt(0)
    s_barrier
    s_cmp_eq_u32 s73, 1
    s_cbranch_scc1 L_q1
    v_mfma_f32_16x16x32_bf16 v[72:75], v[8:11], v[48:51], v[72:75]
    ds_read_b64_tr_b16 v[40:41], v60 offset:32768
    s_add_u32 s68, s78, 0
    s_lshl_b32 s71, s74, 14
    v_mfma_f32_16x16x32_bf16 v[76:79], v[8:11], v[52:55], v[76:79]
    s_add_u32 s71, s71, 0
    v_add_u32 v59, s71, v58
    ds_read_b128 v[8:11], v1 offset:0
    v_mfma_f32_16x16x32_bf16 v[96:99], v[12:15], v[48:51], v[96:99]
    ds_read_b64_tr_b16 v[42:43], v60 offset:33280
    v_add_u32 v62, 98304, v59
    v_cvt_pk_bf16_f32 v64, v64, v65
    v_mfma_f32_16x16x32_bf16 v[100:103], v[12:15], v[52:55], v[100:103]
    v_cvt_pk_bf16_f32 v65, v66, v67
    v_cvt_pk_bf16_f32 v66, v88, v89
    ds_read_b128 v[12:15], v1 offset:2048
    v_mfma_f32_16x16x32_bf16 v[120:123], v[16:19], v[48:51], v[120:123]
    ds_read_b64_tr_b16 v[44:45], v61 offset:32768
    v_cvt_pk_bf16_f32 v67, v90, v91
    v_cvt_pk_bf16_f32 v68, v68, v69
    v_mfma_f32_16x16x32_bf16 v[124:127], v[16:19], v[52:55], v[124:127]
    v_cvt_pk_bf16_f32 v69, v70, v71
    v_cvt_pk_bf16_f32 v70, v92, v93
    ds_read_b128 v[16:19], v1 offset:4096
    v_mfma_f32_16x16x32_bf16 v[144:147], v[20:23], v[48:51], v[144:147]
    ds_read_b64_tr_b16 v[46:47], v61 offset:33280
    v_cvt_pk_bf16_f32 v71, v94, v95
    v_permlane16_swap_b32 v64, v66
    v_mfma_f32_16x16x32_bf16 v[148:151], v[20:23], v[52:55], v[148:151]
    v_permlane16_swap_b32 v65, v67
    v_cvt_pk_bf16_f32 v112, v112, v113
    ds_write_b128 v62, v[64:67] offset:0
    ds_read_b128 v[20:23], v1 offset:6144
    v_mfma_f32_16x16x32_bf16 v[168:171], v[24:27], v[48:51], v[168:171]
    v_cvt_pk_bf16_f32 v113, v114, v115
    v_cvt_pk_bf16_f32 v114, v136, v137
    v_mfma_f32_16x16x32_bf16 v[172:175], v[24:27], v[52:55], v[172:175]
    v_cvt_pk_bf16_f32 v115, v138, v139
    v_permlane16_swap_b32 v68, v70
    ds_read_b128 v[24:27], v1 offset:8192
    v_mfma_f32_16x16x32_bf16 v[192:195], v[28:31], v[48:51], v[192:195]
    v_permlane16_swap_b32 v69, v71
    v_cvt_pk_bf16_f32 v116, v116, v117
    v_mfma_f32_16x16x32_bf16 v[196:199], v[28:31], v[52:55], v[196:199]
    v_cvt_pk_bf16_f32 v117, v118, v119
    v_cvt_pk_bf16_f32 v118, v140, v141
    ds_write_b128 v62, v[68:71] offset:1024
    ds_read_b128 v[28:31], v1 offset:10240
    v_mfma_f32_16x16x32_bf16 v[216:219], v[32:35], v[48:51], v[216:219]
    v_cvt_pk_bf16_f32 v119, v142, v143
    v_permlane16_swap_b32 v112, v114
    v_mfma_f32_16x16x32_bf16 v[220:223], v[32:35], v[52:55], v[220:223]
    v_permlane16_swap_b32 v113, v115
    v_cvt_pk_bf16_f32 v160, v160, v161
    ds_write_b128 v62, v[112:115] offset:2048
    ds_read_b128 v[32:35], v1 offset:12288
    v_mfma_f32_16x16x32_bf16 v[240:243], v[36:39], v[48:51], v[240:243]
    v_cvt_pk_bf16_f32 v161, v162, v163
    v_cvt_pk_bf16_f32 v162, v184, v185
    v_mfma_f32_16x16x32_bf16 v[244:247], v[36:39], v[52:55], v[244:247]
    v_cvt_pk_bf16_f32 v163, v186, v187
    v_permlane16_swap_b32 v116, v118
    ds_read_b128 v[36:39], v1 offset:14336
    s_waitcnt lgkmcnt(6)
    v_mfma_f32_16x16x32_bf16 v[80:83], v[40:43], v[8:11], v[80:83]
    ds_read_b64_tr_b16 v[48:49], v60 offset:36864
    v_permlane16_swap_b32 v117, v119
    v_cvt_pk_bf16_f32 v164, v164, v165
    v_mfma_f32_16x16x32_bf16 v[84:87], v[44:47], v[8:11], v[84:87]
    ds_read_b64_tr_b16 v[50:51], v60 offset:37376
    v_cvt_pk_bf16_f32 v165, v166, v167
    v_cvt_pk_bf16_f32 v166, v188, v189
    ds_write_b128 v62, v[116:119] offset:3072
    ds_read_b128 v[8:11], v2 offset:0
    v_mfma_f32_16x16x32_bf16 v[104:107], v[40:43], v[12:15], v[104:107]
    ds_read_b64_tr_b16 v[52:53], v61 offset:36864
    v_cvt_pk_bf16_f32 v167, v190, v191
    v_permlane16_swap_b32 v160, v162
    v_mfma_f32_16x16x32_bf16 v[108:111], v[44:47], v[12:15], v[108:111]
    ds_read_b64_tr_b16 v[54:55], v61 offset:37376
    v_permlane16_swap_b32 v161, v163
    v_cvt_pk_bf16_f32 v208, v208, v209
    ds_write_b128 v62, v[160:163] offset:4096
    ds_read_b128 v[12:15], v2 offset:2048
    v_mfma_f32_16x16x32_bf16 v[128:131], v[40:43], v[16:19], v[128:131]
    v_cvt_pk_bf16_f32 v209, v210, v211
    v_cvt_pk_bf16_f32 v210, v232, v233
    v_mfma_f32_16x16x32_bf16 v[132:135], v[44:47], v[16:19], v[132:135]
    v_cvt_pk_bf16_f32 v211, v234, v235
    v_permlane16_swap_b32 v164, v166
    ds_read_b128 v[16:19], v2 offset:4096
    v_mfma_f32_16x16x32_bf16 v[152:155], v[40:43], v[20:23], v[152:155]
    v_permlane16_swap_b32 v165, v167
    v_cvt_pk_bf16_f32 v212, v212, v213
    v_mfma_f32_16x16x32_bf16 v[156:159], v[44:47], v[20:23], v[156:159]
    v_cvt_pk_bf16_f32 v213, v214, v215
    v_cvt_pk_bf16_f32 v214, v236, v237
    ds_write_b128 v62, v[164:167] offset:5120
    ds_read_b128 v[20:23], v2 offset:6144
    s_waitcnt lgkmcnt(11)
    v_mfma_f32_16x16x32_bf16 v[176:179], v[40:43], v[24:27], v[176:179]
    v_cvt_pk_bf16_f32 v215, v238, v239
    v_permlane16_swap_b32 v208, v210
    v_mfma_f32_16x16x32_bf16 v[180:183], v[44:47], v[24:27], v[180:183]
    v_permlane16_swap_b32 v209, v211
    v_cvt_pk_bf16_f32 v72, v72, v73
    ds_write_b128 v62, v[208:211] offset:6144
    ds_read_b128 v[24:27], v2 offset:8192
    v_mfma_f32_16x16x32_bf16 v[200:203], v[40:43], v[28:31], v[200:203]
    v_cvt_pk_bf16_f32 v73, v74, v75
    v_cvt_pk_bf16_f32 v74, v76, v77
    v_mfma_f32_16x16x32_bf16 v[204:207], v[44:47], v[28:31], v[204:207]
    v_cvt_pk_bf16_f32 v75, v78, v79
    v_permlane16_swap_b32 v212, v214
    ds_read_b128 v[28:31], v2 offset:10240
    v_mfma_f32_16x16x32_bf16 v[224:227], v[40:43], v[32:35], v[224:227]
    v_permlane16_swap_b32 v213, v215
    v_cvt_pk_bf16_f32 v76, v96, v97
    v_mfma_f32_16x16x32_bf16 v[228:231], v[44:47], v[32:35], v[228:231]
    v_cvt_pk_bf16_f32 v77, v98, v99
    v_cvt_pk_bf16_f32 v78, v100, v101
    ds_write_b128 v62, v[212:215] offset:7168
    ds_read_b128 v[32:35], v2 offset:12288
    v_mfma_f32_16x16x32_bf16 v[248:251], v[40:43], v[36:39], v[248:251]
    v_cvt_pk_bf16_f32 v79, v102, v103
    v_permlane16_swap_b32 v72, v74
    v_mfma_f32_16x16x32_bf16 v[252:255], v[44:47], v[36:39], v[252:255]
    v_permlane16_swap_b32 v73, v75
    v_cvt_pk_bf16_f32 v120, v120, v121
    ds_read_b128 v[36:39], v2 offset:14336
    s_barrier
    s_waitcnt lgkmcnt(6)
    v_mfma_f32_16x16x32_bf16 v[80:83], v[48:51], v[8:11], v[80:83]
    ds_read_b64_tr_b16 v[40:41], v60 offset:40960
    v_cvt_pk_bf16_f32 v121, v122, v123
    v_cvt_pk_bf16_f32 v122, v124, v125
    v_mfma_f32_16x16x32_bf16 v[84:87], v[52:55], v[8:11], v[84:87]
    ds_read_b64_tr_b16 v[42:43], v60 offset:41472
    v_cvt_pk_bf16_f32 v123, v126, v127
    v_permlane16_swap_b32 v76, v78
    ds_read_b128 v[8:11], v56 offset:0
    v_mfma_f32_16x16x32_bf16 v[104:107], v[48:51], v[12:15], v[104:107]
    ds_read_b64_tr_b16 v[44:45], v61 offset:40960
    v_permlane16_swap_b32 v77, v79
    v_cvt_pk_bf16_f32 v124, v144, v145
    v_mfma_f32_16x16x32_bf16 v[108:111], v[52:55], v[12:15], v[108:111]
    ds_read_b64_tr_b16 v[46:47], v61 offset:41472
    v_cvt_pk_bf16_f32 v125, v146, v147
    v_cvt_pk_bf16_f32 v126, v148, v149
    ds_read_b128 v[12:15], v56 offset:2048
    v_mfma_f32_16x16x32_bf16 v[128:131], v[48:51], v[16:19], v[128:131]
    v_cvt_pk_bf16_f32 v127, v150, v151
    v_permlane16_swap_b32 v120, v122
    v_mfma_f32_16x16x32_bf16 v[132:135], v[52:55], v[16:19], v[132:135]
    v_permlane16_swap_b32 v121, v123
    v_cvt_pk_bf16_f32 v168, v168, v169
    ds_read_b128 v[16:19], v56 offset:4096
    v_mfma_f32_16x16x32_bf16 v[152:155], v[48:51], v[20:23], v[152:155]
    v_cvt_pk_bf16_f32 v169, v170, v171
    v_cvt_pk_bf16_f32 v170, v172, v173
    v_mfma_f32_16x16x32_bf16 v[156:159], v[52:55], v[20:23], v[156:159]
    v_cvt_pk_bf16_f32 v171, v174, v175
    v_permlane16_swap_b32 v124, v126
    ds_read_b128 v[20:23], v56 offset:6144
    s_waitcnt lgkmcnt(8)
    v_mfma_f32_16x16x32_bf16 v[176:179], v[48:51], v[24:27], v[176:179]
    v_permlane16_swap_b32 v125, v127
    v_cvt_pk_bf16_f32 v172, v192, v193
    v_mfma_f32_16x16x32_bf16 v[180:183], v[52:55], v[24:27], v[180:183]
    v_cvt_pk_bf16_f32 v173, v194, v195
    v_cvt_pk_bf16_f32 v174, v196, v197
    ds_read_b128 v[24:27], v56 offset:8192
    v_mfma_f32_16x16x32_bf16 v[200:203], v[48:51], v[28:31], v[200:203]
    v_cvt_pk_bf16_f32 v175, v198, v199
    v_permlane16_swap_b32 v168, v170
    v_mfma_f32_16x16x32_bf16 v[204:207], v[52:55], v[28:31], v[204:207]
    v_permlane16_swap_b32 v169, v171
    v_cvt_pk_bf16_f32 v216, v216, v217
    ds_read_b128 v[28:31], v56 offset:10240
    v_mfma_f32_16x16x32_bf16 v[224:227], v[48:51], v[32:35], v[224:227]
    v_cvt_pk_bf16_f32 v217, v218, v219
    v_cvt_pk_bf16_f32 v218, v220, v221
    v_mfma_f32_16x16x32_bf16 v[228:231], v[52:55], v[32:35], v[228:231]
    v_cvt_pk_bf16_f32 v219, v222, v223
    v_permlane16_swap_b32 v172, v174
    ds_read_b128 v[32:35], v56 offset:12288
    v_mfma_f32_16x16x32_bf16 v[248:251], v[48:51], v[36:39], v[248:251]
    v_permlane16_swap_b32 v173, v175
    v_cvt_pk_bf16_f32 v220, v240, v241
    v_mfma_f32_16x16x32_bf16 v[252:255], v[52:55], v[36:39], v[252:255]
    v_cvt_pk_bf16_f32 v221, v242, v243
    v_cvt_pk_bf16_f32 v222, v244, v245
    ds_read_b128 v[36:39], v56 offset:14336
    s_waitcnt lgkmcnt(4)
    v_mfma_f32_16x16x32_bf16 v[80:83], v[40:43], v[8:11], v[80:83]
    ds_read_b64_tr_b16 v[48:49], v60 offset:45056
    v_cvt_pk_bf16_f32 v223, v246, v247
    v_permlane16_swap_b32 v216, v218
    v_mfma_f32_16x16x32_bf16 v[84:87], v[44:47], v[8:11], v[84:87]
    ds_read_b64_tr_b16 v[50:51], v60 offset:45568
    v_permlane16_swap_b32 v217, v219
    s_nop 1
    ds_read_b128 v[8:11], v57 offset:0
    v_mfma_f32_16x16x32_bf16 v[104:107], v[40:43], v[12:15], v[104:107]
    ds_read_b64_tr_b16 v[52:53], v61 offset:45056
    v_permlane16_swap_b32 v220, v222
    v_permlane16_swap_b32 v221, v223
    v_mfma_f32_16x16x32_bf16 v[108:111], v[44:47], v[12:15], v[108:111]
    ds_read_b64_tr_b16 v[54:55], v61 offset:45568
    s_mov_b32 s84, 1048744942
    s_mov_b32 s85, 1048744942
    ds_read_b128 v[12:15], v57 offset:2048
    v_mfma_f32_16x16x32_bf16 v[128:131], v[40:43], v[16:19], v[128:131]
    v_add_u32 v63, 155648, v58
    v_and_b32 v192, 0x33, v0
    v_mfma_f32_16x16x32_bf16 v[132:135], v[44:47], v[16:19], v[132:135]
    v_bfe_u32 v193, v0, 2, 1
    v_lshl_or_b32 v192, v193, 3, v192
    ds_read_b128 v[16:19], v57 offset:4096
    v_mfma_f32_16x16x32_bf16 v[152:155], v[40:43], v[20:23], v[152:155]
    v_bfe_u32 v193, v0, 3, 1
    v_lshl_or_b32 v192, v193, 2, v192
    v_mfma_f32_16x16x32_bf16 v[156:159], v[44:47], v[20:23], v[156:159]
    s_lshl_b32 s64, s74, 14
    v_lshlrev_b32 v190, 4, v192
    s_add_u32 s67, s68, 0
    buffer_store_dwordx4 v[64:67], v58, s[44:47], s67 offen offset:0 sc1
    ds_read_b128 v[20:23], v57 offset:6144
    s_waitcnt lgkmcnt(8)
    v_mfma_f32_16x16x32_bf16 v[176:179], v[40:43], v[24:27], v[176:179]
    v_add_u32 v191, s64, v58
    s_add_u32 s64, s64, 98304
    v_mfma_f32_16x16x32_bf16 v[180:183], v[44:47], v[24:27], v[180:183]
    v_add_u32 v190, s64, v190
    s_lshl_b32 s64, s74, 14
    ds_read_b128 v[24:27], v57 offset:8192
    v_mfma_f32_16x16x32_bf16 v[200:203], v[40:43], v[28:31], v[200:203]
    s_add_u32 s65, s64, 0xffff0000
    v_add_u32 v196, s65, v190
    v_mfma_f32_16x16x32_bf16 v[204:207], v[44:47], v[28:31], v[204:207]
    s_add_u32 s65, s64, 34816
    v_add_u32 v197, s65, v191
    s_add_u32 s67, s68, 0
    buffer_store_dwordx4 v[68:71], v58, s[44:47], s67 offen offset:1024 sc1
    ds_read_b128 v[28:31], v57 offset:10240
    v_mfma_f32_16x16x32_bf16 v[224:227], v[40:43], v[32:35], v[224:227]
    s_add_u32 s65, s64, 131072
    v_mov_b32 v198, s65
    v_mfma_f32_16x16x32_bf16 v[228:231], v[44:47], v[32:35], v[228:231]
    v_lshrrev_b32 v192, 2, v0
    v_lshrrev_b32 v193, 4, v0
    ds_read_b128 v[32:35], v57 offset:12288
    v_mfma_f32_16x16x32_bf16 v[248:251], v[40:43], v[36:39], v[248:251]
    v_xor_b32 v192, v192, v193
    v_and_b32 v192, 1, v192
    v_mfma_f32_16x16x32_bf16 v[252:255], v[44:47], v[36:39], v[252:255]
    v_subrev_u32 v192, 1, v192
    v_and_b32 v184, 0x3f803f80, v192
    s_add_u32 s67, s68, 4096
    buffer_store_dwordx4 v[112:115], v58, s[44:47], s67 offen offset:0 sc1
    ds_read_b128 v[36:39], v57 offset:14336
    s_barrier
    s_waitcnt lgkmcnt(4)
    v_mfma_f32_16x16x32_bf16 v[80:83], v[48:51], v[8:11], v[80:83]
    ds_read_b64_tr_b16 v[40:41], v60 offset:49152
    v_mov_b32 v185, v184
    v_mov_b32 v186, v184
    v_mfma_f32_16x16x32_bf16 v[84:87], v[52:55], v[8:11], v[84:87]
    ds_read_b64_tr_b16 v[42:43], v60 offset:49664
    v_mov_b32 v187, v184
    v_lshrrev_b32 v192, 3, v0
    ds_read_b128 v[8:11], v1 offset:32768
    v_mfma_f32_16x16x32_bf16 v[104:107], v[48:51], v[12:15], v[104:107]
    ds_read_b64_tr_b16 v[44:45], v61 offset:49152
    v_and_b32 v188, 7, v0
    v_bfe_u32 v189, v0, 4, 2
    v_mfma_f32_16x16x32_bf16 v[108:111], v[52:55], v[12:15], v[108:111]
    ds_read_b64_tr_b16 v[46:47], v61 offset:49664
    v_lshlrev_b32 v189, 1, v189
    v_xor_b32 v188, v188, v189
    s_add_u32 s67, s68, 4096
    buffer_store_dwordx4 v[116:119], v58, s[44:47], s67 offen offset:1024 sc1
    ds_read_b128 v[12:15], v1 offset:34816
    v_mfma_f32_16x16x32_bf16 v[128:131], v[48:51], v[16:19], v[128:131]
    s_lshr_b32 s64, s63, 2
    s_lshl_b32 s64, s64, 20
    v_mfma_f32_16x16x32_bf16 v[132:135], v[52:55], v[16:19], v[132:135]
    s_and_b32 s65, s63, 3
    s_lshl_b32 s65, s65, 14
    ds_read_b128 v[16:19], v1 offset:36864
    v_mfma_f32_16x16x32_bf16 v[152:155], v[48:51], v[20:23], v[152:155]
    s_add_u32 s64, s64, s65
    s_lshl_b32 s65, s80, 7
    v_mfma_f32_16x16x32_bf16 v[156:159], v[52:55], v[20:23], v[156:159]
    s_add_u32 s64, s64, s65
    v_lshlrev_b32 v192, 11, v192
    s_add_u32 s67, s68, 8192
    buffer_store_dwordx4 v[160:163], v58, s[44:47], s67 offen offset:0 sc1
    ds_read_b128 v[20:23], v1 offset:38912
    s_waitcnt lgkmcnt(8)
    v_mfma_f32_16x16x32_bf16 v[176:179], v[48:51], v[24:27], v[176:179]
    v_add_u32 v192, s64, v192
    v_lshl_add_u32 v188, v188, 4, v192
    v_mfma_f32_16x16x32_bf16 v[180:183], v[52:55], v[24:27], v[180:183]
    v_xor_b32 v195, 0x100000, v188
    s_lshl_b32 s82, s63, 10
    ds_read_b128 v[24:27], v1 offset:40960
    v_mfma_f32_16x16x32_bf16 v[200:203], v[48:51], v[28:31], v[200:203]
    v_and_b32 v189, 15, v0
    v_lshrrev_b32 v192, 5, v0
    v_mfma_f32_16x16x32_bf16 v[204:207], v[52:55], v[28:31], v[204:207]
    v_lshl_add_u32 v189, v192, 4, v189
    v_lshlrev_b32 v189, 4, v189
    s_add_u32 s67, s68, 8192
    buffer_store_dwordx4 v[164:167], v58, s[44:47], s67 offen offset:1024 sc1
    ds_read_b128 v[28:31], v1 offset:43008
    v_mfma_f32_16x16x32_bf16 v[224:227], v[48:51], v[32:35], v[224:227]
    v_bfe_u32 v192, v0, 4, 1
    v_lshl_add_u32 v189, v192, 15, v189
    v_mfma_f32_16x16x32_bf16 v[228:231], v[52:55], v[32:35], v[228:231]
    ds_read_b128 v[32:35], v1 offset:45056
    v_mfma_f32_16x16x32_bf16 v[248:251], v[48:51], v[36:39], v[248:251]
    v_mfma_f32_16x16x32_bf16 v[252:255], v[52:55], v[36:39], v[252:255]
    s_add_u32 s67, s68, 12288
    buffer_store_dwordx4 v[208:211], v58, s[44:47], s67 offen offset:0 sc1
    ds_read_b128 v[36:39], v1 offset:47104
    s_waitcnt lgkmcnt(4)
    v_mfma_f32_16x16x32_bf16 v[80:83], v[40:43], v[8:11], v[80:83]
    ds_read_b64_tr_b16 v[48:49], v60 offset:53248
    ds_read_b128 v[88:91], v63 offset:0
    v_mfma_f32_16x16x32_bf16 v[84:87], v[44:47], v[8:11], v[84:87]
    ds_read_b64_tr_b16 v[50:51], v60 offset:53760
    ds_write_b128 v59, v[72:75] offset:0
    ds_read_b128 v[8:11], v2 offset:32768
    v_mfma_f32_16x16x32_bf16 v[104:107], v[40:43], v[12:15], v[104:107]
    ds_read_b64_tr_b16 v[52:53], v61 offset:53248
    ds_read_b128 v[92:95], v63 offset:1024
    v_mfma_f32_16x16x32_bf16 v[108:111], v[44:47], v[12:15], v[108:111]
    ds_read_b64_tr_b16 v[54:55], v61 offset:53760
    s_add_u32 s67, s68, 12288
    buffer_store_dwordx4 v[212:215], v58, s[44:47], s67 offen offset:1024 sc1
    ds_write_b128 v59, v[76:79] offset:1024
    ds_read_b128 v[12:15], v2 offset:34816
    v_mfma_f32_16x16x32_bf16 v[128:131], v[40:43], v[16:19], v[128:131]
    ds_read_b128 v[96:99], v63 offset:2048
    v_mfma_f32_16x16x32_bf16 v[132:135], v[44:47], v[16:19], v[132:135]
    ds_write_b128 v59, v[120:123] offset:2048
    ds_read_b128 v[16:19], v2 offset:36864
    v_mfma_f32_16x16x32_bf16 v[152:155], v[40:43], v[20:23], v[152:155]
    ds_read_b128 v[100:103], v63 offset:3072
    v_mfma_f32_16x16x32_bf16 v[156:159], v[44:47], v[20:23], v[156:159]
    s_add_u32 s67, s68, 0
    buffer_store_dwordx4 v[72:75], v58, s[44:47], s67 offen offset:2048 sc1
    ds_write_b128 v59, v[124:127] offset:3072
    ds_read_b128 v[20:23], v2 offset:38912
    s_waitcnt lgkmcnt(15)
    v_mfma_f32_16x16x32_bf16 v[176:179], v[40:43], v[24:27], v[176:179]
    ds_read_b128 v[136:139], v63 offset:4096
    v_mfma_f32_16x16x32_bf16 v[180:183], v[44:47], v[24:27], v[180:183]
    ds_write_b128 v59, v[168:171] offset:4096
    ds_read_b128 v[24:27], v2 offset:40960
    v_mfma_f32_16x16x32_bf16 v[200:203], v[40:43], v[28:31], v[200:203]
    ds_read_b128 v[140:143], v63 offset:5120
    v_mfma_f32_16x16x32_bf16 v[204:207], v[44:47], v[28:31], v[204:207]
    s_add_u32 s67, s68, 0
    buffer_store_dwordx4 v[76:79], v58, s[44:47], s67 offen offset:3072 sc1
    ds_write_b128 v59, v[172:175] offset:5120
    ds_read_b128 v[28:31], v2 offset:43008
    v_mfma_f32_16x16x32_bf16 v[224:227], v[40:43], v[32:35], v[224:227]
    ds_read_b128 v[144:147], v63 offset:6144
    v_mfma_f32_16x16x32_bf16 v[228:231], v[44:47], v[32:35], v[228:231]
    ds_write_b128 v59, v[216:219] offset:6144
    ds_read_b128 v[32:35], v2 offset:45056
    v_mfma_f32_16x16x32_bf16 v[248:251], v[40:43], v[36:39], v[248:251]
    ds_read_b128 v[148:151], v63 offset:7168
    v_mfma_f32_16x16x32_bf16 v[252:255], v[44:47], v[36:39], v[252:255]
    s_add_u32 s67, s68, 4096
    buffer_store_dwordx4 v[120:123], v58, s[44:47], s67 offen offset:2048 sc1
    ds_write_b128 v59, v[220:223] offset:7168
    ds_read_b128 v[36:39], v2 offset:47104
    s_waitcnt lgkmcnt(12)
    v_mfma_f32_16x16x32_bf16 v[80:83], v[48:51], v[8:11], v[80:83]
    v_mfma_f32_16x16x32_bf16 v[84:87], v[52:55], v[8:11], v[84:87]
    v_mfma_f32_16x16x32_bf16 v[104:107], v[48:51], v[12:15], v[104:107]
    v_mfma_f32_16x16x32_bf16 v[108:111], v[52:55], v[12:15], v[108:111]
    s_add_u32 s67, s68, 4096
    buffer_store_dwordx4 v[124:127], v58, s[44:47], s67 offen offset:3072 sc1
    v_mfma_f32_16x16x32_bf16 v[128:131], v[48:51], v[16:19], v[128:131]
    v_mfma_f32_16x16x32_bf16 v[132:135], v[52:55], v[16:19], v[132:135]
    v_mfma_f32_16x16x32_bf16 v[152:155], v[48:51], v[20:23], v[152:155]
    v_mfma_f32_16x16x32_bf16 v[156:159], v[52:55], v[20:23], v[156:159]
    s_nop 1
    v_pk_mul_f32 v[80:81], v[80:81], s[84:85]
    v_pk_mul_f32 v[82:83], v[82:83], s[84:85]
    v_pk_mul_f32 v[104:105], v[104:105], s[84:85]
    v_pk_mul_f32 v[106:107], v[106:107], s[84:85]
    v_cvt_pk_bf16_f32 v80, v80, v81
    v_cvt_pk_bf16_f32 v81, v82, v83
    v_cvt_pk_bf16_f32 v82, v104, v105
    v_cvt_pk_bf16_f32 v83, v106, v107
    v_pk_mul_f32 v[84:85], v[84:85], s[84:85]
    v_pk_mul_f32 v[86:87], v[86:87], s[84:85]
    v_pk_mul_f32 v[108:109], v[108:109], s[84:85]
    v_pk_mul_f32 v[110:111], v[110:111], s[84:85]
    v_cvt_pk_bf16_f32 v84, v84, v85
    v_cvt_pk_bf16_f32 v85, v86, v87
    v_cvt_pk_bf16_f32 v86, v108, v109
    v_cvt_pk_bf16_f32 v87, v110, v111
    s_nop 0
    v_permlane16_swap_b32 v80, v82
    v_permlane16_swap_b32 v81, v83
    v_permlane16_swap_b32 v84, v86
    v_permlane16_swap_b32 v85, v87
    s_waitcnt lgkmcnt(0)
    v_mfma_f32_16x16x32_bf16 v[176:179], v[48:51], v[24:27], v[176:179]
    v_mfma_f32_16x16x32_bf16 v[180:183], v[52:55], v[24:27], v[180:183]
    v_mfma_f32_16x16x32_bf16 v[200:203], v[48:51], v[28:31], v[200:203]
    v_mfma_f32_16x16x32_bf16 v[204:207], v[52:55], v[28:31], v[204:207]
    s_nop 1
    v_pk_mul_f32 v[128:129], v[128:129], s[84:85]
    v_pk_mul_f32 v[130:131], v[130:131], s[84:85]
    v_pk_mul_f32 v[152:153], v[152:153], s[84:85]
    v_pk_mul_f32 v[154:155], v[154:155], s[84:85]
    v_cvt_pk_bf16_f32 v128, v128, v129
    v_cvt_pk_bf16_f32 v129, v130, v131
    v_cvt_pk_bf16_f32 v130, v152, v153
    v_cvt_pk_bf16_f32 v131, v154, v155
    v_pk_mul_f32 v[132:133], v[132:133], s[84:85]
    v_pk_mul_f32 v[134:135], v[134:135], s[84:85]
    v_pk_mul_f32 v[156:157], v[156:157], s[84:85]
    v_pk_mul_f32 v[158:159], v[158:159], s[84:85]
    v_cvt_pk_bf16_f32 v132, v132, v133
    v_cvt_pk_bf16_f32 v133, v134, v135
    v_cvt_pk_bf16_f32 v134, v156, v157
    v_cvt_pk_bf16_f32 v135, v158, v159
    s_nop 0
    v_permlane16_swap_b32 v128, v130
    v_permlane16_swap_b32 v129, v131
    v_permlane16_swap_b32 v132, v134
    v_permlane16_swap_b32 v133, v135
    v_mfma_f32_16x16x32_bf16 v[224:227], v[48:51], v[32:35], v[224:227]
    v_mfma_f32_16x16x32_bf16 v[228:231], v[52:55], v[32:35], v[228:231]
    v_mfma_f32_16x16x32_bf16 v[248:251], v[48:51], v[36:39], v[248:251]
    v_mfma_f32_16x16x32_bf16 v[252:255], v[52:55], v[36:39], v[252:255]
    s_nop 1
    v_pk_mul_f32 v[176:177], v[176:177], s[84:85]
    v_pk_mul_f32 v[178:179], v[178:179], s[84:85]
    v_pk_mul_f32 v[200:201], v[200:201], s[84:85]
    v_pk_mul_f32 v[202:203], v[202:203], s[84:85]
    v_cvt_pk_bf16_f32 v176, v176, v177
    v_cvt_pk_bf16_f32 v177, v178, v179
    v_cvt_pk_bf16_f32 v178, v200, v201
    v_cvt_pk_bf16_f32 v179, v202, v203
    v_pk_mul_f32 v[180:181], v[180:181], s[84:85]
    v_pk_mul_f32 v[182:183], v[182:183], s[84:85]
    v_pk_mul_f32 v[204:205], v[204:205], s[84:85]
    v_pk_mul_f32 v[206:207], v[206:207], s[84:85]
    v_cvt_pk_bf16_f32 v180, v180, v181
    v_cvt_pk_bf16_f32 v181, v182, v183
    v_cvt_pk_bf16_f32 v182, v204, v205
    v_cvt_pk_bf16_f32 v183, v206, v207
    s_nop 0
    v_permlane16_swap_b32 v176, v178
    v_permlane16_swap_b32 v177, v179
    v_permlane16_swap_b32 v180, v182
    v_permlane16_swap_b32 v181, v183
    s_waitcnt lgkmcnt(0)
    s_branch L_qe
L_q1:
    v_mfma_f32_16x16x32_bf16 v[72:75], v[8:11], v[48:51], v[72:75]
    ds_read_b64_tr_b16 v[40:41], v60 offset:32768
    s_add_u32 s68, s78, 16384
    s_lshl_b32 s71, s74, 14
    v_mfma_f32_16x16x32_bf16 v[76:79], v[8:11], v[52:55], v[76:79]
    s_add_u32 s71, s71, 8192
    v_add_u32 v59, s71, v58
    ds_read_b128 v[8:11], v1 offset:0
    v_mfma_f32_16x16x32_bf16 v[96:99], v[12:15], v[48:51], v[96:99]
    ds_read_b64_tr_b16 v[42:43], v60 offset:33280
    v_add_u32 v62, 98304, v59
    v_cvt_pk_bf16_f32 v64, v64, v65
    v_mfma_f32_16x16x32_bf16 v[100:103], v[12:15], v[52:55], v[100:103]
    v_cvt_pk_bf16_f32 v65, v66, v67
    v_cvt_pk_bf16_f32 v66, v88, v89
    ds_read_b128 v[12:15], v1 offset:2048
    v_mfma_f32_16x16x32_bf16 v[120:123], v[16:19], v[48:51], v[120:123]
    ds_read_b64_tr_b16 v[44:45], v61 offset:32768
    v_cvt_pk_bf16_f32 v67, v90, v91
    v_cvt_pk_bf16_f32 v68, v68, v69
    v_mfma_f32_16x16x32_bf16 v[124:127], v[16:19], v[52:55], v[124:127]
    v_cvt_pk_bf16_f32 v69, v70, v71
    v_cvt_pk_bf16_f32 v70, v92, v93
    ds_read_b128 v[16:19], v1 offset:4096
    v_mfma_f32_16x16x32_bf16 v[144:147], v[20:23], v[48:51], v[144:147]
    ds_read_b64_tr_b16 v[46:47], v61 offset:33280
    v_cvt_pk_bf16_f32 v71, v94, v95
    v_permlane16_swap_b32 v64, v66
    v_mfma_f32_16x16x32_bf16 v[148:151], v[20:23], v[52:55], v[148:151]
    v_permlane16_swap_b32 v65, v67
    v_cvt_pk_bf16_f32 v112, v112, v113
    ds_write_b128 v62, v[64:67] offset:0
    ds_read_b128 v[20:23], v1 offset:6144
    v_mfma_f32_16x16x32_bf16 v[168:171], v[24:27], v[48:51], v[168:171]
    v_cvt_pk_bf16_f32 v113, v114, v115
    v_cvt_pk_bf16_f32 v114, v136, v137
    v_mfma_f32_16x16x32_bf16 v[172:175], v[24:27], v[52:55], v[172:175]
    v_cvt_pk_bf16_f32 v115, v138, v139
    v_permlane16_swap_b32 v68, v70
    s_add_u32 s67, s68, 0
    buffer_store_dwordx4 v[64:67], v58, s[44:47], s67 offen offset:0 sc1
    ds_read_b128 v[24:27], v1 offset:8192
    v_mfma_f32_16x16x32_bf16 v[192:195], v[28:31], v[48:51], v[192:195]
    v_permlane16_swap_b32 v69, v71
    v_cvt_pk_bf16_f32 v116, v116, v117
    v_mfma_f32_16x16x32_bf16 v[196:199], v[28:31], v[52:55], v[196:199]
    v_cvt_pk_bf16_f32 v117, v118, v119
    v_cvt_pk_bf16_f32 v118, v140, v141
    s_add_u32 s67, s68, 0
    buffer_store_dwordx4 v[68:71], v58, s[44:47], s67 offen offset:1024 sc1
    ds_write_b128 v62, v[68:71] offset:1024
    ds_read_b128 v[28:31], v1 offset:10240
    v_mfma_f32_16x16x32_bf16 v[216:219], v[32:35], v[48:51], v[216:219]
    v_cvt_pk_bf16_f32 v119, v142, v143
    v_permlane16_swap_b32 v112, v114
    v_mfma_f32_16x16x32_bf16 v[220:223], v[32:35], v[52:55], v[220:223]
    v_permlane16_swap_b32 v113, v115
    v_cvt_pk_bf16_f32 v160, v160, v161
    ds_write_b128 v62, v[112:115] offset:2048
    ds_read_b128 v[32:35], v1 offset:12288
    v_mfma_f32_16x16x32_bf16 v[240:243], v[36:39], v[48:51], v[240:243]
    v_cvt_pk_bf16_f32 v161, v162, v163
    v_cvt_pk_bf16_f32 v162, v184, v185
    s_add_u32 s67, s68, 4096
    buffer_store_dwordx4 v[112:115], v58, s[44:47], s67 offen offset:0 sc1
    v_mfma_f32_16x16x32_bf16 v[244:247], v[36:39], v[52:55], v[244:247]
    v_cvt_pk_bf16_f32 v163, v186, v187
    v_permlane16_swap_b32 v116, v118
    ds_read_b128 v[36:39], v1 offset:14336
    s_waitcnt lgkmcnt(6)
    v_mfma_f32_16x16x32_bf16 v[80:83], v[40:43], v[8:11], v[80:83]
    ds_read_b64_tr_b16 v[48:49], v60 offset:36864
    v_permlane16_swap_b32 v117, v119
    v_cvt_pk_bf16_f32 v164, v164, v165
    v_mfma_f32_16x16x32_bf16 v[84:87], v[44:47], v[8:11], v[84:87]
    ds_read_b64_tr_b16 v[50:51], v60 offset:37376
    v_cvt_pk_bf16_f32 v165, v166, v167
    v_cvt_pk_bf16_f32 v166, v188, v189
    s_add_u32 s67, s68, 4096
    buffer_store_dwordx4 v[116:119], v58, s[44:47], s67 offen offset:1024 sc1
    ds_write_b128 v62, v[116:119] offset:3072
    ds_read_b128 v[8:11], v2 offset:0
    v_mfma_f32_16x16x32_bf16 v[104:107], v[40:43], v[12:15], v[104:107]
    ds_read_b64_tr_b16 v[52:53], v61 offset:36864
    v_cvt_pk_bf16_f32 v167, v190, v191
    v_permlane16_swap_b32 v160, v162
    v_mfma_f32_16x16x32_bf16 v[108:111], v[44:47], v[12:15], v[108:111]
    ds_read_b64_tr_b16 v[54:55], v61 offset:37376
    v_permlane16_swap_b32 v161, v163
    v_cvt_pk_bf16_f32 v208, v208, v209
    ds_write_b128 v62, v[160:163] offset:4096
    ds_read_b128 v[12:15], v2 offset:2048
    v_mfma_f32_16x16x32_bf16 v[128:131], v[40:43], v[16:19], v[128:131]
    v_cvt_pk_bf16_f32 v209, v210, v211
    v_cvt_pk_bf16_f32 v210, v232, v233
    s_add_u32 s67, s68, 8192
    buffer_store_dwordx4 v[160:163], v58, s[44:47], s67 offen offset:0 sc1
    v_mfma_f32_16x16x32_bf16 v[132:135], v[44:47], v[16:19], v[132:135]
    v_cvt_pk_bf16_f32 v211, v234, v235
    v_permlane16_swap_b32 v164, v166
    ds_read_b128 v[16:19], v2 offset:4096
    v_mfma_f32_16x16x32_bf16 v[152:155], v[40:43], v[20:23], v[152:155]
    v_permlane16_swap_b32 v165, v167
    v_cvt_pk_bf16_f32 v212, v212, v213
    v_mfma_f32_16x16x32_bf16 v[156:159], v[44:47], v[20:23], v[156:159]
    v_cvt_pk_bf16_f32 v213, v214, v215
    v_cvt_pk_bf16_f32 v214, v236, v237
    s_add_u32 s67, s68, 8192
    buffer_store_dwordx4 v[164:167], v58, s[44:47], s67 offen offset:1024 sc1
    ds_write_b128 v62, v[164:167] offset:5120
    ds_read_b128 v[20:23], v2 offset:6144
    s_waitcnt lgkmcnt(11)
    v_mfma_f32_16x16x32_bf16 v[176:179], v[40:43], v[24:27], v[176:179]
    v_cvt_pk_bf16_f32 v215, v238, v239
    v_permlane16_swap_b32 v208, v210
    v_mfma_f32_16x16x32_bf16 v[180:183], v[44:47], v[24:27], v[180:183]
    v_permlane16_swap_b32 v209, v211
    v_cvt_pk_bf16_f32 v72, v72, v73
    ds_write_b128 v62, v[208:211] offset:6144
    ds_read_b128 v[24:27], v2 offset:8192
    v_mfma_f32_16x16x32_bf16 v[200:203], v[40:43], v[28:31], v[200:203]
    v_cvt_pk_bf16_f32 v73, v74, v75
    v_cvt_pk_bf16_f32 v74, v76, v77
    s_add_u32 s67, s68, 12288
    buffer_store_dwordx4 v[208:211], v58, s[44:47], s67 offen offset:0 sc1
    v_mfma_f32_16x16x32_bf16 v[204:207], v[44:47], v[28:31], v[204:207]
    v_cvt_pk_bf16_f32 v75, v78, v79
    v_permlane16_swap_b32 v212, v214
    ds_read_b128 v[28:31], v2 offset:10240
    v_mfma_f32_16x16x32_bf16 v[224:227], v[40:43], v[32:35], v[224:227]
    v_permlane16_swap_b32 v213, v215
    v_cvt_pk_bf16_f32 v76, v96, v97
    v_mfma_f32_16x16x32_bf16 v[228:231], v[44:47], v[32:35], v[228:231]
    v_cvt_pk_bf16_f32 v77, v98, v99
    v_cvt_pk_bf16_f32 v78, v100, v101
    s_add_u32 s67, s68, 12288
    buffer_store_dwordx4 v[212:215], v58, s[44:47], s67 offen offset:1024 sc1
    ds_write_b128 v62, v[212:215] offset:7168
    ds_read_b128 v[32:35], v2 offset:12288
    v_mfma_f32_16x16x32_bf16 v[248:251], v[40:43], v[36:39], v[248:251]
    v_cvt_pk_bf16_f32 v79, v102, v103
    v_permlane16_swap_b32 v72, v74
    v_mfma_f32_16x16x32_bf16 v[252:255], v[44:47], v[36:39], v[252:255]
    v_permlane16_swap_b32 v73, v75
    v_cvt_pk_bf16_f32 v120, v120, v121
    ds_read_b128 v[36:39], v2 offset:14336
    s_barrier
    s_waitcnt lgkmcnt(6)
    v_mfma_f32_16x16x32_bf16 v[80:83], v[48:51], v[8:11], v[80:83]
    ds_read_b64_tr_b16 v[40:41], v60 offset:40960
    v_cvt_pk_bf16_f32 v121, v122, v123
    v_cvt_pk_bf16_f32 v122, v124, v125
    s_add_u32 s67, s68, 0
    buffer_store_dwordx4 v[72:75], v58, s[44:47], s67 offen offset:2048 sc1
    v_mfma_f32_16x16x32_bf16 v[84:87], v[52:55], v[8:11], v[84:87]
    ds_read_b64_tr_b16 v[42:43], v60 offset:41472
    v_cvt_pk_bf16_f32 v123, v126, v127
    v_permlane16_swap_b32 v76, v78
    ds_read_b128 v[8:11], v56 offset:0
    v_mfma_f32_16x16x32_bf16 v[104:107], v[48:51], v[12:15], v[104:107]
    ds_read_b64_tr_b16 v[44:45], v61 offset:40960
    v_permlane16_swap_b32 v77, v79
    v_cvt_pk_bf16_f32 v124, v144, v145
    s_add_u32 s67, s68, 0
    buffer_store_dwordx4 v[76:79], v58, s[44:47], s67 offen offset:3072 sc1
    v_mfma_f32_16x16x32_bf16 v[108:111], v[52:55], v[12:15], v[108:111]
    ds_read_b64_tr_b16 v[46:47], v61 offset:41472
    v_cvt_pk_bf16_f32 v125, v146, v147
    v_cvt_pk_bf16_f32 v126, v148, v149
    ds_read_b128 v[12:15], v56 offset:2048
    v_mfma_f32_16x16x32_bf16 v[128:131], v[48:51], v[16:19], v[128:131]
    v_cvt_pk_bf16_f32 v127, v150, v151
    v_permlane16_swap_b32 v120, v122
    v_mfma_f32_16x16x32_bf16 v[132:135], v[52:55], v[16:19], v[132:135]
    v_permlane16_swap_b32 v121, v123
    v_cvt_pk_bf16_f32 v168, v168, v169
    s_add_u32 s67, s68, 4096
    buffer_store_dwordx4 v[120:123], v58, s[44:47], s67 offen offset:2048 sc1
    ds_read_b128 v[16:19], v56 offset:4096
    v_mfma_f32_16x16x32_bf16 v[152:155], v[48:51], v[20:23], v[152:155]
    v_cvt_pk_bf16_f32 v169, v170, v171
    v_cvt_pk_bf16_f32 v170, v172, v173
    v_mfma_f32_16x16x32_bf16 v[156:159], v[52:55], v[20:23], v[156:159]
    v_cvt_pk_bf16_f32 v171, v174, v175
    v_permlane16_swap_b32 v124, v126
    ds_read_b128 v[20:23], v56 offset:6144
    s_waitcnt lgkmcnt(8)
    v_mfma_f32_16x16x32_bf16 v[176:179], v[48:51], v[24:27], v[176:179]
    v_permlane16_swap_b32 v125, v127
    v_cvt_pk_bf16_f32 v172, v192, v193
    s_add_u32 s67, s68, 4096
    buffer_store_dwordx4 v[124:127], v58, s[44:47], s67 offen offset:3072 sc1
    v_mfma_f32_16x16x32_bf16 v[180:183], v[52:55], v[24:27], v[180:183]
    v_cvt_pk_bf16_f32 v173, v194, v195
    v_cvt_pk_bf16_f32 v174, v196, v197
    ds_read_b128 v[24:27], v56 offset:8192
    v_mfma_f32_16x16x32_bf16 v[200:203], v[48:51], v[28:31], v[200:203]
    v_cvt_pk_bf16_f32 v175, v198, v199
    v_permlane16_swap_b32 v168, v170
    v_mfma_f32_16x16x32_bf16 v[204:207], v[52:55], v[28:31], v[204:207]
    v_permlane16_swap_b32 v169, v171
    v_cvt_pk_bf16_f32 v216, v216, v217
    s_add_u32 s67, s68, 8192
    buffer_store_dwordx4 v[168:171], v58, s[44:47], s67 offen offset:2048 sc1
    ds_read_b128 v[28:31], v56 offset:10240
    v_mfma_f32_16x16x32_bf16 v[224:227], v[48:51], v[32:35], v[224:227]
    v_cvt_pk_bf16_f32 v217, v218, v219
    v_cvt_pk_bf16_f32 v218, v220, v221
    v_mfma_f32_16x16x32_bf16 v[228:231], v[52:55], v[32:35], v[228:231]
    v_cvt_pk_bf16_f32 v219, v222, v223
    v_permlane16_swap_b32 v172, v174
    ds_read_b128 v[32:35], v56 offset:12288
    v_mfma_f32_16x16x32_bf16 v[248:251], v[48:51], v[36:39], v[248:251]
    v_permlane16_swap_b32 v173, v175
    v_cvt_pk_bf16_f32 v220, v240, v241
    s_add_u32 s67, s68, 8192
    buffer_store_dwordx4 v[172:175], v58, s[44:47], s67 offen offset:3072 sc1
    v_mfma_f32_16x16x32_bf16 v[252:255], v[52:55], v[36:39], v[252:255]
    v_cvt_pk_bf16_f32 v221, v242, v243
    v_cvt_pk_bf16_f32 v222, v244, v245
    ds_read_b128 v[36:39], v56 offset:14336
    s_waitcnt lgkmcnt(4)
    v_mfma_f32_16x16x32_bf16 v[80:83], v[40:43], v[8:11], v[80:83]
    ds_read_b64_tr_b16 v[48:49], v60 offset:45056
    v_cvt_pk_bf16_f32 v223, v246, v247
    v_permlane16_swap_b32 v216, v218
    v_mfma_f32_16x16x32_bf16 v[84:87], v[44:47], v[8:11], v[84:87]
    ds_read_b64_tr_b16 v[50:51], v60 offset:45568
    v_permlane16_swap_b32 v217, v219
    s_nop 1
    s_add_u32 s67, s68, 12288
    buffer_store_dwordx4 v[216:219], v58, s[44:47], s67 offen offset:2048 sc1
    ds_read_b128 v[8:11], v57 offset:0
    v_mfma_f32_16x16x32_bf16 v[104:107], v[40:43], v[12:15], v[104:107]
    ds_read_b64_tr_b16 v[52:53], v61 offset:45056
    v_permlane16_swap_b32 v220, v222
    v_permlane16_swap_b32 v221, v223
    v_mfma_f32_16x16x32_bf16 v[108:111], v[44:47], v[12:15], v[108:111]
    ds_read_b64_tr_b16 v[54:55], v61 offset:45568
    s_mov_b32 s84, 1048744942
    s_mov_b32 s85, 1048744942
    ds_read_b128 v[12:15], v57 offset:2048
    v_mfma_f32_16x16x32_bf16 v[128:131], v[40:43], v[16:19], v[128:131]
    v_add_u32 v63, 155648, v58
    v_and_b32 v192, 0x33, v0
    s_add_u32 s67, s68, 12288
    buffer_store_dwordx4 v[220:223], v58, s[44:47], s67 offen offset:3072 sc1
    v_mfma_f32_16x16x32_bf16 v[132:135], v[44:47], v[16:19], v[132:135]
    v_bfe_u32 v193, v0, 2, 1
    v_lshl_or_b32 v192, v193, 3, v192
    ds_read_b128 v[16:19], v57 offset:4096
    v_mfma_f32_16x16x32_bf16 v[152:155], v[40:43], v[20:23], v[152:155]
    v_bfe_u32 v193, v0, 3, 1
    v_lshl_or_b32 v192, v193, 2, v192
    v_mfma_f32_16x16x32_bf16 v[156:159], v[44:47], v[20:23], v[156:159]
    s_lshl_b32 s64, s74, 14
    v_lshlrev_b32 v190, 4, v192
    ds_read_b128 v[20:23], v57 offset:6144
    s_waitcnt lgkmcnt(8)
    v_mfma_f32_16x16x32_bf16 v[176:179], v[40:43], v[24:27], v[176:179]
    v_add_u32 v191, s64, v58
    s_add_u32 s64, s64, 98304
    v_mfma_f32_16x16x32_bf16 v[180:183], v[44:47], v[24:27], v[180:183]
    v_add_u32 v190, s64, v190
    s_lshl_b32 s64, s74, 14
    ds_read_b128 v[24:27], v57 offset:8192
    v_mfma_f32_16x16x32_bf16 v[200:203], v[40:43], v[28:31], v[200:203]
    s_add_u32 s65, s64, 0xffff0000
    v_add_u32 v196, s65, v190
    v_mfma_f32_16x16x32_bf16 v[204:207], v[44:47], v[28:31], v[204:207]
    s_add_u32 s65, s64, 34816
    v_add_u32 v197, s65, v191
    ds_read_b128 v[28:31], v57 offset:10240
    v_mfma_f32_16x16x32_bf16 v[224:227], v[40:43], v[32:35], v[224:227]
    s_add_u32 s65, s64, 131072
    v_mov_b32 v198, s65
    v_mfma_f32_16x16x32_bf16 v[228:231], v[44:47], v[32:35], v[228:231]
    v_lshrrev_b32 v192, 2, v0
    v_lshrrev_b32 v193, 4, v0
    ds_read_b128 v[32:35], v57 offset:12288
    v_mfma_f32_16x16x32_bf16 v[248:251], v[40:43], v[36:39], v[248:251]
    v_xor_b32 v192, v192, v193
    v_and_b32 v192, 1, v192
    v_mfma_f32_16x16x32_bf16 v[252:255], v[44:47], v[36:39], v[252:255]
    v_subrev_u32 v192, 1, v192
    v_and_b32 v184, 0x3f803f80, v192
    ds_read_b128 v[36:39], v57 offset:14336
    s_barrier
    s_waitcnt lgkmcnt(4)
    v_mfma_f32_16x16x32_bf16 v[80:83], v[48:51], v[8:11], v[80:83]
    ds_read_b64_tr_b16 v[40:41], v60 offset:49152
    v_mov_b32 v185, v184
    v_mov_b32 v186, v184
    v_mfma_f32_16x16x32_bf16 v[84:87], v[52:55], v[8:11], v[84:87]
    ds_read_b64_tr_b16 v[42:43], v60 offset:49664
    v_mov_b32 v187, v184
    v_lshrrev_b32 v192, 3, v0
    ds_read_b128 v[8:11], v1 offset:32768
    v_mfma_f32_16x16x32_bf16 v[104:107], v[48:51], v[12:15], v[104:107]
    ds_read_b64_tr_b16 v[44:45], v61 offset:49152
    v_and_b32 v188, 7, v0
    v_bfe_u32 v189, v0, 4, 2
    v_mfma_f32_16x16x32_bf16 v[108:111], v[52:55], v[12:15], v[108:111]
    ds_read_b64_tr_b16 v[46:47], v61 offset:49664
    v_lshlrev_b32 v189, 1, v189
    v_xor_b32 v188, v188, v189
    ds_read_b128 v[12:15], v1 offset:34816
    v_mfma_f32_16x16x32_bf16 v[128:131], v[48:51], v[16:19], v[128:131]
    s_lshr_b32 s64, s63, 2
    s_lshl_b32 s64, s64, 20
    v_mfma_f32_16x16x32_bf16 v[132:135], v[52:55], v[16:19], v[132:135]
    s_and_b32 s65, s63, 3
    s_lshl_b32 s65, s65, 14
    ds_read_b128 v[16:19], v1 offset:36864
    v_mfma_f32_16x16x32_bf16 v[152:155], v[48:51], v[20:23], v[152:155]
    s_add_u32 s64, s64, s65
    s_lshl_b32 s65, s80, 7
    v_mfma_f32_16x16x32_bf16 v[156:159], v[52:55], v[20:23], v[156:159]
    s_add_u32 s64, s64, s65
    v_lshlrev_b32 v192, 11, v192
    ds_read_b128 v[20:23], v1 offset:38912
    s_waitcnt lgkmcnt(8)
    v_mfma_f32_16x16x32_bf16 v[176:179], v[48:51], v[24:27], v[176:179]
    v_add_u32 v192, s64, v192
    v_lshl_add_u32 v188, v188, 4, v192
    v_mfma_f32_16x16x32_bf16 v[180:183], v[52:55], v[24:27], v[180:183]
    v_xor_b32 v195, 0x100000, v188
    s_lshl_b32 s82, s63, 10
    ds_read_b128 v[24:27], v1 offset:40960
    v_mfma_f32_16x16x32_bf16 v[200:203], v[48:51], v[28:31], v[200:203]
    v_and_b32 v189, 15, v0
    v_lshrrev_b32 v192, 5, v0
    v_mfma_f32_16x16x32_bf16 v[204:207], v[52:55], v[28:31], v[204:207]
    v_lshl_add_u32 v189, v192, 4, v189
    v_lshlrev_b32 v189, 4, v189
    ds_read_b128 v[28:31], v1 offset:43008
    v_mfma_f32_16x16x32_bf16 v[224:227], v[48:51], v[32:35], v[224:227]
    v_bfe_u32 v192, v0, 4, 1
    v_lshl_add_u32 v189, v192, 15, v189
    v_mfma_f32_16x16x32_bf16 v[228:231], v[52:55], v[32:35], v[228:231]
    ds_read_b128 v[32:35], v1 offset:45056
    v_mfma_f32_16x16x32_bf16 v[248:251], v[48:51], v[36:39], v[248:251]
    v_mfma_f32_16x16x32_bf16 v[252:255], v[52:55], v[36:39], v[252:255]
    ds_read_b128 v[36:39], v1 offset:47104
    s_waitcnt lgkmcnt(4)
    v_mfma_f32_16x16x32_bf16 v[80:83], v[40:43], v[8:11], v[80:83]
    ds_read_b64_tr_b16 v[48:49], v60 offset:53248
    ds_read_b128 v[88:91], v63 offset:0
    v_mfma_f32_16x16x32_bf16 v[84:87], v[44:47], v[8:11], v[84:87]
    ds_read_b64_tr_b16 v[50:51], v60 offset:53760
    ds_write_b128 v59, v[72:75] offset:0
    ds_read_b128 v[8:11], v2 offset:32768
    v_mfma_f32_16x16x32_bf16 v[104:107], v[40:43], v[12:15], v[104:107]
    ds_read_b64_tr_b16 v[52:53], v61 offset:53248
    ds_read_b128 v[92:95], v63 offset:1024
    v_mfma_f32_16x16x32_bf16 v[108:111], v[44:47], v[12:15], v[108:111]
    ds_read_b64_tr_b16 v[54:55], v61 offset:53760
    ds_write_b128 v59, v[76:79] offset:1024
    ds_read_b128 v[12:15], v2 offset:34816
    v_mfma_f32_16x16x32_bf16 v[128:131], v[40:43], v[16:19], v[128:131]
    ds_read_b128 v[96:99], v63 offset:2048
    v_mfma_f32_16x16x32_bf16 v[132:135], v[44:47], v[16:19], v[132:135]
    ds_write_b128 v59, v[120:123] offset:2048
    ds_read_b128 v[16:19], v2 offset:36864
    v_mfma_f32_16x16x32_bf16 v[152:155], v[40:43], v[20:23], v[152:155]
    ds_read_b128 v[100:103], v63 offset:3072
    v_mfma_f32_16x16x32_bf16 v[156:159], v[44:47], v[20:23], v[156:159]
    ds_write_b128 v59, v[124:127] offset:3072
    ds_read_b128 v[20:23], v2 offset:38912
    s_waitcnt lgkmcnt(15)
    v_mfma_f32_16x16x32_bf16 v[176:179], v[40:43], v[24:27], v[176:179]
    ds_read_b128 v[136:139], v63 offset:4096
    v_mfma_f32_16x16x32_bf16 v[180:183], v[44:47], v[24:27], v[180:183]
    ds_write_b128 v59, v[168:171] offset:4096
    ds_read_b128 v[24:27], v2 offset:40960
    v_mfma_f32_16x16x32_bf16 v[200:203], v[40:43], v[28:31], v[200:203]
    ds_read_b128 v[140:143], v63 offset:5120
    v_mfma_f32_16x16x32_bf16 v[204:207], v[44:47], v[28:31], v[204:207]
    s_lshl_b32 s97, s60, 7
    s_lshl_b32 s98, s62, 3
    s_add_u32 s97, s97, s98
    s_add_u32 s97, s97, s61
    s_lshl_b32 s97, s97, 7
    s_lshl_b32 s98, s63, 3
    s_add_u32 s97, s97, s98
    s_add_u32 s97, s97, 25169920
    v_mov_b32 v4, s77
    v_mov_b32 v5, s81
    v_mov_b32 v6, 0
    s_sub_u32 s70, s97, 128
    s_waitcnt vmcnt(0)
    s_mov_b64 exec, 1
    buffer_store_dwordx2 v[4:5], v6, s[44:47], s97 offen sc1
    s_mov_b64 exec, -1
    s_nop 3
    ds_write_b128 v59, v[172:175] offset:5120
    ds_read_b128 v[28:31], v2 offset:43008
    v_mfma_f32_16x16x32_bf16 v[224:227], v[40:43], v[32:35], v[224:227]
    ds_read_b128 v[144:147], v63 offset:6144
    v_mfma_f32_16x16x32_bf16 v[228:231], v[44:47], v[32:35], v[228:231]
    ds_write_b128 v59, v[216:219] offset:6144
    ds_read_b128 v[32:35], v2 offset:45056
    v_mfma_f32_16x16x32_bf16 v[248:251], v[40:43], v[36:39], v[248:251]
    ds_read_b128 v[148:151], v63 offset:7168
    v_mfma_f32_16x16x32_bf16 v[252:255], v[44:47], v[36:39], v[252:255]
    ds_write_b128 v59, v[220:223] offset:7168
    ds_read_b128 v[36:39], v2 offset:47104
    s_waitcnt lgkmcnt(12)
    v_mfma_f32_16x16x32_bf16 v[80:83], v[48:51], v[8:11], v[80:83]
    v_mfma_f32_16x16x32_bf16 v[84:87], v[52:55], v[8:11], v[84:87]
    v_mfma_f32_16x16x32_bf16 v[104:107], v[48:51], v[12:15], v[104:107]
    v_mfma_f32_16x16x32_bf16 v[108:111], v[52:55], v[12:15], v[108:111]
    v_mfma_f32_16x16x32_bf16 v[128:131], v[48:51], v[16:19], v[128:131]
    v_mfma_f32_16x16x32_bf16 v[132:135], v[52:55], v[16:19], v[132:135]
    v_mfma_f32_16x16x32_bf16 v[152:155], v[48:51], v[20:23], v[152:155]
    v_mfma_f32_16x16x32_bf16 v[156:159], v[52:55], v[20:23], v[156:159]
    s_nop 1
    v_pk_mul_f32 v[80:81], v[80:81], s[84:85]
    v_pk_mul_f32 v[82:83], v[82:83], s[84:85]
    v_pk_mul_f32 v[104:105], v[104:105], s[84:85]
    v_pk_mul_f32 v[106:107], v[106:107], s[84:85]
    v_cvt_pk_bf16_f32 v80, v80, v81
    v_cvt_pk_bf16_f32 v81, v82, v83
    v_cvt_pk_bf16_f32 v82, v104, v105
    v_cvt_pk_bf16_f32 v83, v106, v107
    v_pk_mul_f32 v[84:85], v[84:85], s[84:85]
    v_pk_mul_f32 v[86:87], v[86:87], s[84:85]
    v_pk_mul_f32 v[108:109], v[108:109], s[84:85]
    v_pk_mul_f32 v[110:111], v[110:111], s[84:85]
    v_cvt_pk_bf16_f32 v84, v84, v85
    v_cvt_pk_bf16_f32 v85, v86, v87
    v_cvt_pk_bf16_f32 v86, v108, v109
    v_cvt_pk_bf16_f32 v87, v110, v111
    s_nop 0
    v_permlane16_swap_b32 v80, v82
    v_permlane16_swap_b32 v81, v83
    v_permlane16_swap_b32 v84, v86
    v_permlane16_swap_b32 v85, v87
    s_waitcnt lgkmcnt(0)
    v_mfma_f32_16x16x32_bf16 v[176:179], v[48:51], v[24:27], v[176:179]
    v_mfma_f32_16x16x32_bf16 v[180:183], v[52:55], v[24:27], v[180:183]
    v_mfma_f32_16x16x32_bf16 v[200:203], v[48:51], v[28:31], v[200:203]
    v_mfma_f32_16x16x32_bf16 v[204:207], v[52:55], v[28:31], v[204:207]
    s_nop 1
    v_pk_mul_f32 v[128:129], v[128:129], s[84:85]
    v_pk_mul_f32 v[130:131], v[130:131], s[84:85]
    v_pk_mul_f32 v[152:153], v[152:153], s[84:85]
    v_pk_mul_f32 v[154:155], v[154:155], s[84:85]
    v_cvt_pk_bf16_f32 v128, v128, v129
    v_cvt_pk_bf16_f32 v129, v130, v131
    v_cvt_pk_bf16_f32 v130, v152, v153
    v_cvt_pk_bf16_f32 v131, v154, v155
    v_pk_mul_f32 v[132:133], v[132:133], s[84:85]
    v_pk_mul_f32 v[134:135], v[134:135], s[84:85]
    v_pk_mul_f32 v[156:157], v[156:157], s[84:85]
    v_pk_mul_f32 v[158:159], v[158:159], s[84:85]
    v_cvt_pk_bf16_f32 v132, v132, v133
    v_cvt_pk_bf16_f32 v133, v134, v135
    v_cvt_pk_bf16_f32 v134, v156, v157
    v_cvt_pk_bf16_f32 v135, v158, v159
    s_nop 0
    v_permlane16_swap_b32 v128, v130
    v_permlane16_swap_b32 v129, v131
    v_permlane16_swap_b32 v132, v134
    v_permlane16_swap_b32 v133, v135
    v_mfma_f32_16x16x32_bf16 v[224:227], v[48:51], v[32:35], v[224:227]
    v_mfma_f32_16x16x32_bf16 v[228:231], v[52:55], v[32:35], v[228:231]
    v_mfma_f32_16x16x32_bf16 v[248:251], v[48:51], v[36:39], v[248:251]
    v_mfma_f32_16x16x32_bf16 v[252:255], v[52:55], v[36:39], v[252:255]
    s_nop 1
    v_pk_mul_f32 v[176:177], v[176:177], s[84:85]
    v_pk_mul_f32 v[178:179], v[178:179], s[84:85]
    v_pk_mul_f32 v[200:201], v[200:201], s[84:85]
    v_pk_mul_f32 v[202:203], v[202:203], s[84:85]
    v_cvt_pk_bf16_f32 v176, v176, v177
    v_cvt_pk_bf16_f32 v177, v178, v179
    v_cvt_pk_bf16_f32 v178, v200, v201
    v_cvt_pk_bf16_f32 v179, v202, v203
    v_pk_mul_f32 v[180:181], v[180:181], s[84:85]
    v_pk_mul_f32 v[182:183], v[182:183], s[84:85]
    v_pk_mul_f32 v[204:205], v[204:205], s[84:85]
    v_pk_mul_f32 v[206:207], v[206:207], s[84:85]
    v_cvt_pk_bf16_f32 v180, v180, v181
    v_cvt_pk_bf16_f32 v181, v182, v183
    v_cvt_pk_bf16_f32 v182, v204, v205
    v_cvt_pk_bf16_f32 v183, v206, v207
    s_nop 0
    v_permlane16_swap_b32 v176, v178
    v_permlane16_swap_b32 v177, v179
    v_permlane16_swap_b32 v180, v182
    v_permlane16_swap_b32 v181, v183
    s_waitcnt lgkmcnt(0)
L_qe:
    s_barrier
    v_add_u32 v60, 131072, v59
    v_pk_mul_f32 v[224:225], v[224:225], s[84:85]
    v_pk_mul_f32 v[226:227], v[226:227], s[84:85]
    v_pk_mul_f32 v[248:249], v[248:249], s[84:85]
    v_pk_mul_f32 v[250:251], v[250:251], s[84:85]
    v_cvt_pk_bf16_f32 v224, v224, v225
    v_cvt_pk_bf16_f32 v225, v226, v227
    v_cvt_pk_bf16_f32 v226, v248, v249
    v_cvt_pk_bf16_f32 v227, v250, v251
    v_pk_mul_f32 v[228:229], v[228:229], s[84:85]
    v_pk_mul_f32 v[230:231], v[230:231], s[84:85]
    v_pk_mul_f32 v[252:253], v[252:253], s[84:85]
    v_pk_mul_f32 v[254:255], v[254:255], s[84:85]
    v_cvt_pk_bf16_f32 v228, v228, v229
    v_cvt_pk_bf16_f32 v229, v230, v231
    v_cvt_pk_bf16_f32 v230, v252, v253
    v_cvt_pk_bf16_f32 v231, v254, v255
    ds_write_b128 v60, v[80:83] offset:0
    ds_write_b128 v60, v[84:87] offset:1024
    ds_write_b128 v60, v[128:131] offset:2048
    ds_write_b128 v60, v[132:135] offset:3072
    ds_write_b128 v60, v[176:179] offset:4096
    ds_write_b128 v60, v[180:183] offset:5120
    v_permlane16_swap_b32 v224, v226
    v_permlane16_swap_b32 v225, v227
    v_permlane16_swap_b32 v228, v230
    v_permlane16_swap_b32 v229, v231
    v_mov_b32 v1, v58
    ds_write_b128 v60, v[224:227] offset:6144
    ds_write_b128 v60, v[228:231] offset:7168
    s_setprio 1
L_attn:
    s_lshr_b32 s64, s63, 1
    s_waitcnt lgkmcnt(0)
    s_barrier
    s_cmp_eq_u32 s64, 1
    s_cbranch_scc1 L_u1
    s_cmp_eq_u32 s64, 2
    s_cbranch_scc1 L_u2
    s_cmp_eq_u32 s64, 3
    s_cbranch_scc1 L_u3
    v_add_u32 v4, v198, v1
    ds_read_b128 v[16:19], v4 offset:14336
    ds_read_b128 v[20:23], v4 offset:15360
    ds_read_b128 v[8:11], v4 offset:0
    ds_read_b128 v[12:15], v4 offset:1024
    s_waitcnt lgkmcnt(2)
    ds_read_b128 v[80:83], v190 offset:0
    ds_read_b128 v[84:87], v190 offset:1024
    s_waitcnt lgkmcnt(1)
    v_mfma_f32_32x32x16_bf16 v[224:239], v[80:83], v[16:19], 0
    s_waitcnt lgkmcnt(0)
    v_mfma_f32_32x32x16_bf16 v[224:239], v[84:87], v[20:23], v[224:239]
    ds_read_b128 v[80:83], v190 offset:2048
    ds_read_b128 v[84:87], v190 offset:3072
    s_add_u32 s67, s68, 8192
    buffer_store_dwordx4 v[168:171], v1, s[44:47], s67 offen offset:2048 sc1
    s_add_u32 s67, s68, 8192
    buffer_store_dwordx4 v[172:175], v1, s[44:47], s67 offen offset:3072 sc1
    s_waitcnt lgkmcnt(1)
    v_mfma_f32_32x32x16_bf16 v[240:255], v[80:83], v[16:19], 0
    s_nop 7
    s_nop 3
    v_exp_f32 v224, v224
    v_exp_f32 v225, v225
    v_exp_f32 v226, v226
    v_exp_f32 v227, v227
    v_exp_f32 v228, v228
    v_exp_f32 v229, v229
    s_waitcnt lgkmcnt(0)
    v_mfma_f32_32x32x16_bf16 v[240:255], v[84:87], v[20:23], v[240:255]
    ds_read_b128 v[80:83], v190 offset:4096
    ds_read_b128 v[84:87], v190 offset:5120
    v_exp_f32 v230, v230
    v_exp_f32 v231, v231
    v_exp_f32 v232, v232
    ds_read_b128 v[104:107], v191 offset:0
    ds_read_b128 v[108:111], v191 offset:1024
    v_exp_f32 v233, v233
    v_exp_f32 v234, v234
    v_exp_f32 v235, v235
    v_cvt_pk_bf16_f32 v128, v224, v225
    v_cvt_pk_bf16_f32 v129, v226, v227
    v_exp_f32 v236, v236
    v_exp_f32 v237, v237
    v_exp_f32 v238, v238
    v_exp_f32 v239, v239
    v_cvt_pk_bf16_f32 v130, v228, v229
    v_cvt_pk_bf16_f32 v131, v230, v231
    v_cvt_pk_bf16_f32 v132, v232, v233
    v_cvt_pk_bf16_f32 v133, v234, v235
    v_cvt_pk_bf16_f32 v134, v236, v237
    v_cvt_pk_bf16_f32 v135, v238, v239
    s_add_u32 s67, s68, 12288
    buffer_store_dwordx4 v[216:219], v1, s[44:47], s67 offen offset:2048 sc1
    s_add_u32 s67, s68, 12288
    buffer_store_dwordx4 v[220:223], v1, s[44:47], s67 offen offset:3072 sc1
    s_waitcnt lgkmcnt(3)
    v_mfma_f32_32x32x16_bf16 v[224:239], v[80:83], v[16:19], 0
    v_exp_f32 v240, v240
    v_exp_f32 v241, v241
    v_exp_f32 v242, v242
    s_waitcnt lgkmcnt(1)
    v_mfma_f32_32x32x16_bf16 v[40:55], v[104:107], v[128:131], 0
    v_exp_f32 v243, v243
    v_exp_f32 v244, v244
    v_exp_f32 v245, v245
    v_mfma_f32_32x32x16_bf16 v[224:239], v[84:87], v[20:23], v[224:239]
    ds_read_b128 v[80:83], v190 offset:6144
    ds_read_b128 v[84:87], v190 offset:7168
    v_exp_f32 v246, v246
    v_exp_f32 v247, v247
    v_exp_f32 v248, v248
    s_waitcnt lgkmcnt(2)
    v_mfma_f32_32x32x16_bf16 v[40:55], v[108:111], v[132:135], v[40:55]
    ds_read_b128 v[104:107], v191 offset:2048
    ds_read_b128 v[108:111], v191 offset:3072
    v_exp_f32 v249, v249
    v_exp_f32 v250, v250
    v_exp_f32 v251, v251
    v_cvt_pk_bf16_f32 v152, v240, v241
    v_cvt_pk_bf16_f32 v153, v242, v243
    v_mfma_f32_16x16x32_bf16 v[60:63], v[184:187], v[128:131], 0
    v_exp_f32 v252, v252
    v_exp_f32 v253, v253
    v_exp_f32 v254, v254
    v_exp_f32 v255, v255
    v_cvt_pk_bf16_f32 v154, v244, v245
    v_mfma_f32_16x16x32_bf16 v[60:63], v[184:187], v[132:135], v[60:63]
    v_cvt_pk_bf16_f32 v155, v246, v247
    v_cvt_pk_bf16_f32 v156, v248, v249
    v_cvt_pk_bf16_f32 v157, v250, v251
    v_cvt_pk_bf16_f32 v158, v252, v253
    v_cvt_pk_bf16_f32 v159, v254, v255
    s_waitcnt lgkmcnt(3)
    v_mfma_f32_32x32x16_bf16 v[240:255], v[80:83], v[16:19], 0
    v_exp_f32 v224, v224
    v_exp_f32 v225, v225
    v_exp_f32 v226, v226
    s_waitcnt lgkmcnt(1)
    v_mfma_f32_32x32x16_bf16 v[40:55], v[104:107], v[152:155], v[40:55]
    v_exp_f32 v227, v227
    v_exp_f32 v228, v228
    v_exp_f32 v229, v229
    v_mfma_f32_32x32x16_bf16 v[240:255], v[84:87], v[20:23], v[240:255]
    ds_read_b128 v[80:83], v190 offset:8192
    ds_read_b128 v[84:87], v190 offset:9216
    v_exp_f32 v230, v230
    v_exp_f32 v231, v231
    v_exp_f32 v232, v232
    s_waitcnt lgkmcnt(2)
    v_mfma_f32_32x32x16_bf16 v[40:55], v[108:111], v[156:159], v[40:55]
    ds_read_b128 v[104:107], v191 offset:4096
    ds_read_b128 v[108:111], v191 offset:5120
    v_exp_f32 v233, v233
    v_exp_f32 v234, v234
    v_exp_f32 v235, v235
    v_cvt_pk_bf16_f32 v128, v224, v225
    v_cvt_pk_bf16_f32 v129, v226, v227
    v_mfma_f32_16x16x32_bf16 v[60:63], v[184:187], v[152:155], v[60:63]
    v_exp_f32 v236, v236
    v_exp_f32 v237, v237
    v_exp_f32 v238, v238
    v_exp_f32 v239, v239
    v_cvt_pk_bf16_f32 v130, v228, v229
    v_mfma_f32_16x16x32_bf16 v[60:63], v[184:187], v[156:159], v[60:63]
    v_cvt_pk_bf16_f32 v131, v230, v231
    v_cvt_pk_bf16_f32 v132, v232, v233
    v_cvt_pk_bf16_f32 v133, v234, v235
    v_cvt_pk_bf16_f32 v134, v236, v237
    v_cvt_pk_bf16_f32 v135, v238, v239
    s_lshl_b32 s97, s60, 7
    s_lshl_b32 s98, s62, 3
    s_add_u32 s97, s97, s98
    s_add_u32 s97, s97, s61
    s_lshl_b32 s97, s97, 7
    s_lshl_b32 s98, s63, 3
    s_add_u32 s97, s97, s98
    s_add_u32 s97, s97, 25169920
    v_mov_b32 v4, s77
    v_mov_b32 v5, s81
    v_mov_b32 v6, 0
    s_sub_u32 s70, s97, 128
    s_waitcnt vmcnt(0)
    s_mov_b64 exec, 1
    buffer_store_dwordx2 v[4:5], v6, s[44:47], s97 offen sc1
    s_mov_b64 exec, -1
    s_nop 3
    s_cmp_eq_u32 s61, 0
    s_cbranch_scc1 L_np0
    v_mov_b32 v6, 0
    buffer_load_dwordx2 v[2:3], v6, s[44:47], s70 offen sc1
L_np0:
    s_waitcnt lgkmcnt(3)
    v_mfma_f32_32x32x16_bf16 v[224:239], v[80:83], v[16:19], 0
    v_exp_f32 v240, v240
    v_exp_f32 v241, v241
    v_exp_f32 v242, v242
    s_waitcnt lgkmcnt(1)
    v_mfma_f32_32x32x16_bf16 v[40:55], v[104:107], v[128:131], v[40:55]
    v_exp_f32 v243, v243
    v_exp_f32 v244, v244
    v_exp_f32 v245, v245
    v_mfma_f32_32x32x16_bf16 v[224:239], v[84:87], v[20:23], v[224:239]
    ds_read_b128 v[80:83], v190 offset:10240
    ds_read_b128 v[84:87], v190 offset:11264
    v_exp_f32 v246, v246
    v_exp_f32 v247, v247
    v_exp_f32 v248, v248
    s_waitcnt lgkmcnt(2)
    v_mfma_f32_32x32x16_bf16 v[40:55], v[108:111], v[132:135], v[40:55]
    ds_read_b128 v[104:107], v191 offset:6144
    ds_read_b128 v[108:111], v191 offset:7168
    v_exp_f32 v249, v249
    v_exp_f32 v250, v250
    v_exp_f32 v251, v251
    v_cvt_pk_bf16_f32 v152, v240, v241
    v_cvt_pk_bf16_f32 v153, v242, v243
    v_mfma_f32_16x16x32_bf16 v[60:63], v[184:187], v[128:131], v[60:63]
    v_exp_f32 v252, v252
    v_exp_f32 v253, v253
    v_exp_f32 v254, v254
    v_exp_f32 v255, v255
    v_cvt_pk_bf16_f32 v154, v244, v245
    v_mfma_f32_16x16x32_bf16 v[60:63], v[184:187], v[132:135], v[60:63]
    v_cvt_pk_bf16_f32 v155, v246, v247
    v_cvt_pk_bf16_f32 v156, v248, v249
    v_cvt_pk_bf16_f32 v157, v250, v251
    v_cvt_pk_bf16_f32 v158, v252, v253
    v_cvt_pk_bf16_f32 v159, v254, v255
    s_waitcnt lgkmcnt(3)
    v_mfma_f32_32x32x16_bf16 v[240:255], v[80:83], v[16:19], 0
    v_exp_f32 v224, v224
    v_exp_f32 v225, v225
    v_exp_f32 v226, v226
    s_waitcnt lgkmcnt(1)
    v_mfma_f32_32x32x16_bf16 v[40:55], v[104:107], v[152:155], v[40:55]
    v_exp_f32 v227, v227
    v_exp_f32 v228, v228
    v_exp_f32 v229, v229
    v_mfma_f32_32x32x16_bf16 v[240:255], v[84:87], v[20:23], v[240:255]
    ds_read_b128 v[80:83], v190 offset:12288
    ds_read_b128 v[84:87], v190 offset:13312
    v_exp_f32 v230, v230
    v_exp_f32 v231, v231
    v_exp_f32 v232, v232
    s_waitcnt lgkmcnt(2)
    v_mfma_f32_32x32x16_bf16 v[40:55], v[108:111], v[156:159], v[40:55]
    ds_read_b128 v[104:107], v191 offset:8192
    ds_read_b128 v[108:111], v191 offset:9216
    v_exp_f32 v233, v233
    v_exp_f32 v234, v234
    v_exp_f32 v235, v235
    v_cvt_pk_bf16_f32 v128, v224, v225
    v_cvt_pk_bf16_f32 v129, v226, v227
    v_mfma_f32_16x16x32_bf16 v[60:63], v[184:187], v[152:155], v[60:63]
    v_exp_f32 v236, v236
    v_exp_f32 v237, v237
    v_exp_f32 v238, v238
    v_exp_f32 v239, v239
    v_cvt_pk_bf16_f32 v130, v228, v229
    v_mfma_f32_16x16x32_bf16 v[60:63], v[184:187], v[156:159], v[60:63]
    v_cvt_pk_bf16_f32 v131, v230, v231
    v_cvt_pk_bf16_f32 v132, v232, v233
    v_cvt_pk_bf16_f32 v133, v234, v235
    v_cvt_pk_bf16_f32 v134, v236, v237
    v_cvt_pk_bf16_f32 v135, v238, v239
    s_waitcnt lgkmcnt(3)
    v_mfma_f32_32x32x16_bf16 v[224:239], v[80:83], v[16:19], 0
    v_exp_f32 v240, v240
    v_exp_f32 v241, v241
    v_exp_f32 v242, v242
    s_waitcnt lgkmcnt(1)
    v_mfma_f32_32x32x16_bf16 v[40:55], v[104:107], v[128:131], v[40:55]
    v_exp_f32 v243, v243
    v_exp_f32 v244, v244
    v_exp_f32 v245, v245
    v_mfma_f32_32x32x16_bf16 v[224:239], v[84:87], v[20:23], v[224:239]
    ds_read_b128 v[80:83], v190 offset:14336
    ds_read_b128 v[84:87], v190 offset:15360
    v_exp_f32 v246, v246
    v_exp_f32 v247, v247
    v_exp_f32 v248, v248
    s_waitcnt lgkmcnt(2)
    v_mfma_f32_32x32x16_bf16 v[40:55], v[108:111], v[132:135], v[40:55]
    ds_read_b128 v[104:107], v191 offset:10240
    ds_read_b128 v[108:111], v191 offset:11264
    v_exp_f32 v249, v249
    v_exp_f32 v250, v250
    v_exp_f32 v251, v251
    v_cvt_pk_bf16_f32 v152, v240, v241
    v_cvt_pk_bf16_f32 v153, v242, v243
    v_mfma_f32_16x16x32_bf16 v[60:63], v[184:187], v[128:131], v[60:63]
    v_exp_f32 v252, v252
    v_exp_f32 v253, v253
    v_exp_f32 v254, v254
    v_exp_f32 v255, v255
    v_cvt_pk_bf16_f32 v154, v244, v245
    v_mfma_f32_16x16x32_bf16 v[60:63], v[184:187], v[132:135], v[60:63]
    v_cvt_pk_bf16_f32 v155, v246, v247
    v_cvt_pk_bf16_f32 v156, v248, v249
    v_cvt_pk_bf16_f32 v157, v250, v251
    v_cvt_pk_bf16_f32 v158, v252, v253
    v_cvt_pk_bf16_f32 v159, v254, v255
    s_cmp_eq_u32 s61, 0
    s_cbranch_scc1 L_got0
    s_mov_b32 s72, 0x40000
L_poll0:
    s_waitcnt vmcnt(0)
    v_readfirstlane_b32 s66, v2
    v_readfirstlane_b32 s67, v3
    s_cmp_eq_u32 s66, s77
    s_cselect_b32 s66, 1, 0
    s_cmp_eq_u32 s67, s81
    s_cselect_b32 s66, s66, 0
    s_cmp_lg_u32 s66, 0
    s_cbranch_scc1 L_got0
    s_sub_u32 s72, s72, 1
    s_cmp_eq_u32 s72, 0
    s_cbranch_scc1 L_got0
    s_sleep 1
    buffer_load_dwordx2 v[2:3], v6, s[44:47], s70 offen sc1
    s_branch L_poll0
L_got0:
    s_add_u32 s75, s78, 4294934528
    s_lshl_b32 s76, s74, 15
    s_add_u32 s76, s76, 32768
    s_cmp_eq_u32 s61, 0
    s_cbranch_scc1 L_nd0_0
    s_add_u32 m0, s76, 0
    s_add_u32 s66, s75, 0
    buffer_load_dwordx4 v1, s[44:47], s66 offen offset:0 sc1 lds
    buffer_load_dwordx4 v1, s[44:47], s66 offen offset:1024 sc1 lds
    buffer_load_dwordx4 v1, s[44:47], s66 offen offset:2048 sc1 lds
    buffer_load_dwordx4 v1, s[44:47], s66 offen offset:3072 sc1 lds
L_nd0_0:
    s_cmp_eq_u32 s61, 0
    s_cbranch_scc1 L_nd0_1
    s_add_u32 m0, s76, 4096
    s_add_u32 s66, s75, 4096
    buffer_load_dwordx4 v1, s[44:47], s66 offen offset:0 sc1 lds
    buffer_load_dwordx4 v1, s[44:47], s66 offen offset:1024 sc1 lds
    buffer_load_dwordx4 v1, s[44:47], s66 offen offset:2048 sc1 lds
    buffer_load_dwordx4 v1, s[44:47], s66 offen offset:3072 sc1 lds
L_nd0_1:
    s_waitcnt lgkmcnt(3)
    v_mfma_f32_32x32x16_bf16 v[240:255], v[80:83], v[16:19], v[88:103]
    v_exp_f32 v224, v224
    v_exp_f32 v225, v225
    v_exp_f32 v226, v226
    s_waitcnt lgkmcnt(1)
    v_mfma_f32_32x32x16_bf16 v[40:55], v[104:107], v[152:155], v[40:55]
    v_exp_f32 v227, v227
    v_exp_f32 v228, v228
    v_exp_f32 v229, v229
    v_mfma_f32_32x32x16_bf16 v[240:255], v[84:87], v[20:23], v[240:255]
    v_exp_f32 v230, v230
    v_exp_f32 v231, v231
    v_exp_f32 v232, v232
    s_waitcnt lgkmcnt(0)
    v_mfma_f32_32x32x16_bf16 v[40:55], v[108:111], v[156:159], v[40:55]
    ds_read_b128 v[104:107], v191 offset:12288
    ds_read_b128 v[108:111], v191 offset:13312
    v_exp_f32 v233, v233
    v_exp_f32 v234, v234
    v_exp_f32 v235, v235
    v_cvt_pk_bf16_f32 v128, v224, v225
    v_cvt_pk_bf16_f32 v129, v226, v227
    v_mfma_f32_16x16x32_bf16 v[60:63], v[184:187], v[152:155], v[60:63]
    v_exp_f32 v236, v236
    v_exp_f32 v237, v237
    v_exp_f32 v238, v238
    v_exp_f32 v239, v239
    v_cvt_pk_bf16_f32 v130, v228, v229
    v_mfma_f32_16x16x32_bf16 v[60:63], v[184:187], v[156:159], v[60:63]
    v_cvt_pk_bf16_f32 v131, v230, v231
    v_cvt_pk_bf16_f32 v132, v232, v233
    v_cvt_pk_bf16_f32 v133, v234, v235
    v_cvt_pk_bf16_f32 v134, v236, v237
    v_cvt_pk_bf16_f32 v135, v238, v239
    s_cmp_eq_u32 s61, 0
    s_cbranch_scc1 L_nd0_2
    s_add_u32 m0, s76, 8192
    s_add_u32 s66, s75, 8192
    buffer_load_dwordx4 v1, s[44:47], s66 offen offset:0 sc1 lds
    buffer_load_dwordx4 v1, s[44:47], s66 offen offset:1024 sc1 lds
    buffer_load_dwordx4 v1, s[44:47], s66 offen offset:2048 sc1 lds
    buffer_load_dwordx4 v1, s[44:47], s66 offen offset:3072 sc1 lds
L_nd0_2:
    s_cmp_eq_u32 s61, 0
    s_cbranch_scc1 L_nd0_3
    s_add_u32 m0, s76, 12288
    s_add_u32 s66, s75, 12288
    buffer_load_dwordx4 v1, s[44:47], s66 offen offset:0 sc1 lds
    buffer_load_dwordx4 v1, s[44:47], s66 offen offset:1024 sc1 lds
    buffer_load_dwordx4 v1, s[44:47], s66 offen offset:2048 sc1 lds
    buffer_load_dwordx4 v1, s[44:47], s66 offen offset:3072 sc1 lds
L_nd0_3:
    v_exp_f32 v240, v240
    v_exp_f32 v241, v241
    v_exp_f32 v242, v242
    s_waitcnt lgkmcnt(1)
    v_mfma_f32_32x32x16_bf16 v[40:55], v[104:107], v[128:131], v[40:55]
    v_exp_f32 v243, v243
    v_exp_f32 v244, v244
    v_exp_f32 v245, v245
    v_exp_f32 v246, v246
    v_exp_f32 v247, v247
    v_exp_f32 v248, v248
    s_waitcnt lgkmcnt(0)
    v_mfma_f32_32x32x16_bf16 v[40:55], v[108:111], v[132:135], v[40:55]
    ds_read_b128 v[104:107], v191 offset:14336
    ds_read_b128 v[108:111], v191 offset:15360
    v_exp_f32 v249, v249
    v_exp_f32 v250, v250
    v_exp_f32 v251, v251
    v_cvt_pk_bf16_f32 v152, v240, v241
    v_cvt_pk_bf16_f32 v153, v242, v243
    v_mfma_f32_16x16x32_bf16 v[60:63], v[184:187], v[128:131], v[60:63]
    v_exp_f32 v252, v252
    v_exp_f32 v253, v253
    v_exp_f32 v254, v254
    v_exp_f32 v255, v255
    v_cvt_pk_bf16_f32 v154, v244, v245
    v_mfma_f32_16x16x32_bf16 v[60:63], v[184:187], v[132:135], v[60:63]
    v_cvt_pk_bf16_f32 v155, v246, v247
    v_cvt_pk_bf16_f32 v156, v248, v249
    v_cvt_pk_bf16_f32 v157, v250, v251
    v_cvt_pk_bf16_f32 v158, v252, v253
    v_cvt_pk_bf16_f32 v159, v254, v255
    s_nop 1
    s_waitcnt lgkmcnt(1)
    v_mfma_f32_32x32x16_bf16 v[40:55], v[104:107], v[152:155], v[40:55]
    s_waitcnt lgkmcnt(0)
    v_mfma_f32_32x32x16_bf16 v[40:55], v[108:111], v[156:159], v[40:55]
    v_mfma_f32_16x16x32_bf16 v[60:63], v[184:187], v[152:155], v[60:63]
    v_mfma_f32_16x16x32_bf16 v[60:63], v[184:187], v[156:159], v[60:63]
    s_waitcnt lgkmcnt(0)
    s_cmp_eq_u32 s61, 0
    s_cbranch_scc1 L_z0
    s_mov_b32 s72, 0x400000
L_wl0a:
    ds_read_b64 v[2:3], v198 offset:2048
    s_waitcnt lgkmcnt(0)
    v_readfirstlane_b32 s66, v2
    v_readfirstlane_b32 s67, v3
    s_cmp_eq_u32 s66, s77
    s_cselect_b32 s66, 1, 0
    s_cmp_eq_u32 s67, s81
    s_cselect_b32 s66, s66, 0
    s_cmp_lg_u32 s66, 0
    s_cbranch_scc1 L_wd0a
    s_sub_u32 s72, s72, 1
    s_cmp_eq_u32 s72, 0
    s_cbranch_scc1 L_wd0a
    s_sleep 1
    s_branch L_wl0a
L_wd0a:
    ds_read_b128 v[80:83], v196 offset:28672
    ds_read_b128 v[84:87], v196 offset:29696
    s_waitcnt lgkmcnt(1)
    v_mfma_f32_32x32x16_bf16 v[224:239], v[80:83], v[16:19], v[136:151]
    s_waitcnt lgkmcnt(0)
    v_mfma_f32_32x32x16_bf16 v[224:239], v[84:87], v[20:23], v[224:239]
    ds_read_b128 v[80:83], v190 offset:0
    ds_read_b128 v[84:87], v190 offset:1024
    s_waitcnt lgkmcnt(1)
    v_mfma_f32_32x32x16_bf16 v[240:255], v[80:83], v[8:11], v[88:103]
    s_nop 7
    s_nop 3
    v_exp_f32 v224, v224
    v_exp_f32 v225, v225
    v_exp_f32 v226, v226
    v_exp_f32 v227, v227
    v_exp_f32 v228, v228
    v_exp_f32 v229, v229
    s_waitcnt lgkmcnt(0)
    v_mfma_f32_32x32x16_bf16 v[240:255], v[84:87], v[12:15], v[240:255]
    v_exp_f32 v230, v230
    v_exp_f32 v231, v231
    v_exp_f32 v232, v232
    ds_read_b128 v[104:107], v197 offset:28672
    ds_read_b128 v[108:111], v197 offset:29696
    v_exp_f32 v233, v233
    v_exp_f32 v234, v234
    v_exp_f32 v235, v235
    v_cvt_pk_bf16_f32 v128, v224, v225
    v_cvt_pk_bf16_f32 v129, v226, v227
    v_exp_f32 v236, v236
    v_exp_f32 v237, v237
    v_exp_f32 v238, v238
    v_exp_f32 v239, v239
    v_cvt_pk_bf16_f32 v130, v228, v229
    v_cvt_pk_bf16_f32 v131, v230, v231
    v_cvt_pk_bf16_f32 v132, v232, v233
    v_cvt_pk_bf16_f32 v133, v234, v235
    v_cvt_pk_bf16_f32 v134, v236, v237
    v_cvt_pk_bf16_f32 v135, v238, v239
    v_exp_f32 v240, v240
    v_exp_f32 v241, v241
    v_exp_f32 v242, v242
    s_waitcnt lgkmcnt(1)
    v_mfma_f32_32x32x16_bf16 v[40:55], v[104:107], v[128:131], v[40:55]
    v_exp_f32 v243, v243
    v_exp_f32 v244, v244
    v_exp_f32 v245, v245
    v_exp_f32 v246, v246
    v_exp_f32 v247, v247
    v_exp_f32 v248, v248
    s_waitcnt lgkmcnt(0)
    v_mfma_f32_32x32x16_bf16 v[40:55], v[108:111], v[132:135], v[40:55]
    ds_read_b128 v[104:107], v191 offset:0
    ds_read_b128 v[108:111], v191 offset:1024
    v_exp_f32 v249, v249
    v_exp_f32 v250, v250
    v_exp_f32 v251, v251
    v_cvt_pk_bf16_f32 v152, v240, v241
    v_cvt_pk_bf16_f32 v153, v242, v243
    v_mfma_f32_16x16x32_bf16 v[60:63], v[184:187], v[128:131], v[60:63]
    v_exp_f32 v252, v252
    v_exp_f32 v253, v253
    v_exp_f32 v254, v254
    v_exp_f32 v255, v255
    v_cvt_pk_bf16_f32 v154, v244, v245
    v_mfma_f32_16x16x32_bf16 v[60:63], v[184:187], v[132:135], v[60:63]
    v_cvt_pk_bf16_f32 v155, v246, v247
    v_cvt_pk_bf16_f32 v156, v248, v249
    v_cvt_pk_bf16_f32 v157, v250, v251
    v_cvt_pk_bf16_f32 v158, v252, v253
    v_cvt_pk_bf16_f32 v159, v254, v255
    s_mov_b32 s88, 7
    s_nop 3
    v_cmp_le_f32 s[84:85], s34, v60
    v_cmp_ge_f32 s[86:87], s35, v60
    s_lshl_b32 s64, s88, 16
    s_add_u32 s64, s64, s89
    s_and_b64 s[84:85], s[84:85], s[86:87]
    s_cmp_eq_u64 s[84:85], -1
    s_cbranch_scc1 L_ok1
    s_call_b64 s[90:91], L_slowB
L_ok1:
    v_rcp_f32 v61, v60
    s_nop 0
    v_mul_f32 v40, v40, v61
    v_mul_f32 v41, v41, v61
    v_mul_f32 v42, v42, v61
    v_mul_f32 v43, v43, v61
    v_mul_f32 v44, v44, v61
    v_mul_f32 v45, v45, v61
    v_mul_f32 v46, v46, v61
    v_mul_f32 v47, v47, v61
    v_mul_f32 v48, v48, v61
    v_mul_f32 v49, v49, v61
    v_mul_f32 v50, v50, v61
    v_mul_f32 v51, v51, v61
    v_mul_f32 v52, v52, v61
    v_mul_f32 v53, v53, v61
    v_mul_f32 v54, v54, v61
    v_mul_f32 v55, v55, v61
    v_cvt_pk_bf16_f32 v40, v40, v41
    v_cvt_pk_bf16_f32 v41, v42, v43
    v_cvt_pk_bf16_f32 v42, v44, v45
    v_cvt_pk_bf16_f32 v43, v46, v47
    v_cvt_pk_bf16_f32 v44, v48, v49
    v_cvt_pk_bf16_f32 v45, v50, v51
    v_cvt_pk_bf16_f32 v46, v52, v53
    v_cvt_pk_bf16_f32 v47, v54, v55
    buffer_store_dwordx4 v[40:43], v189, s[44:47], s64 offen sc1
    buffer_store_dwordx4 v[44:47], v189, s[44:47], s64 offen offset:512 sc1
    s_nop 1
    s_waitcnt lgkmcnt(1)
    v_mfma_f32_32x32x16_bf16 v[24:39], v[104:107], v[152:155], 0
    s_waitcnt lgkmcnt(0)
    v_mfma_f32_32x32x16_bf16 v[24:39], v[108:111], v[156:159], v[24:39]
    v_mfma_f32_16x16x32_bf16 v[56:59], v[184:187], v[152:155], 0
    v_mfma_f32_16x16x32_bf16 v[56:59], v[184:187], v[156:159], v[56:59]
    s_branch L_w0
L_z0:
    s_nop 7
    s_mov_b32 s88, 7
    s_nop 3
    v_cmp_le_f32 s[84:85], s34, v60
    v_cmp_ge_f32 s[86:87], s35, v60
    s_lshl_b32 s64, s88, 16
    s_add_u32 s64, s64, s89
    s_and_b64 s[84:85], s[84:85], s[86:87]
    s_cmp_eq_u64 s[84:85], -1
    s_cbranch_scc1 L_ok2
    s_call_b64 s[90:91], L_slowB
L_ok2:
    v_rcp_f32 v61, v60
    s_nop 0
    v_mul_f32 v40, v40, v61
    v_mul_f32 v41, v41, v61
    v_mul_f32 v42, v42, v61
    v_mul_f32 v43, v43, v61
    v_mul_f32 v44, v44, v61
    v_mul_f32 v45, v45, v61
    v_mul_f32 v46, v46, v61
    v_mul_f32 v47, v47, v61
    v_mul_f32 v48, v48, v61
    v_mul_f32 v49, v49, v61
    v_mul_f32 v50, v50, v61
    v_mul_f32 v51, v51, v61
    v_mul_f32 v52, v52, v61
    v_mul_f32 v53, v53, v61
    v_mul_f32 v54, v54, v61
    v_mul_f32 v55, v55, v61
    v_cvt_pk_bf16_f32 v40, v40, v41
    v_cvt_pk_bf16_f32 v41, v42, v43
    v_cvt_pk_bf16_f32 v42, v44, v45
    v_cvt_pk_bf16_f32 v43, v46, v47
    v_cvt_pk_bf16_f32 v44, v48, v49
    v_cvt_pk_bf16_f32 v45, v50, v51
    v_cvt_pk_bf16_f32 v46, v52, v53
    v_cvt_pk_bf16_f32 v47, v54, v55
    buffer_store_dwordx4 v[40:43], v189, s[44:47], s64 offen sc1
    buffer_store_dwordx4 v[44:47], v189, s[44:47], s64 offen offset:512 sc1
    ds_read_b128 v[80:83], v190 offset:0
    ds_read_b128 v[84:87], v190 offset:1024
    s_waitcnt lgkmcnt(1)
    v_mfma_f32_32x32x16_bf16 v[224:239], v[80:83], v[8:11], v[88:103]
    s_waitcnt lgkmcnt(0)
    v_mfma_f32_32x32x16_bf16 v[224:239], v[84:87], v[12:15], v[224:239]
    s_nop 7
    s_nop 3
    v_exp_f32 v224, v224
    v_exp_f32 v225, v225
    v_exp_f32 v226, v226
    v_exp_f32 v227, v227
    v_exp_f32 v228, v228
    v_exp_f32 v229, v229
    v_exp_f32 v230, v230
    v_exp_f32 v231, v231
    v_exp_f32 v232, v232
    ds_read_b128 v[104:107], v191 offset:0
    ds_read_b128 v[108:111], v191 offset:1024
    v_exp_f32 v233, v233
    v_exp_f32 v234, v234
    v_exp_f32 v235, v235
    v_cvt_pk_bf16_f32 v128, v224, v225
    v_cvt_pk_bf16_f32 v129, v226, v227
    v_exp_f32 v236, v236
    v_exp_f32 v237, v237
    v_exp_f32 v238, v238
    v_exp_f32 v239, v239
    v_cvt_pk_bf16_f32 v130, v228, v229
    v_cvt_pk_bf16_f32 v131, v230, v231
    v_cvt_pk_bf16_f32 v132, v232, v233
    v_cvt_pk_bf16_f32 v133, v234, v235
    v_cvt_pk_bf16_f32 v134, v236, v237
    v_cvt_pk_bf16_f32 v135, v238, v239
    s_nop 1
    s_waitcnt lgkmcnt(1)
    v_mfma_f32_32x32x16_bf16 v[24:39], v[104:107], v[128:131], 0
    s_waitcnt lgkmcnt(0)
    v_mfma_f32_32x32x16_bf16 v[24:39], v[108:111], v[132:135], v[24:39]
    v_mfma_f32_16x16x32_bf16 v[56:59], v[184:187], v[128:131], 0
    v_mfma_f32_16x16x32_bf16 v[56:59], v[184:187], v[132:135], v[56:59]
L_w0:
    s_waitcnt lgkmcnt(0)
    s_setprio 0
    s_barrier
    s_cmp_eq_u32 s61, 0
    s_cbranch_scc1 L_y0
    ds_read_b128 v[80:83], v196 offset:28672
    ds_read_b128 v[84:87], v196 offset:29696
    s_waitcnt lgkmcnt(1)
    v_mfma_f32_32x32x16_bf16 v[224:239], v[80:83], v[8:11], 0
    s_waitcnt lgkmcnt(0)
    v_mfma_f32_32x32x16_bf16 v[224:239], v[84:87], v[12:15], v[224:239]
    ds_read_b128 v[80:83], v196 offset:24576
    ds_read_b128 v[84:87], v196 offset:25600
    s_waitcnt lgkmcnt(1)
    v_mfma_f32_32x32x16_bf16 v[240:255], v[80:83], v[8:11], 0
    s_nop 7
    s_nop 3
    v_exp_f32 v224, v224
    v_exp_f32 v225, v225
    v_exp_f32 v226, v226
    v_exp_f32 v227, v227
    v_exp_f32 v228, v228
    v_exp_f32 v229, v229
    s_waitcnt lgkmcnt(0)
    v_mfma_f32_32x32x16_bf16 v[240:255], v[84:87], v[12:15], v[240:255]
    ds_read_b128 v[80:83], v196 offset:20480
    ds_read_b128 v[84:87], v196 offset:21504
    v_exp_f32 v230, v230
    v_exp_f32 v231, v231
    v_exp_f32 v232, v232
    ds_read_b128 v[104:107], v197 offset:28672
    ds_read_b128 v[108:111], v197 offset:29696
    v_exp_f32 v233, v233
    v_exp_f32 v234, v234
    v_exp_f32 v235, v235
    v_cvt_pk_bf16_f32 v128, v224, v225
    v_cvt_pk_bf16_f32 v129, v226, v227
    v_exp_f32 v236, v236
    v_exp_f32 v237, v237
    v_exp_f32 v238, v238
    v_exp_f32 v239, v239
    v_cvt_pk_bf16_f32 v130, v228, v229
    v_cvt_pk_bf16_f32 v131, v230, v231
    v_cvt_pk_bf16_f32 v132, v232, v233
    v_cvt_pk_bf16_f32 v133, v234, v235
    v_cvt_pk_bf16_f32 v134, v236, v237
    v_cvt_pk_bf16_f32 v135, v238, v239
    s_mov_b32 s88, 7
    s_lshl_b32 s64, s88, 8
    s_add_u32 s64, s64, s96
    v_mov_b32 v4, s77
    v_mov_b32 v5, s81
    v_mov_b32 v6, 0
    s_waitcnt vmcnt(0)
    s_mov_b64 exec, 1
    buffer_store_dwordx2 v[4:5], v6, s[44:47], s64 offen sc1
    s_mov_b64 exec, -1
    s_nop 3
    v_mov_b32 v2, s77
    v_mov_b32 v3, s81
    s_lshl_b32 s66, s74, 3
    s_add_u32 s66, s66, 155648
    v_mov_b32 v198, s66
    s_waitcnt vmcnt(0)
    ds_write_b64 v198, v[2:3]
    s_add_u32 m0, s82, 0
    s_mov_b32 s67, 0
    buffer_load_dwordx4 v188, s[48:51], s67 offen lds
    s_add_u32 m0, s82, 8192
    s_mov_b32 s67, 65536
    buffer_load_dwordx4 v188, s[48:51], s67 offen lds
    s_add_u32 m0, s82, 16384
    s_mov_b32 s67, 131072
    buffer_load_dwordx4 v188, s[48:51], s67 offen lds
    s_waitcnt lgkmcnt(4)
    v_mfma_f32_32x32x16_bf16 v[224:239], v[80:83], v[8:11], 0
    v_exp_f32 v240, v240
    v_exp_f32 v241, v241
    v_exp_f32 v242, v242
    s_waitcnt lgkmcnt(2)
    v_mfma_f32_32x32x16_bf16 v[24:39], v[104:107], v[128:131], v[24:39]
    v_exp_f32 v243, v243
    v_exp_f32 v244, v244
    v_exp_f32 v245, v245
    v_mfma_f32_32x32x16_bf16 v[224:239], v[84:87], v[12:15], v[224:239]
    ds_read_b128 v[80:83], v196 offset:16384
    ds_read_b128 v[84:87], v196 offset:17408
    v_exp_f32 v246, v246
    v_exp_f32 v247, v247
    v_exp_f32 v248, v248
    s_waitcnt lgkmcnt(3)
    v_mfma_f32_32x32x16_bf16 v[24:39], v[108:111], v[132:135], v[24:39]
    ds_read_b128 v[104:107], v197 offset:24576
    ds_read_b128 v[108:111], v197 offset:25600
    v_exp_f32 v249, v249
    v_exp_f32 v250, v250
    v_exp_f32 v251, v251
    v_cvt_pk_bf16_f32 v152, v240, v241
    v_cvt_pk_bf16_f32 v153, v242, v243
    v_mfma_f32_16x16x32_bf16 v[56:59], v[184:187], v[128:131], v[56:59]
    v_exp_f32 v252, v252
    v_exp_f32 v253, v253
    v_exp_f32 v254, v254
    v_exp_f32 v255, v255
    v_cvt_pk_bf16_f32 v154, v244, v245
    v_mfma_f32_16x16x32_bf16 v[56:59], v[184:187], v[132:135], v[56:59]
    v_cvt_pk_bf16_f32 v155, v246, v247
    v_cvt_pk_bf16_f32 v156, v248, v249
    v_cvt_pk_bf16_f32 v157, v250, v251
    v_cvt_pk_bf16_f32 v158, v252, v253
    v_cvt_pk_bf16_f32 v159, v254, v255
    s_add_u32 m0, s82, 24576
    s_mov_b32 s67, 196608
    buffer_load_dwordx4 v188, s[48:51], s67 offen lds
    s_add_u32 m0, s82, 98304
    s_mov_b32 s67, 262144
    buffer_load_dwordx4 v188, s[48:51], s67 offen lds
    s_add_u32 m0, s82, 106496
    s_mov_b32 s67, 327680
    buffer_load_dwordx4 v188, s[48:51], s67 offen lds
    s_waitcnt lgkmcnt(3)
    v_mfma_f32_32x32x16_bf16 v[240:255], v[80:83], v[8:11], 0
    v_exp_f32 v224, v224
    v_exp_f32 v225, v225
    v_exp_f32 v226, v226
    s_waitcnt lgkmcnt(1)
    v_mfma_f32_32x32x16_bf16 v[24:39], v[104:107], v[152:155], v[24:39]
    v_exp_f32 v227, v227
    v_exp_f32 v228, v228
    v_exp_f32 v229, v229
    v_mfma_f32_32x32x16_bf16 v[240:255], v[84:87], v[12:15], v[240:255]
    ds_read_b128 v[80:83], v196 offset:12288
    ds_read_b128 v[84:87], v196 offset:13312
    v_exp_f32 v230, v230
    v_exp_f32 v231, v231
    v_exp_f32 v232, v232
    s_waitcnt lgkmcnt(2)
    v_mfma_f32_32x32x16_bf16 v[24:39], v[108:111], v[156:159], v[24:39]
    ds_read_b128 v[104:107], v197 offset:20480
    ds_read_b128 v[108:111], v197 offset:21504
    v_exp_f32 v233, v233
    v_exp_f32 v234, v234
    v_exp_f32 v235, v235
    v_cvt_pk_bf16_f32 v128, v224, v225
    v_cvt_pk_bf16_f32 v129, v226, v227
    v_mfma_f32_16x16x32_bf16 v[56:59], v[184:187], v[152:155], v[56:59]
    v_exp_f32 v236, v236
    v_exp_f32 v237, v237
    v_exp_f32 v238, v238
    v_exp_f32 v239, v239
    v_cvt_pk_bf16_f32 v130, v228, v229
    v_mfma_f32_16x16x32_bf16 v[56:59], v[184:187], v[156:159], v[56:59]
    v_cvt_pk_bf16_f32 v131, v230, v231
    v_cvt_pk_bf16_f32 v132, v232, v233
    v_cvt_pk_bf16_f32 v133, v234, v235
    v_cvt_pk_bf16_f32 v134, v236, v237
    v_cvt_pk_bf16_f32 v135, v238, v239
    s_add_u32 m0, s82, 114688
    s_mov_b32 s67, 393216
    buffer_load_dwordx4 v188, s[48:51], s67 offen lds
    s_add_u32 m0, s82, 122880
    s_mov_b32 s67, 458752
    buffer_load_dwordx4 v188, s[48:51], s67 offen lds
    s_add_u32 m0, s82, 131072
    s_mov_b32 s67, 524288
    buffer_load_dwordx4 v188, s[48:51], s67 offen lds
    s_waitcnt lgkmcnt(3)
    v_mfma_f32_32x32x16_bf16 v[224:239], v[80:83], v[8:11], 0
    v_exp_f32 v240, v240
    v_exp_f32 v241, v241
    v_exp_f32 v242, v242
    s_waitcnt lgkmcnt(1)
    v_mfma_f32_32x32x16_bf16 v[24:39], v[104:107], v[128:131], v[24:39]
    v_exp_f32 v243, v243
    v_exp_f32 v244, v244
    v_exp_f32 v245, v245
    v_mfma_f32_32x32x16_bf16 v[224:239], v[84:87], v[12:15], v[224:239]
    ds_read_b128 v[80:83], v196 offset:8192
    ds_read_b128 v[84:87], v196 offset:9216
    v_exp_f32 v246, v246
    v_exp_f32 v247, v247
    v_exp_f32 v248, v248
    s_waitcnt lgkmcnt(2)
    v_mfma_f32_32x32x16_bf16 v[24:39], v[108:111], v[132:135], v[24:39]
    ds_read_b128 v[104:107], v197 offset:16384
    ds_read_b128 v[108:111], v197 offset:17408
    v_exp_f32 v249, v249
    v_exp_f32 v250, v250
    v_exp_f32 v251, v251
    v_cvt_pk_bf16_f32 v152, v240, v241
    v_cvt_pk_bf16_f32 v153, v242, v243
    v_mfma_f32_16x16x32_bf16 v[56:59], v[184:187], v[128:131], v[56:59]
    v_exp_f32 v252, v252
    v_exp_f32 v253, v253
    v_exp_f32 v254, v254
    v_exp_f32 v255, v255
    v_cvt_pk_bf16_f32 v154, v244, v245
    v_mfma_f32_16x16x32_bf16 v[56:59], v[184:187], v[132:135], v[56:59]
    v_cvt_pk_bf16_f32 v155, v246, v247
    v_cvt_pk_bf16_f32 v156, v248, v249
    v_cvt_pk_bf16_f32 v157, v250, v251
    v_cvt_pk_bf16_f32 v158, v252, v253
    v_cvt_pk_bf16_f32 v159, v254, v255
    s_add_u32 m0, s82, 139264
    s_mov_b32 s67, 589824
    buffer_load_dwordx4 v188, s[48:51], s67 offen lds
    s_add_u32 m0, s82, 147456
    s_mov_b32 s67, 655360
    buffer_load_dwordx4 v188, s[48:51], s67 offen lds
    s_waitcnt lgkmcnt(3)
    v_mfma_f32_32x32x16_bf16 v[240:255], v[80:83], v[8:11], 0
    v_exp_f32 v224, v224
    v_exp_f32 v225, v225
    v_exp_f32 v226, v226
    s_waitcnt lgkmcnt(1)
    v_mfma_f32_32x32x16_bf16 v[24:39], v[104:107], v[152:155], v[24:39]
    v_exp_f32 v227, v227
    v_exp_f32 v228, v228
    v_exp_f32 v229, v229
    v_mfma_f32_32x32x16_bf16 v[240:255], v[84:87], v[12:15], v[240:255]
    ds_read_b128 v[80:83], v196 offset:4096
    ds_read_b128 v[84:87], v196 offset:5120
    v_exp_f32 v230, v230
    v_exp_f32 v231, v231
    v_exp_f32 v232, v232
    s_waitcnt lgkmcnt(2)
    v_mfma_f32_32x32x16_bf16 v[24:39], v[108:111], v[156:159], v[24:39]
    ds_read_b128 v[104:107], v197 offset:12288
    ds_read_b128 v[108:111], v197 offset:13312
    v_exp_f32 v233, v233
    v_exp_f32 v234, v234
    v_exp_f32 v235, v235
    v_cvt_pk_bf16_f32 v128, v224, v225
    v_cvt_pk_bf16_f32 v129, v226, v227
    v_mfma_f32_16x16x32_bf16 v[56:59], v[184:187], v[152:155], v[56:59]
    v_exp_f32 v236, v236
    v_exp_f32 v237, v237
    v_exp_f32 v238, v238
    v_exp_f32 v239, v239
    v_cvt_pk_bf16_f32 v130, v228, v229
    v_mfma_f32_16x16x32_bf16 v[56:59], v[184:187], v[156:159], v[56:59]
    v_cvt_pk_bf16_f32 v131, v230, v231
    v_cvt_pk_bf16_f32 v132, v232, v233
    v_cvt_pk_bf16_f32 v133, v234, v235
    v_cvt_pk_bf16_f32 v134, v236, v237
    v_cvt_pk_bf16_f32 v135, v238, v239
    s_waitcnt lgkmcnt(3)
    v_mfma_f32_32x32x16_bf16 v[224:239], v[80:83], v[8:11], 0
    v_exp_f32 v240, v240
    v_exp_f32 v241, v241
    v_exp_f32 v242, v242
    s_waitcnt lgkmcnt(1)
    v_mfma_f32_32x32x16_bf16 v[24:39], v[104:107], v[128:131], v[24:39]
    v_exp_f32 v243, v243
    v_exp_f32 v244, v244
    v_exp_f32 v245, v245
    v_mfma_f32_32x32x16_bf16 v[224:239], v[84:87], v[12:15], v[224:239]
    ds_read_b128 v[80:83], v196 offset:0
    ds_read_b128 v[84:87], v196 offset:1024
    v_exp_f32 v246, v246
    v_exp_f32 v247, v247
    v_exp_f32 v248, v248
    s_waitcnt lgkmcnt(2)
    v_mfma_f32_32x32x16_bf16 v[24:39], v[108:111], v[132:135], v[24:39]
    ds_read_b128 v[104:107], v197 offset:8192
    ds_read_b128 v[108:111], v197 offset:9216
    v_exp_f32 v249, v249
    v_exp_f32 v250, v250
    v_exp_f32 v251, v251
    v_cvt_pk_bf16_f32 v152, v240, v241
    v_cvt_pk_bf16_f32 v153, v242, v243
    v_mfma_f32_16x16x32_bf16 v[56:59], v[184:187], v[128:131], v[56:59]
    v_exp_f32 v252, v252
    v_exp_f32 v253, v253
    v_exp_f32 v254, v254
    v_exp_f32 v255, v255
    v_cvt_pk_bf16_f32 v154, v244, v245
    v_mfma_f32_16x16x32_bf16 v[56:59], v[184:187], v[132:135], v[56:59]
    v_cvt_pk_bf16_f32 v155, v246, v247
    v_cvt_pk_bf16_f32 v156, v248, v249
    v_cvt_pk_bf16_f32 v157, v250, v251
    v_cvt_pk_bf16_f32 v158, v252, v253
    v_cvt_pk_bf16_f32 v159, v254, v255
    s_waitcnt lgkmcnt(3)
    v_mfma_f32_32x32x16_bf16 v[240:255], v[80:83], v[8:11], v[136:151]
    v_exp_f32 v224, v224
    v_exp_f32 v225, v225
    v_exp_f32 v226, v226
    s_waitcnt lgkmcnt(1)
    v_mfma_f32_32x32x16_bf16 v[24:39], v[104:107], v[152:155], v[24:39]
    v_exp_f32 v227, v227
    v_exp_f32 v228, v228
    v_exp_f32 v229, v229
    v_mfma_f32_32x32x16_bf16 v[240:255], v[84:87], v[12:15], v[240:255]
    v_exp_f32 v230, v230
    v_exp_f32 v231, v231
    v_exp_f32 v232, v232
    s_waitcnt lgkmcnt(0)
    v_mfma_f32_32x32x16_bf16 v[24:39], v[108:111], v[156:159], v[24:39]
    ds_read_b128 v[104:107], v197 offset:4096
    ds_read_b128 v[108:111], v197 offset:5120
    v_exp_f32 v233, v233
    v_exp_f32 v234, v234
    v_exp_f32 v235, v235
    v_cvt_pk_bf16_f32 v128, v224, v225
    v_cvt_pk_bf16_f32 v129, v226, v227
    v_mfma_f32_16x16x32_bf16 v[56:59], v[184:187], v[152:155], v[56:59]
    v_exp_f32 v236, v236
    v_exp_f32 v237, v237
    v_exp_f32 v238, v238
    v_exp_f32 v239, v239
    v_cvt_pk_bf16_f32 v130, v228, v229
    v_mfma_f32_16x16x32_bf16 v[56:59], v[184:187], v[156:159], v[56:59]
    v_cvt_pk_bf16_f32 v131, v230, v231
    v_cvt_pk_bf16_f32 v132, v232, v233
    v_cvt_pk_bf16_f32 v133, v234, v235
    v_cvt_pk_bf16_f32 v134, v236, v237
    v_cvt_pk_bf16_f32 v135, v238, v239
    s_lshr_b32 s73, s63, 2
    s_and_b32 s76, s63, 3
    s_lshl_b32 s64, s60, 3
    s_add_u32 s64, s64, s79
    s_lshl_b32 s65, s64, 3
    s_add_u32 s65, s65, s76
    s_lshl_b32 s71, s65, 8
    s_lshl_b32 s66, s73, 7
    s_add_u32 s71, s71, s66
    s_add_u32 s71, s71, 25231360
    v_and_b32 v7, 15, v0
    v_lshlrev_b32 v7, 3, v7
    s_lshl_b32 s70, s65, 16
    s_lshl_b32 s66, s73, 14
    s_add_u32 s70, s70, s66
    s_add_u32 s70, s70, 17039360
    v_add_u32 v192, 0x8000, v1
    s_and_b32 s66, s80, 0
    s_lshl_b32 s66, s66, 10
    s_add_u32 s70, s70, s66
    buffer_load_dwordx2 v[2:3], v7, s[44:47], s71 offen offset:1024 sc1
    v_exp_f32 v240, v240
    v_exp_f32 v241, v241
    v_exp_f32 v242, v242
    s_waitcnt lgkmcnt(1)
    v_mfma_f32_32x32x16_bf16 v[24:39], v[104:107], v[128:131], v[24:39]
    v_exp_f32 v243, v243
    v_exp_f32 v244, v244
    v_exp_f32 v245, v245
    v_exp_f32 v246, v246
    v_exp_f32 v247, v247
    v_exp_f32 v248, v248
    s_waitcnt lgkmcnt(0)
    v_mfma_f32_32x32x16_bf16 v[24:39], v[108:111], v[132:135], v[24:39]
    ds_read_b128 v[104:107], v197 offset:0
    ds_read_b128 v[108:111], v197 offset:1024
    v_exp_f32 v249, v249
    v_exp_f32 v250, v250
    v_exp_f32 v251, v251
    v_cvt_pk_bf16_f32 v152, v240, v241
    v_cvt_pk_bf16_f32 v153, v242, v243
    v_mfma_f32_16x16x32_bf16 v[56:59], v[184:187], v[128:131], v[56:59]
    v_exp_f32 v252, v252
    v_exp_f32 v253, v253
    v_exp_f32 v254, v254
    v_exp_f32 v255, v255
    v_cvt_pk_bf16_f32 v154, v244, v245
    v_mfma_f32_16x16x32_bf16 v[56:59], v[184:187], v[132:135], v[56:59]
    v_cvt_pk_bf16_f32 v155, v246, v247
    v_cvt_pk_bf16_f32 v156, v248, v249
    v_cvt_pk_bf16_f32 v157, v250, v251
    v_cvt_pk_bf16_f32 v158, v252, v253
    v_cvt_pk_bf16_f32 v159, v254, v255
    s_nop 1
    s_waitcnt lgkmcnt(1)
    v_mfma_f32_32x32x16_bf16 v[24:39], v[104:107], v[152:155], v[24:39]
    s_waitcnt lgkmcnt(0)
    v_mfma_f32_32x32x16_bf16 v[24:39], v[108:111], v[156:159], v[24:39]
    v_mfma_f32_16x16x32_bf16 v[56:59], v[184:187], v[152:155], v[56:59]
    v_mfma_f32_16x16x32_bf16 v[56:59], v[184:187], v[156:159], v[56:59]
    s_mov_b32 s88, 0
    s_nop 7
    s_branch L_last
L_y0:
    s_mov_b32 s88, 7
    s_lshl_b32 s64, s88, 8
    s_add_u32 s64, s64, s96
    v_mov_b32 v4, s77
    v_mov_b32 v5, s81
    v_mov_b32 v6, 0
    s_waitcnt vmcnt(0)
    s_mov_b64 exec, 1
    buffer_store_dwordx2 v[4:5], v6, s[44:47], s64 offen sc1
    s_mov_b64 exec, -1
    s_nop 3
    v_mov_b32 v2, s77
    v_mov_b32 v3, s81
    s_lshl_b32 s66, s74, 3
    s_add_u32 s66, s66, 155648
    v_mov_b32 v198, s66
    s_waitcnt vmcnt(0)
    ds_write_b64 v198, v[2:3]
    s_add_u32 m0, s82, 0
    s_mov_b32 s67, 0
    buffer_load_dwordx4 v188, s[48:51], s67 offen lds
    s_add_u32 m0, s82, 8192
    s_mov_b32 s67, 65536
    buffer_load_dwordx4 v188, s[48:51], s67 offen lds
    s_add_u32 m0, s82, 16384
    s_mov_b32 s67, 131072
    buffer_load_dwordx4 v188, s[48:51], s67 offen lds
    s_add_u32 m0, s82, 24576
    s_mov_b32 s67, 196608
    buffer_load_dwordx4 v188, s[48:51], s67 offen lds
    s_add_u32 m0, s82, 98304
    s_mov_b32 s67, 262144
    buffer_load_dwordx4 v188, s[48:51], s67 offen lds
    s_add_u32 m0, s82, 106496
    s_mov_b32 s67, 327680
    buffer_load_dwordx4 v188, s[48:51], s67 offen lds
    s_add_u32 m0, s82, 114688
    s_mov_b32 s67, 393216
    buffer_load_dwordx4 v188, s[48:51], s67 offen lds
    s_add_u32 m0, s82, 122880
    s_mov_b32 s67, 458752
    buffer_load_dwordx4 v188, s[48:51], s67 offen lds
    s_add_u32 m0, s82, 131072
    s_mov_b32 s67, 524288
    buffer_load_dwordx4 v188, s[48:51], s67 offen lds
    s_add_u32 m0, s82, 139264
    s_mov_b32 s67, 589824
    buffer_load_dwordx4 v188, s[48:51], s67 offen lds
    s_add_u32 m0, s82, 147456
    s_mov_b32 s67, 655360
    buffer_load_dwordx4 v188, s[48:51], s67 offen lds
    s_lshr_b32 s73, s63, 2
    s_and_b32 s76, s63, 3
    s_lshl_b32 s64, s60, 3
    s_add_u32 s64, s64, s79
    s_lshl_b32 s65, s64, 3
    s_add_u32 s65, s65, s76
    s_lshl_b32 s71, s65, 8
    s_lshl_b32 s66, s73, 7
    s_add_u32 s71, s71, s66
    s_add_u32 s71, s71, 25231360
    v_and_b32 v7, 15, v0
    v_lshlrev_b32 v7, 3, v7
    s_lshl_b32 s70, s65, 16
    s_lshl_b32 s66, s73, 14
    s_add_u32 s70, s70, s66
    s_add_u32 s70, s70, 17039360
    v_add_u32 v192, 0x8000, v1
    s_and_b32 s66, s80, 0
    s_lshl_b32 s66, s66, 10
    s_add_u32 s70, s70, s66
    buffer_load_dwordx2 v[2:3], v7, s[44:47], s71 offen offset:1024 sc1
    s_waitcnt lgkmcnt(0)
    s_mov_b32 s88, 0
    s_branch L_last
L_u1:
    v_add_u32 v4, v198, v1
    ds_read_b128 v[16:19], v4 offset:12288
    ds_read_b128 v[20:23], v4 offset:13312
    ds_read_b128 v[8:11], v4 offset:2048
    ds_read_b128 v[12:15], v4 offset:3072
    s_waitcnt lgkmcnt(2)
    ds_read_b128 v[80:83], v190 offset:0
    ds_read_b128 v[84:87], v190 offset:1024
    s_waitcnt lgkmcnt(1)
    v_mfma_f32_32x32x16_bf16 v[224:239], v[80:83], v[16:19], 0
    s_waitcnt lgkmcnt(0)
    v_mfma_f32_32x32x16_bf16 v[224:239], v[84:87], v[20:23], v[224:239]
    ds_read_b128 v[80:83], v190 offset:2048
    ds_read_b128 v[84:87], v190 offset:3072
    s_cmp_eq_u32 s61, 0
    s_cbranch_scc1 L_np1
    v_mov_b32 v6, 0
    buffer_load_dwordx2 v[2:3], v6, s[44:47], s70 offen sc1
L_np1:
    s_waitcnt lgkmcnt(1)
    v_mfma_f32_32x32x16_bf16 v[240:255], v[80:83], v[16:19], 0
    s_nop 7
    s_nop 3
    v_exp_f32 v224, v224
    v_exp_f32 v225, v225
    v_exp_f32 v226, v226
    v_exp_f32 v227, v227
    v_exp_f32 v228, v228
    v_exp_f32 v229, v229
    s_waitcnt lgkmcnt(0)
    v_mfma_f32_32x32x16_bf16 v[240:255], v[84:87], v[20:23], v[240:255]
    ds_read_b128 v[80:83], v190 offset:4096
    ds_read_b128 v[84:87], v190 offset:5120
    v_exp_f32 v230, v230
    v_exp_f32 v231, v231
    v_exp_f32 v232, v232
    ds_read_b128 v[104:107], v191 offset:0
    ds_read_b128 v[108:111], v191 offset:1024
    v_exp_f32 v233, v233
    v_exp_f32 v234, v234
    v_exp_f32 v235, v235
    v_cvt_pk_bf16_f32 v128, v224, v225
    v_cvt_pk_bf16_f32 v129, v226, v227
    v_exp_f32 v236, v236
    v_exp_f32 v237, v237
    v_exp_f32 v238, v238
    v_exp_f32 v239, v239
    v_cvt_pk_bf16_f32 v130, v228, v229
    v_cvt_pk_bf16_f32 v131, v230, v231
    v_cvt_pk_bf16_f32 v132, v232, v233
    v_cvt_pk_bf16_f32 v133, v234, v235
    v_cvt_pk_bf16_f32 v134, v236, v237
    v_cvt_pk_bf16_f32 v135, v238, v239
    s_cmp_eq_u32 s61, 0
    s_cbranch_scc1 L_got1
    s_mov_b32 s72, 0x40000
L_poll1:
    s_waitcnt vmcnt(0)
    v_readfirstlane_b32 s66, v2
    v_readfirstlane_b32 s67, v3
    s_cmp_eq_u32 s66, s77
    s_cselect_b32 s66, 1, 0
    s_cmp_eq_u32 s67, s81
    s_cselect_b32 s66, s66, 0
    s_cmp_lg_u32 s66, 0
    s_cbranch_scc1 L_got1
    s_sub_u32 s72, s72, 1
    s_cmp_eq_u32 s72, 0
    s_cbranch_scc1 L_got1
    s_sleep 1
    buffer_load_dwordx2 v[2:3], v6, s[44:47], s70 offen sc1
    s_branch L_poll1
L_got1:
    s_add_u32 s75, s78, 4294950912
    s_lshl_b32 s76, s74, 15
    s_add_u32 s76, s76, 49152
    s_cmp_eq_u32 s61, 0
    s_cbranch_scc1 L_nd1_0
    s_add_u32 m0, s76, 0
    s_add_u32 s66, s75, 0
    buffer_load_dwordx4 v1, s[44:47], s66 offen offset:0 sc1 lds
    buffer_load_dwordx4 v1, s[44:47], s66 offen offset:1024 sc1 lds
    buffer_load_dwordx4 v1, s[44:47], s66 offen offset:2048 sc1 lds
    buffer_load_dwordx4 v1, s[44:47], s66 offen offset:3072 sc1 lds
L_nd1_0:
    s_cmp_eq_u32 s61, 0
    s_cbranch_scc1 L_nd1_1
    s_add_u32 m0, s76, 4096
    s_add_u32 s66, s75, 4096
    buffer_load_dwordx4 v1, s[44:47], s66 offen offset:0 sc1 lds
    buffer_load_dwordx4 v1, s[44:47], s66 offen offset:1024 sc1 lds
    buffer_load_dwordx4 v1, s[44:47], s66 offen offset:2048 sc1 lds
    buffer_load_dwordx4 v1, s[44:47], s66 offen offset:3072 sc1 lds
L_nd1_1:
    s_waitcnt lgkmcnt(3)
    v_mfma_f32_32x32x16_bf16 v[224:239], v[80:83], v[16:19], 0
    v_exp_f32 v240, v240
    v_exp_f32 v241, v241
    v_exp_f32 v242, v242
    s_waitcnt lgkmcnt(1)
    v_mfma_f32_32x32x16_bf16 v[40:55], v[104:107], v[128:131], 0
    v_exp_f32 v243, v243
    v_exp_f32 v244, v244
    v_exp_f32 v245, v245
    v_mfma_f32_32x32x16_bf16 v[224:239], v[84:87], v[20:23], v[224:239]
    ds_read_b128 v[80:83], v190 offset:6144
    ds_read_b128 v[84:87], v190 offset:7168
    v_exp_f32 v246, v246
    v_exp_f32 v247, v247
    v_exp_f32 v248, v248
    s_waitcnt lgkmcnt(2)
    v_mfma_f32_32x32x16_bf16 v[40:55], v[108:111], v[132:135], v[40:55]
    ds_read_b128 v[104:107], v191 offset:2048
    ds_read_b128 v[108:111], v191 offset:3072
    v_exp_f32 v249, v249
    v_exp_f32 v250, v250
    v_exp_f32 v251, v251
    v_cvt_pk_bf16_f32 v152, v240, v241
    v_cvt_pk_bf16_f32 v153, v242, v243
    v_mfma_f32_16x16x32_bf16 v[60:63], v[184:187], v[128:131], 0
    v_exp_f32 v252, v252
    v_exp_f32 v253, v253
    v_exp_f32 v254, v254
    v_exp_f32 v255, v255
    v_cvt_pk_bf16_f32 v154, v244, v245
    v_mfma_f32_16x16x32_bf16 v[60:63], v[184:187], v[132:135], v[60:63]
    v_cvt_pk_bf16_f32 v155, v246, v247
    v_cvt_pk_bf16_f32 v156, v248, v249
    v_cvt_pk_bf16_f32 v157, v250, v251
    v_cvt_pk_bf16_f32 v158, v252, v253
    v_cvt_pk_bf16_f32 v159, v254, v255
    s_cmp_eq_u32 s61, 0
    s_cbranch_scc1 L_nd1_2
    s_add_u32 m0, s76, 8192
    s_add_u32 s66, s75, 8192
    buffer_load_dwordx4 v1, s[44:47], s66 offen offset:0 sc1 lds
    buffer_load_dwordx4 v1, s[44:47], s66 offen offset:1024 sc1 lds
    buffer_load_dwordx4 v1, s[44:47], s66 offen offset:2048 sc1 lds
    buffer_load_dwordx4 v1, s[44:47], s66 offen offset:3072 sc1 lds
L_nd1_2:
    s_cmp_eq_u32 s61, 0
    s_cbranch_scc1 L_nd1_3
    s_add_u32 m0, s76, 12288
    s_add_u32 s66, s75, 12288
    buffer_load_dwordx4 v1, s[44:47], s66 offen offset:0 sc1 lds
    buffer_load_dwordx4 v1, s[44:47], s66 offen offset:1024 sc1 lds
    buffer_load_dwordx4 v1, s[44:47], s66 offen offset:2048 sc1 lds
    buffer_load_dwordx4 v1, s[44:47], s66 offen offset:3072 sc1 lds
L_nd1_3:
    s_waitcnt lgkmcnt(3)
    v_mfma_f32_32x32x16_bf16 v[240:255], v[80:83], v[16:19], 0
    v_exp_f32 v224, v224
    v_exp_f32 v225, v225
    v_exp_f32 v226, v226
    s_waitcnt lgkmcnt(1)
    v_mfma_f32_32x32x16_bf16 v[40:55], v[104:107], v[152:155], v[40:55]
    v_exp_f32 v227, v227
    v_exp_f32 v228, v228
    v_exp_f32 v229, v229
    v_mfma_f32_32x32x16_bf16 v[240:255], v[84:87], v[20:23], v[240:255]
    ds_read_b128 v[80:83], v190 offset:8192
    ds_read_b128 v[84:87], v190 offset:9216
    v_exp_f32 v230, v230
    v_exp_f32 v231, v231
    v_exp_f32 v232, v232
    s_waitcnt lgkmcnt(2)
    v_mfma_f32_32x32x16_bf16 v[40:55], v[108:111], v[156:159], v[40:55]
    ds_read_b128 v[104:107], v191 offset:4096
    ds_read_b128 v[108:111], v191 offset:5120
    v_exp_f32 v233, v233
    v_exp_f32 v234, v234
    v_exp_f32 v235, v235
    v_cvt_pk_bf16_f32 v128, v224, v225
    v_cvt_pk_bf16_f32 v129, v226, v227
    v_mfma_f32_16x16x32_bf16 v[60:63], v[184:187], v[152:155], v[60:63]
    v_exp_f32 v236, v236
    v_exp_f32 v237, v237
    v_exp_f32 v238, v238
    v_exp_f32 v239, v239
    v_cvt_pk_bf16_f32 v130, v228, v229
    v_mfma_f32_16x16x32_bf16 v[60:63], v[184:187], v[156:159], v[60:63]
    v_cvt_pk_bf16_f32 v131, v230, v231
    v_cvt_pk_bf16_f32 v132, v232, v233
    v_cvt_pk_bf16_f32 v133, v234, v235
    v_cvt_pk_bf16_f32 v134, v236, v237
    v_cvt_pk_bf16_f32 v135, v238, v239
    s_waitcnt lgkmcnt(3)
    v_mfma_f32_32x32x16_bf16 v[224:239], v[80:83], v[16:19], 0
    v_exp_f32 v240, v240
    v_exp_f32 v241, v241
    v_exp_f32 v242, v242
    s_waitcnt lgkmcnt(1)
    v_mfma_f32_32x32x16_bf16 v[40:55], v[104:107], v[128:131], v[40:55]
    v_exp_f32 v243, v243
    v_exp_f32 v244, v244
    v_exp_f32 v245, v245
    v_mfma_f32_32x32x16_bf16 v[224:239], v[84:87], v[20:23], v[224:239]
    ds_read_b128 v[80:83], v190 offset:10240
    ds_read_b128 v[84:87], v190 offset:11264
    v_exp_f32 v246, v246
    v_exp_f32 v247, v247
    v_exp_f32 v248, v248
    s_waitcnt lgkmcnt(2)
    v_mfma_f32_32x32x16_bf16 v[40:55], v[108:111], v[132:135], v[40:55]
    ds_read_b128 v[104:107], v191 offset:6144
    ds_read_b128 v[108:111], v191 offset:7168
    v_exp_f32 v249, v249
    v_exp_f32 v250, v250
    v_exp_f32 v251, v251
    v_cvt_pk_bf16_f32 v152, v240, v241
    v_cvt_pk_bf16_f32 v153, v242, v243
    v_mfma_f32_16x16x32_bf16 v[60:63], v[184:187], v[128:131], v[60:63]
    v_exp_f32 v252, v252
    v_exp_f32 v253, v253
    v_exp_f32 v254, v254
    v_exp_f32 v255, v255
    v_cvt_pk_bf16_f32 v154, v244, v245
    v_mfma_f32_16x16x32_bf16 v[60:63], v[184:187], v[132:135], v[60:63]
    v_cvt_pk_bf16_f32 v155, v246, v247
    v_cvt_pk_bf16_f32 v156, v248, v249
    v_cvt_pk_bf16_f32 v157, v250, v251
    v_cvt_pk_bf16_f32 v158, v252, v253
    v_cvt_pk_bf16_f32 v159, v254, v255
    v_mov_b32 v2, s77
    v_mov_b32 v3, s81
    s_waitcnt vmcnt(0)
    ds_write_b64 v198, v[2:3] offset:2048
    s_waitcnt lgkmcnt(4)
    v_mfma_f32_32x32x16_bf16 v[240:255], v[80:83], v[16:19], 0
    v_exp_f32 v224, v224
    v_exp_f32 v225, v225
    v_exp_f32 v226, v226
    s_waitcnt lgkmcnt(2)
    v_mfma_f32_32x32x16_bf16 v[40:55], v[104:107], v[152:155], v[40:55]
    v_exp_f32 v227, v227
    v_exp_f32 v228, v228
    v_exp_f32 v229, v229
    v_mfma_f32_32x32x16_bf16 v[240:255], v[84:87], v[20:23], v[240:255]
    ds_read_b128 v[80:83], v190 offset:12288
    ds_read_b128 v[84:87], v190 offset:13312
    v_exp_f32 v230, v230
    v_exp_f32 v231, v231
    v_exp_f32 v232, v232
    s_waitcnt lgkmcnt(3)
    v_mfma_f32_32x32x16_bf16 v[40:55], v[108:111], v[156:159], v[40:55]
    ds_read_b128 v[104:107], v191 offset:8192
    ds_read_b128 v[108:111], v191 offset:9216
    v_exp_f32 v233, v233
    v_exp_f32 v234, v234
    v_exp_f32 v235, v235
    v_cvt_pk_bf16_f32 v128, v224, v225
    v_cvt_pk_bf16_f32 v129, v226, v227
    v_mfma_f32_16x16x32_bf16 v[60:63], v[184:187], v[152:155], v[60:63]
    v_exp_f32 v236, v236
    v_exp_f32 v237, v237
    v_exp_f32 v238, v238
    v_exp_f32 v239, v239
    v_cvt_pk_bf16_f32 v130, v228, v229
    v_mfma_f32_16x16x32_bf16 v[60:63], v[184:187], v[156:159], v[60:63]
    v_cvt_pk_bf16_f32 v131, v230, v231
    v_cvt_pk_bf16_f32 v132, v232, v233
    v_cvt_pk_bf16_f32 v133, v234, v235
    v_cvt_pk_bf16_f32 v134, v236, v237
    v_cvt_pk_bf16_f32 v135, v238, v239
    s_waitcnt lgkmcnt(3)
    v_mfma_f32_32x32x16_bf16 v[224:239], v[80:83], v[16:19], v[88:103]
    v_exp_f32 v240, v240
    v_exp_f32 v241, v241
    v_exp_f32 v242, v242
    s_waitcnt lgkmcnt(1)
    v_mfma_f32_32x32x16_bf16 v[40:55], v[104:107], v[128:131], v[40:55]
    v_exp_f32 v243, v243
    v_exp_f32 v244, v244
    v_exp_f32 v245, v245
    v_mfma_f32_32x32x16_bf16 v[224:239], v[84:87], v[20:23], v[224:239]
    v_exp_f32 v246, v246
    v_exp_f32 v247, v247
    v_exp_f32 v248, v248
    s_waitcnt lgkmcnt(0)
    v_mfma_f32_32x32x16_bf16 v[40:55], v[108:111], v[132:135], v[40:55]
    ds_read_b128 v[104:107], v191 offset:10240
    ds_read_b128 v[108:111], v191 offset:11264
    v_exp_f32 v249, v249
    v_exp_f32 v250, v250
    v_exp_f32 v251, v251
    v_cvt_pk_bf16_f32 v152, v240, v241
    v_cvt_pk_bf16_f32 v153, v242, v243
    v_mfma_f32_16x16x32_bf16 v[60:63], v[184:187], v[128:131], v[60:63]
    v_exp_f32 v252, v252
    v_exp_f32 v253, v253
    v_exp_f32 v254, v254
    v_exp_f32 v255, v255
    v_cvt_pk_bf16_f32 v154, v244, v245
    v_mfma_f32_16x16x32_bf16 v[60:63], v[184:187], v[132:135], v[60:63]
    v_cvt_pk_bf16_f32 v155, v246, v247
    v_cvt_pk_bf16_f32 v156, v248, v249
    v_cvt_pk_bf16_f32 v157, v250, v251
    v_cvt_pk_bf16_f32 v158, v252, v253
    v_cvt_pk_bf16_f32 v159, v254, v255
    v_exp_f32 v224, v224
    v_exp_f32 v225, v225
    v_exp_f32 v226, v226
    s_waitcnt lgkmcnt(1)
    v_mfma_f32_32x32x16_bf16 v[40:55], v[104:107], v[152:155], v[40:55]
    v_exp_f32 v227, v227
    v_exp_f32 v228, v228
    v_exp_f32 v229, v229
    v_exp_f32 v230, v230
    v_exp_f32 v231, v231
    v_exp_f32 v232, v232
    s_waitcnt lgkmcnt(0)
    v_mfma_f32_32x32x16_bf16 v[40:55], v[108:111], v[156:159], v[40:55]
    ds_read_b128 v[104:107], v191 offset:12288
    ds_read_b128 v[108:111], v191 offset:13312
    v_exp_f32 v233, v233
    v_exp_f32 v234, v234
    v_exp_f32 v235, v235
    v_cvt_pk_bf16_f32 v128, v224, v225
    v_cvt_pk_bf16_f32 v129, v226, v227
    v_mfma_f32_16x16x32_bf16 v[60:63], v[184:187], v[152:155], v[60:63]
    v_exp_f32 v236, v236
    v_exp_f32 v237, v237
    v_exp_f32 v238, v238
    v_exp_f32 v239, v239
    v_cvt_pk_bf16_f32 v130, v228, v229
    v_mfma_f32_16x16x32_bf16 v[60:63], v[184:187], v[156:159], v[60:63]
    v_cvt_pk_bf16_f32 v131, v230, v231
    v_cvt_pk_bf16_f32 v132, v232, v233
    v_cvt_pk_bf16_f32 v133, v234, v235
    v_cvt_pk_bf16_f32 v134, v236, v237
    v_cvt_pk_bf16_f32 v135, v238, v239
    s_nop 1
    s_waitcnt lgkmcnt(1)
    v_mfma_f32_32x32x16_bf16 v[40:55], v[104:107], v[128:131], v[40:55]
    s_waitcnt lgkmcnt(0)
    v_mfma_f32_32x32x16_bf16 v[40:55], v[108:111], v[132:135], v[40:55]
    v_mfma_f32_16x16x32_bf16 v[60:63], v[184:187], v[128:131], v[60:63]
    v_mfma_f32_16x16x32_bf16 v[60:63], v[184:187], v[132:135], v[60:63]
    s_waitcnt lgkmcnt(0)
    s_cmp_eq_u32 s61, 0
    s_cbranch_scc1 L_z1
    s_mov_b32 s72, 0x400000
L_wl1a:
    ds_read_b64 v[2:3], v198 offset:2048
    s_waitcnt lgkmcnt(0)
    v_readfirstlane_b32 s66, v2
    v_readfirstlane_b32 s67, v3
    s_cmp_eq_u32 s66, s77
    s_cselect_b32 s66, 1, 0
    s_cmp_eq_u32 s67, s81
    s_cselect_b32 s66, s66, 0
    s_cmp_lg_u32 s66, 0
    s_cbranch_scc1 L_wd1a
    s_sub_u32 s72, s72, 1
    s_cmp_eq_u32 s72, 0
    s_cbranch_scc1 L_wd1a
    s_sleep 1
    s_branch L_wl1a
L_wd1a:
    ds_read_b128 v[80:83], v196 offset:24576
    ds_read_b128 v[84:87], v196 offset:25600
    s_waitcnt lgkmcnt(1)
    v_mfma_f32_32x32x16_bf16 v[224:239], v[80:83], v[16:19], v[136:151]
    s_waitcnt lgkmcnt(0)
    v_mfma_f32_32x32x16_bf16 v[224:239], v[84:87], v[20:23], v[224:239]
    ds_read_b128 v[80:83], v196 offset:28672
    ds_read_b128 v[84:87], v196 offset:29696
    s_waitcnt lgkmcnt(1)
    v_mfma_f32_32x32x16_bf16 v[240:255], v[80:83], v[16:19], 0
    s_nop 7
    s_nop 3
    v_exp_f32 v224, v224
    v_exp_f32 v225, v225
    v_exp_f32 v226, v226
    v_exp_f32 v227, v227
    v_exp_f32 v228, v228
    v_exp_f32 v229, v229
    s_waitcnt lgkmcnt(0)
    v_mfma_f32_32x32x16_bf16 v[240:255], v[84:87], v[20:23], v[240:255]
    ds_read_b128 v[80:83], v190 offset:0
    ds_read_b128 v[84:87], v190 offset:1024
    v_exp_f32 v230, v230
    v_exp_f32 v231, v231
    v_exp_f32 v232, v232
    ds_read_b128 v[104:107], v197 offset:24576
    ds_read_b128 v[108:111], v197 offset:25600
    v_exp_f32 v233, v233
    v_exp_f32 v234, v234
    v_exp_f32 v235, v235
    v_cvt_pk_bf16_f32 v128, v224, v225
    v_cvt_pk_bf16_f32 v129, v226, v227
    v_exp_f32 v236, v236
    v_exp_f32 v237, v237
    v_exp_f32 v238, v238
    v_exp_f32 v239, v239
    v_cvt_pk_bf16_f32 v130, v228, v229
    v_cvt_pk_bf16_f32 v131, v230, v231
    v_cvt_pk_bf16_f32 v132, v232, v233
    v_cvt_pk_bf16_f32 v133, v234, v235
    v_cvt_pk_bf16_f32 v134, v236, v237
    v_cvt_pk_bf16_f32 v135, v238, v239
    s_waitcnt lgkmcnt(3)
    v_mfma_f32_32x32x16_bf16 v[224:239], v[80:83], v[8:11], 0
    v_exp_f32 v240, v240
    v_exp_f32 v241, v241
    v_exp_f32 v242, v242
    s_waitcnt lgkmcnt(1)
    v_mfma_f32_32x32x16_bf16 v[40:55], v[104:107], v[128:131], v[40:55]
    v_exp_f32 v243, v243
    v_exp_f32 v244, v244
    v_exp_f32 v245, v245
    v_mfma_f32_32x32x16_bf16 v[224:239], v[84:87], v[12:15], v[224:239]
    ds_read_b128 v[80:83], v190 offset:2048
    ds_read_b128 v[84:87], v190 offset:3072
    v_exp_f32 v246, v246
    v_exp_f32 v247, v247
    v_exp_f32 v248, v248
    s_waitcnt lgkmcnt(2)
    v_mfma_f32_32x32x16_bf16 v[40:55], v[108:111], v[132:135], v[40:55]
    ds_read_b128 v[104:107], v197 offset:28672
    ds_read_b128 v[108:111], v197 offset:29696
    v_exp_f32 v249, v249
    v_exp_f32 v250, v250
    v_exp_f32 v251, v251
    v_cvt_pk_bf16_f32 v152, v240, v241
    v_cvt_pk_bf16_f32 v153, v242, v243
    v_mfma_f32_16x16x32_bf16 v[60:63], v[184:187], v[128:131], v[60:63]
    v_exp_f32 v252, v252
    v_exp_f32 v253, v253
    v_exp_f32 v254, v254
    v_exp_f32 v255, v255
    v_cvt_pk_bf16_f32 v154, v244, v245
    v_mfma_f32_16x16x32_bf16 v[60:63], v[184:187], v[132:135], v[60:63]
    v_cvt_pk_bf16_f32 v155, v246, v247
    v_cvt_pk_bf16_f32 v156, v248, v249
    v_cvt_pk_bf16_f32 v157, v250, v251
    v_cvt_pk_bf16_f32 v158, v252, v253
    v_cvt_pk_bf16_f32 v159, v254, v255
    s_waitcnt lgkmcnt(3)
    v_mfma_f32_32x32x16_bf16 v[240:255], v[80:83], v[8:11], v[88:103]
    v_exp_f32 v224, v224
    v_exp_f32 v225, v225
    v_exp_f32 v226, v226
    s_waitcnt lgkmcnt(1)
    v_mfma_f32_32x32x16_bf16 v[40:55], v[104:107], v[152:155], v[40:55]
    v_exp_f32 v227, v227
    v_exp_f32 v228, v228
    v_exp_f32 v229, v229
    v_mfma_f32_32x32x16_bf16 v[240:255], v[84:87], v[12:15], v[240:255]
    v_exp_f32 v230, v230
    v_exp_f32 v231, v231
    v_exp_f32 v232, v232
    s_waitcnt lgkmcnt(0)
    v_mfma_f32_32x32x16_bf16 v[40:55], v[108:111], v[156:159], v[40:55]
    ds_read_b128 v[104:107], v191 offset:0
    ds_read_b128 v[108:111], v191 offset:1024
    v_exp_f32 v233, v233
    v_exp_f32 v234, v234
    v_exp_f32 v235, v235
    v_cvt_pk_bf16_f32 v128, v224, v225
    v_cvt_pk_bf16_f32 v129, v226, v227
    v_mfma_f32_16x16x32_bf16 v[60:63], v[184:187], v[152:155], v[60:63]
    v_exp_f32 v236, v236
    v_exp_f32 v237, v237
    v_exp_f32 v238, v238
    v_exp_f32 v239, v239
    v_cvt_pk_bf16_f32 v130, v228, v229
    v_mfma_f32_16x16x32_bf16 v[60:63], v[184:187], v[156:159], v[60:63]
    v_cvt_pk_bf16_f32 v131, v230, v231
    v_cvt_pk_bf16_f32 v132, v232, v233
    v_cvt_pk_bf16_f32 v133, v234, v235
    v_cvt_pk_bf16_f32 v134, v236, v237
    v_cvt_pk_bf16_f32 v135, v238, v239
    s_mov_b32 s88, 6
    s_nop 3
    v_cmp_le_f32 s[84:85], s34, v60
    v_cmp_ge_f32 s[86:87], s35, v60
    s_lshl_b32 s64, s88, 16
    s_add_u32 s64, s64, s89
    s_and_b64 s[84:85], s[84:85], s[86:87]
    s_cmp_eq_u64 s[84:85], -1
    s_cbranch_scc1 L_ok3
    s_call_b64 s[90:91], L_slowB
L_ok3:
    v_rcp_f32 v61, v60
    s_nop 0
    v_mul_f32 v40, v40, v61
    v_mul_f32 v41, v41, v61
    v_mul_f32 v42, v42, v61
    v_mul_f32 v43, v43, v61
    v_mul_f32 v44, v44, v61
    v_mul_f32 v45, v45, v61
    v_mul_f32 v46, v46, v61
    v_mul_f32 v47, v47, v61
    v_mul_f32 v48, v48, v61
    v_mul_f32 v49, v49, v61
    v_mul_f32 v50, v50, v61
    v_mul_f32 v51, v51, v61
    v_mul_f32 v52, v52, v61
    v_mul_f32 v53, v53, v61
    v_mul_f32 v54, v54, v61
    v_mul_f32 v55, v55, v61
    v_cvt_pk_bf16_f32 v40, v40, v41
    v_cvt_pk_bf16_f32 v41, v42, v43
    v_cvt_pk_bf16_f32 v42, v44, v45
    v_cvt_pk_bf16_f32 v43, v46, v47
    v_cvt_pk_bf16_f32 v44, v48, v49
    v_cvt_pk_bf16_f32 v45, v50, v51
    v_cvt_pk_bf16_f32 v46, v52, v53
    v_cvt_pk_bf16_f32 v47, v54, v55
    buffer_store_dwordx4 v[40:43], v189, s[44:47], s64 offen sc1
    buffer_store_dwordx4 v[44:47], v189, s[44:47], s64 offen offset:512 sc1
    v_exp_f32 v240, v240
    v_exp_f32 v241, v241
    v_exp_f32 v242, v242
    s_waitcnt lgkmcnt(1)
    v_mfma_f32_32x32x16_bf16 v[24:39], v[104:107], v[128:131], 0
    v_exp_f32 v243, v243
    v_exp_f32 v244, v244
    v_exp_f32 v245, v245
    v_exp_f32 v246, v246
    v_exp_f32 v247, v247
    v_exp_f32 v248, v248
    s_waitcnt lgkmcnt(0)
    v_mfma_f32_32x32x16_bf16 v[24:39], v[108:111], v[132:135], v[24:39]
    ds_read_b128 v[104:107], v191 offset:2048
    ds_read_b128 v[108:111], v191 offset:3072
    v_exp_f32 v249, v249
    v_exp_f32 v250, v250
    v_exp_f32 v251, v251
    v_cvt_pk_bf16_f32 v152, v240, v241
    v_cvt_pk_bf16_f32 v153, v242, v243
    v_mfma_f32_16x16x32_bf16 v[56:59], v[184:187], v[128:131], 0
    v_exp_f32 v252, v252
    v_exp_f32 v253, v253
    v_exp_f32 v254, v254
    v_exp_f32 v255, v255
    v_cvt_pk_bf16_f32 v154, v244, v245
    v_mfma_f32_16x16x32_bf16 v[56:59], v[184:187], v[132:135], v[56:59]
    v_cvt_pk_bf16_f32 v155, v246, v247
    v_cvt_pk_bf16_f32 v156, v248, v249
    v_cvt_pk_bf16_f32 v157, v250, v251
    v_cvt_pk_bf16_f32 v158, v252, v253
    v_cvt_pk_bf16_f32 v159, v254, v255
    s_nop 1
    s_waitcnt lgkmcnt(1)
    v_mfma_f32_32x32x16_bf16 v[24:39], v[104:107], v[152:155], v[24:39]
    s_waitcnt lgkmcnt(0)
    v_mfma_f32_32x32x16_bf16 v[24:39], v[108:111], v[156:159], v[24:39]
    v_mfma_f32_16x16x32_bf16 v[56:59], v[184:187], v[152:155], v[56:59]
    v_mfma_f32_16x16x32_bf16 v[56:59], v[184:187], v[156:159], v[56:59]
    s_branch L_w1
L_z1:
    s_nop 7
    s_mov_b32 s88, 6
    s_nop 3
    v_cmp_le_f32 s[84:85], s34, v60
    v_cmp_ge_f32 s[86:87], s35, v60
    s_lshl_b32 s64, s88, 16
    s_add_u32 s64, s64, s89
    s_and_b64 s[84:85], s[84:85], s[86:87]
    s_cmp_eq_u64 s[84:85], -1
    s_cbranch_scc1 L_ok4
    s_call_b64 s[90:91], L_slowB
L_ok4:
    v_rcp_f32 v61, v60
    s_nop 0
    v_mul_f32 v40, v40, v61
    v_mul_f32 v41, v41, v61
    v_mul_f32 v42, v42, v61
    v_mul_f32 v43, v43, v61
    v_mul_f32 v44, v44, v61
    v_mul_f32 v45, v45, v61
    v_mul_f32 v46, v46, v61
    v_mul_f32 v47, v47, v61
    v_mul_f32 v48, v48, v61
    v_mul_f32 v49, v49, v61
    v_mul_f32 v50, v50, v61
    v_mul_f32 v51, v51, v61
    v_mul_f32 v52, v52, v61
    v_mul_f32 v53, v53, v61
    v_mul_f32 v54, v54, v61
    v_mul_f32 v55, v55, v61
    v_cvt_pk_bf16_f32 v40, v40, v41
    v_cvt_pk_bf16_f32 v41, v42, v43
    v_cvt_pk_bf16_f32 v42, v44, v45
    v_cvt_pk_bf16_f32 v43, v46, v47
    v_cvt_pk_bf16_f32 v44, v48, v49
    v_cvt_pk_bf16_f32 v45, v50, v51
    v_cvt_pk_bf16_f32 v46, v52, v53
    v_cvt_pk_bf16_f32 v47, v54, v55
    buffer_store_dwordx4 v[40:43], v189, s[44:47], s64 offen sc1
    buffer_store_dwordx4 v[44:47], v189, s[44:47], s64 offen offset:512 sc1
    ds_read_b128 v[80:83], v190 offset:0
    ds_read_b128 v[84:87], v190 offset:1024
    s_waitcnt lgkmcnt(1)
    v_mfma_f32_32x32x16_bf16 v[224:239], v[80:83], v[8:11], 0
    s_waitcnt lgkmcnt(0)
    v_mfma_f32_32x32x16_bf16 v[224:239], v[84:87], v[12:15], v[224:239]
    ds_read_b128 v[80:83], v190 offset:2048
    ds_read_b128 v[84:87], v190 offset:3072
    s_waitcnt lgkmcnt(1)
    v_mfma_f32_32x32x16_bf16 v[240:255], v[80:83], v[8:11], v[88:103]
    s_nop 7
    s_nop 3
    v_exp_f32 v224, v224
    v_exp_f32 v225, v225
    v_exp_f32 v226, v226
    v_exp_f32 v227, v227
    v_exp_f32 v228, v228
    v_exp_f32 v229, v229
    s_waitcnt lgkmcnt(0)
    v_mfma_f32_32x32x16_bf16 v[240:255], v[84:87], v[12:15], v[240:255]
    v_exp_f32 v230, v230
    v_exp_f32 v231, v231
    v_exp_f32 v232, v232
    ds_read_b128 v[104:107], v191 offset:0
    ds_read_b128 v[108:111], v191 offset:1024
    v_exp_f32 v233, v233
    v_exp_f32 v234, v234
    v_exp_f32 v235, v235
    v_cvt_pk_bf16_f32 v128, v224, v225
    v_cvt_pk_bf16_f32 v129, v226, v227
    v_exp_f32 v236, v236
    v_exp_f32 v237, v237
    v_exp_f32 v238, v238
    v_exp_f32 v239, v239
    v_cvt_pk_bf16_f32 v130, v228, v229
    v_cvt_pk_bf16_f32 v131, v230, v231
    v_cvt_pk_bf16_f32 v132, v232, v233
    v_cvt_pk_bf16_f32 v133, v234, v235
    v_cvt_pk_bf16_f32 v134, v236, v237
    v_cvt_pk_bf16_f32 v135, v238, v239
    v_exp_f32 v240, v240
    v_exp_f32 v241, v241
    v_exp_f32 v242, v242
    s_waitcnt lgkmcnt(1)
    v_mfma_f32_32x32x16_bf16 v[24:39], v[104:107], v[128:131], 0
    v_exp_f32 v243, v243
    v_exp_f32 v244, v244
    v_exp_f32 v245, v245
    v_exp_f32 v246, v246
    v_exp_f32 v247, v247
    v_exp_f32 v248, v248
    s_waitcnt lgkmcnt(0)
    v_mfma_f32_32x32x16_bf16 v[24:39], v[108:111], v[132:135], v[24:39]
    ds_read_b128 v[104:107], v191 offset:2048
    ds_read_b128 v[108:111], v191 offset:3072
    v_exp_f32 v249, v249
    v_exp_f32 v250, v250
    v_exp_f32 v251, v251
    v_cvt_pk_bf16_f32 v152, v240, v241
    v_cvt_pk_bf16_f32 v153, v242, v243
    v_mfma_f32_16x16x32_bf16 v[56:59], v[184:187], v[128:131], 0
    v_exp_f32 v252, v252
    v_exp_f32 v253, v253
    v_exp_f32 v254, v254
    v_exp_f32 v255, v255
    v_cvt_pk_bf16_f32 v154, v244, v245
    v_mfma_f32_16x16x32_bf16 v[56:59], v[184:187], v[132:135], v[56:59]
    v_cvt_pk_bf16_f32 v155, v246, v247
    v_cvt_pk_bf16_f32 v156, v248, v249
    v_cvt_pk_bf16_f32 v157, v250, v251
    v_cvt_pk_bf16_f32 v158, v252, v253
    v_cvt_pk_bf16_f32 v159, v254, v255
    s_nop 1
    s_waitcnt lgkmcnt(1)
    v_mfma_f32_32x32x16_bf16 v[24:39], v[104:107], v[152:155], v[24:39]
    s_waitcnt lgkmcnt(0)
    v_mfma_f32_32x32x16_bf16 v[24:39], v[108:111], v[156:159], v[24:39]
    v_mfma_f32_16x16x32_bf16 v[56:59], v[184:187], v[152:155], v[56:59]
    v_mfma_f32_16x16x32_bf16 v[56:59], v[184:187], v[156:159], v[56:59]
L_w1:
    s_waitcnt lgkmcnt(0)
    s_setprio 0
    s_barrier
    s_cmp_eq_u32 s61, 0
    s_cbranch_scc1 L_y1
    ds_read_b128 v[80:83], v196 offset:28672
    ds_read_b128 v[84:87], v196 offset:29696
    s_waitcnt lgkmcnt(1)
    v_mfma_f32_32x32x16_bf16 v[224:239], v[80:83], v[8:11], 0
    s_waitcnt lgkmcnt(0)
    v_mfma_f32_32x32x16_bf16 v[224:239], v[84:87], v[12:15], v[224:239]
    ds_read_b128 v[80:83], v196 offset:24576
    ds_read_b128 v[84:87], v196 offset:25600
    s_mov_b32 s88, 6
    s_lshl_b32 s64, s88, 8
    s_add_u32 s64, s64, s96
    v_mov_b32 v4, s77
    v_mov_b32 v5, s81
    v_mov_b32 v6, 0
    s_waitcnt vmcnt(0)
    s_mov_b64 exec, 1
    buffer_store_dwordx2 v[4:5], v6, s[44:47], s64 offen sc1
    s_mov_b64 exec, -1
    s_nop 3
    s_add_u32 m0, s82, 0
    s_mov_b32 s67, 0
    buffer_load_dwordx4 v188, s[48:51], s67 offen lds
    s_add_u32 m0, s82, 8192
    s_mov_b32 s67, 65536
    buffer_load_dwordx4 v188, s[48:51], s67 offen lds
    s_add_u32 m0, s82, 16384
    s_mov_b32 s67, 131072
    buffer_load_dwordx4 v188, s[48:51], s67 offen lds
    s_waitcnt lgkmcnt(1)
    v_mfma_f32_32x32x16_bf16 v[240:255], v[80:83], v[8:11], 0
    s_nop 7
    s_nop 3
    v_exp_f32 v224, v224
    v_exp_f32 v225, v225
    v_exp_f32 v226, v226
    v_exp_f32 v227, v227
    v_exp_f32 v228, v228
    v_exp_f32 v229, v229
    s_waitcnt lgkmcnt(0)
    v_mfma_f32_32x32x16_bf16 v[240:255], v[84:87], v[12:15], v[240:255]
    ds_read_b128 v[80:83], v196 offset:20480
    ds_read_b128 v[84:87], v196 offset:21504
    v_exp_f32 v230, v230
    v_exp_f32 v231, v231
    v_exp_f32 v232, v232
    ds_read_b128 v[104:107], v197 offset:28672
    ds_read_b128 v[108:111], v197 offset:29696
    v_exp_f32 v233, v233
    v_exp_f32 v234, v234
    v_exp_f32 v235, v235
    v_cvt_pk_bf16_f32 v128, v224, v225
    v_cvt_pk_bf16_f32 v129, v226, v227
    v_exp_f32 v236, v236
    v_exp_f32 v237, v237
    v_exp_f32 v238, v238
    v_exp_f32 v239, v239
    v_cvt_pk_bf16_f32 v130, v228, v229
    v_cvt_pk_bf16_f32 v131, v230, v231
    v_cvt_pk_bf16_f32 v132, v232, v233
    v_cvt_pk_bf16_f32 v133, v234, v235
    v_cvt_pk_bf16_f32 v134, v236, v237
    v_cvt_pk_bf16_f32 v135, v238, v239
    s_add_u32 m0, s82, 24576
    s_mov_b32 s67, 196608
    buffer_load_dwordx4 v188, s[48:51], s67 offen lds
    s_add_u32 m0, s82, 98304
    s_mov_b32 s67, 262144
    buffer_load_dwordx4 v188, s[48:51], s67 offen lds
    s_add_u32 m0, s82, 106496
    s_mov_b32 s67, 327680
    buffer_load_dwordx4 v188, s[48:51], s67 offen lds
    s_waitcnt lgkmcnt(3)
    v_mfma_f32_32x32x16_bf16 v[224:239], v[80:83], v[8:11], 0
    v_exp_f32 v240, v240
    v_exp_f32 v241, v241
    v_exp_f32 v242, v242
    s_waitcnt lgkmcnt(1)
    v_mfma_f32_32x32x16_bf16 v[24:39], v[104:107], v[128:131], v[24:39]
    v_exp_f32 v243, v243
    v_exp_f32 v244, v244
    v_exp_f32 v245, v245
    v_mfma_f32_32x32x16_bf16 v[224:239], v[84:87], v[12:15], v[224:239]
    ds_read_b128 v[80:83], v196 offset:16384
    ds_read_b128 v[84:87], v196 offset:17408
    v_exp_f32 v246, v246
    v_exp_f32 v247, v247
    v_exp_f32 v248, v248
    s_waitcnt lgkmcnt(2)
    v_mfma_f32_32x32x16_bf16 v[24:39], v[108:111], v[132:135], v[24:39]
    ds_read_b128 v[104:107], v197 offset:24576
    ds_read_b128 v[108:111], v197 offset:25600
    v_exp_f32 v249, v249
    v_exp_f32 v250, v250
    v_exp_f32 v251, v251
    v_cvt_pk_bf16_f32 v152, v240, v241
    v_cvt_pk_bf16_f32 v153, v242, v243
    v_mfma_f32_16x16x32_bf16 v[56:59], v[184:187], v[128:131], v[56:59]
    v_exp_f32 v252, v252
    v_exp_f32 v253, v253
    v_exp_f32 v254, v254
    v_exp_f32 v255, v255
    v_cvt_pk_bf16_f32 v154, v244, v245
    v_mfma_f32_16x16x32_bf16 v[56:59], v[184:187], v[132:135], v[56:59]
    v_cvt_pk_bf16_f32 v155, v246, v247
    v_cvt_pk_bf16_f32 v156, v248, v249
    v_cvt_pk_bf16_f32 v157, v250, v251
    v_cvt_pk_bf16_f32 v158, v252, v253
    v_cvt_pk_bf16_f32 v159, v254, v255
    s_add_u32 m0, s82, 114688
    s_mov_b32 s67, 393216
    buffer_load_dwordx4 v188, s[48:51], s67 offen lds
    s_add_u32 m0, s82, 122880
    s_mov_b32 s67, 458752
    buffer_load_dwordx4 v188, s[48:51], s67 offen lds
    s_add_u32 m0, s82, 131072
    s_mov_b32 s67, 524288
    buffer_load_dwordx4 v188, s[48:51], s67 offen lds
    s_lshl_b32 s66, s74, 3
    s_add_u32 s66, s66, 155648
    v_mov_b32 v198, s66
    s_waitcnt lgkmcnt(0)
    s_mov_b32 s72, 0x400000
L_wl1b:
    ds_read_b64 v[2:3], v198 offset:0
    s_waitcnt lgkmcnt(0)
    v_readfirstlane_b32 s66, v2
    v_readfirstlane_b32 s67, v3
    s_cmp_eq_u32 s66, s77
    s_cselect_b32 s66, 1, 0
    s_cmp_eq_u32 s67, s81
    s_cselect_b32 s66, s66, 0
    s_cmp_lg_u32 s66, 0
    s_cbranch_scc1 L_wd1b
    s_sub_u32 s72, s72, 1
    s_cmp_eq_u32 s72, 0
    s_cbranch_scc1 L_wd1b
    s_sleep 1
    s_branch L_wl1b
L_wd1b:
    v_mfma_f32_32x32x16_bf16 v[240:255], v[80:83], v[8:11], 0
    v_exp_f32 v224, v224
    v_exp_f32 v225, v225
    v_exp_f32 v226, v226
    v_mfma_f32_32x32x16_bf16 v[24:39], v[104:107], v[152:155], v[24:39]
    v_exp_f32 v227, v227
    v_exp_f32 v228, v228
    v_exp_f32 v229, v229
    v_mfma_f32_32x32x16_bf16 v[240:255], v[84:87], v[12:15], v[240:255]
    ds_read_b128 v[80:83], v196 offset:12288
    ds_read_b128 v[84:87], v196 offset:13312
    v_exp_f32 v230, v230
    v_exp_f32 v231, v231
    v_exp_f32 v232, v232
    v_mfma_f32_32x32x16_bf16 v[24:39], v[108:111], v[156:159], v[24:39]
    ds_read_b128 v[104:107], v197 offset:20480
    ds_read_b128 v[108:111], v197 offset:21504
    v_exp_f32 v233, v233
    v_exp_f32 v234, v234
    v_exp_f32 v235, v235
    v_cvt_pk_bf16_f32 v128, v224, v225
    v_cvt_pk_bf16_f32 v129, v226, v227
    v_mfma_f32_16x16x32_bf16 v[56:59], v[184:187], v[152:155], v[56:59]
    v_exp_f32 v236, v236
    v_exp_f32 v237, v237
    v_exp_f32 v238, v238
    v_exp_f32 v239, v239
    v_cvt_pk_bf16_f32 v130, v228, v229
    v_mfma_f32_16x16x32_bf16 v[56:59], v[184:187], v[156:159], v[56:59]
    v_cvt_pk_bf16_f32 v131, v230, v231
    v_cvt_pk_bf16_f32 v132, v232, v233
    v_cvt_pk_bf16_f32 v133, v234, v235
    v_cvt_pk_bf16_f32 v134, v236, v237
    v_cvt_pk_bf16_f32 v135, v238, v239
    s_add_u32 m0, s82, 139264
    s_mov_b32 s67, 589824
    buffer_load_dwordx4 v188, s[48:51], s67 offen lds
    s_add_u32 m0, s82, 147456
    s_mov_b32 s67, 655360
    buffer_load_dwordx4 v188, s[48:51], s67 offen lds
    s_waitcnt lgkmcnt(3)
    v_mfma_f32_32x32x16_bf16 v[224:239], v[80:83], v[8:11], 0
    v_exp_f32 v240, v240
    v_exp_f32 v241, v241
    v_exp_f32 v242, v242
    s_waitcnt lgkmcnt(1)
    v_mfma_f32_32x32x16_bf16 v[24:39], v[104:107], v[128:131], v[24:39]
    v_exp_f32 v243, v243
    v_exp_f32 v244, v244
    v_exp_f32 v245, v245
    v_mfma_f32_32x32x16_bf16 v[224:239], v[84:87], v[12:15], v[224:239]
    ds_read_b128 v[80:83], v196 offset:8192
    ds_read_b128 v[84:87], v196 offset:9216
    v_exp_f32 v246, v246
    v_exp_f32 v247, v247
    v_exp_f32 v248, v248
    s_waitcnt lgkmcnt(2)
    v_mfma_f32_32x32x16_bf16 v[24:39], v[108:111], v[132:135], v[24:39]
    ds_read_b128 v[104:107], v197 offset:16384
    ds_read_b128 v[108:111], v197 offset:17408
    v_exp_f32 v249, v249
    v_exp_f32 v250, v250
    v_exp_f32 v251, v251
    v_cvt_pk_bf16_f32 v152, v240, v241
    v_cvt_pk_bf16_f32 v153, v242, v243
    v_mfma_f32_16x16x32_bf16 v[56:59], v[184:187], v[128:131], v[56:59]
    v_exp_f32 v252, v252
    v_exp_f32 v253, v253
    v_exp_f32 v254, v254
    v_exp_f32 v255, v255
    v_cvt_pk_bf16_f32 v154, v244, v245
    v_mfma_f32_16x16x32_bf16 v[56:59], v[184:187], v[132:135], v[56:59]
    v_cvt_pk_bf16_f32 v155, v246, v247
    v_cvt_pk_bf16_f32 v156, v248, v249
    v_cvt_pk_bf16_f32 v157, v250, v251
    v_cvt_pk_bf16_f32 v158, v252, v253
    v_cvt_pk_bf16_f32 v159, v254, v255
    s_waitcnt lgkmcnt(3)
    v_mfma_f32_32x32x16_bf16 v[240:255], v[80:83], v[8:11], 0
    v_exp_f32 v224, v224
    v_exp_f32 v225, v225
    v_exp_f32 v226, v226
    s_waitcnt lgkmcnt(1)
    v_mfma_f32_32x32x16_bf16 v[24:39], v[104:107], v[152:155], v[24:39]
    v_exp_f32 v227, v227
    v_exp_f32 v228, v228
    v_exp_f32 v229, v229
    v_mfma_f32_32x32x16_bf16 v[240:255], v[84:87], v[12:15], v[240:255]
    ds_read_b128 v[80:83], v196 offset:4096
    ds_read_b128 v[84:87], v196 offset:5120
    v_exp_f32 v230, v230
    v_exp_f32 v231, v231
    v_exp_f32 v232, v232
    s_waitcnt lgkmcnt(2)
    v_mfma_f32_32x32x16_bf16 v[24:39], v[108:111], v[156:159], v[24:39]
    ds_read_b128 v[104:107], v197 offset:12288
    ds_read_b128 v[108:111], v197 offset:13312
    v_exp_f32 v233, v233
    v_exp_f32 v234, v234
    v_exp_f32 v235, v235
    v_cvt_pk_bf16_f32 v128, v224, v225
    v_cvt_pk_bf16_f32 v129, v226, v227
    v_mfma_f32_16x16x32_bf16 v[56:59], v[184:187], v[152:155], v[56:59]
    v_exp_f32 v236, v236
    v_exp_f32 v237, v237
    v_exp_f32 v238, v238
    v_exp_f32 v239, v239
    v_cvt_pk_bf16_f32 v130, v228, v229
    v_mfma_f32_16x16x32_bf16 v[56:59], v[184:187], v[156:159], v[56:59]
    v_cvt_pk_bf16_f32 v131, v230, v231
    v_cvt_pk_bf16_f32 v132, v232, v233
    v_cvt_pk_bf16_f32 v133, v234, v235
    v_cvt_pk_bf16_f32 v134, v236, v237
    v_cvt_pk_bf16_f32 v135, v238, v239
    s_waitcnt lgkmcnt(3)
    v_mfma_f32_32x32x16_bf16 v[224:239], v[80:83], v[8:11], v[136:151]
    v_exp_f32 v240, v240
    v_exp_f32 v241, v241
    v_exp_f32 v242, v242
    s_waitcnt lgkmcnt(1)
    v_mfma_f32_32x32x16_bf16 v[24:39], v[104:107], v[128:131], v[24:39]
    v_exp_f32 v243, v243
    v_exp_f32 v244, v244
    v_exp_f32 v245, v245
    v_mfma_f32_32x32x16_bf16 v[224:239], v[84:87], v[12:15], v[224:239]
    v_exp_f32 v246, v246
    v_exp_f32 v247, v247
    v_exp_f32 v248, v248
    s_waitcnt lgkmcnt(0)
    v_mfma_f32_32x32x16_bf16 v[24:39], v[108:111], v[132:135], v[24:39]
    ds_read_b128 v[104:107], v197 offset:8192
    ds_read_b128 v[108:111], v197 offset:9216
    v_exp_f32 v249, v249
    v_exp_f32 v250, v250
    v_exp_f32 v251, v251
    v_cvt_pk_bf16_f32 v152, v240, v241
    v_cvt_pk_bf16_f32 v153, v242, v243
    v_mfma_f32_16x16x32_bf16 v[56:59], v[184:187], v[128:131], v[56:59]
    v_exp_f32 v252, v252
    v_exp_f32 v253, v253
    v_exp_f32 v254, v254
    v_exp_f32 v255, v255
    v_cvt_pk_bf16_f32 v154, v244, v245
    v_mfma_f32_16x16x32_bf16 v[56:59], v[184:187], v[132:135], v[56:59]
    v_cvt_pk_bf16_f32 v155, v246, v247
    v_cvt_pk_bf16_f32 v156, v248, v249
    v_cvt_pk_bf16_f32 v157, v250, v251
    v_cvt_pk_bf16_f32 v158, v252, v253
    v_cvt_pk_bf16_f32 v159, v254, v255
    s_lshr_b32 s73, s63, 2
    s_and_b32 s76, s63, 3
    s_lshl_b32 s64, s60, 3
    s_add_u32 s64, s64, s79
    s_lshl_b32 s65, s64, 3
    s_add_u32 s65, s65, s76
    s_lshl_b32 s71, s65, 8
    s_lshl_b32 s66, s73, 7
    s_add_u32 s71, s71, s66
    s_add_u32 s71, s71, 25231360
    v_and_b32 v7, 15, v0
    v_lshlrev_b32 v7, 3, v7
    s_lshl_b32 s70, s65, 16
    s_lshl_b32 s66, s73, 14
    s_add_u32 s70, s70, s66
    s_add_u32 s70, s70, 17039360
    v_add_u32 v192, 0x8000, v1
    s_and_b32 s66, s80, 0
    s_lshl_b32 s66, s66, 10
    s_add_u32 s70, s70, s66
    buffer_load_dwordx2 v[2:3], v7, s[44:47], s71 offen offset:1024 sc1
    v_exp_f32 v224, v224
    v_exp_f32 v225, v225
    v_exp_f32 v226, v226
    s_waitcnt lgkmcnt(1)
    v_mfma_f32_32x32x16_bf16 v[24:39], v[104:107], v[152:155], v[24:39]
    v_exp_f32 v227, v227
    v_exp_f32 v228, v228
    v_exp_f32 v229, v229
    v_exp_f32 v230, v230
    v_exp_f32 v231, v231
    v_exp_f32 v232, v232
    s_waitcnt lgkmcnt(0)
    v_mfma_f32_32x32x16_bf16 v[24:39], v[108:111], v[156:159], v[24:39]
    ds_read_b128 v[104:107], v197 offset:4096
    ds_read_b128 v[108:111], v197 offset:5120
    v_exp_f32 v233, v233
    v_exp_f32 v234, v234
    v_exp_f32 v235, v235
    v_cvt_pk_bf16_f32 v128, v224, v225
    v_cvt_pk_bf16_f32 v129, v226, v227
    v_mfma_f32_16x16x32_bf16 v[56:59], v[184:187], v[152:155], v[56:59]
    v_exp_f32 v236, v236
    v_exp_f32 v237, v237
    v_exp_f32 v238, v238
    v_exp_f32 v239, v239
    v_cvt_pk_bf16_f32 v130, v228, v229
    v_mfma_f32_16x16x32_bf16 v[56:59], v[184:187], v[156:159], v[56:59]
    v_cvt_pk_bf16_f32 v131, v230, v231
    v_cvt_pk_bf16_f32 v132, v232, v233
    v_cvt_pk_bf16_f32 v133, v234, v235
    v_cvt_pk_bf16_f32 v134, v236, v237
    v_cvt_pk_bf16_f32 v135, v238, v239
    s_nop 1
    s_waitcnt lgkmcnt(1)
    v_mfma_f32_32x32x16_bf16 v[24:39], v[104:107], v[128:131], v[24:39]
    s_waitcnt lgkmcnt(0)
    v_mfma_f32_32x32x16_bf16 v[24:39], v[108:111], v[132:135], v[24:39]
    v_mfma_f32_16x16x32_bf16 v[56:59], v[184:187], v[128:131], v[56:59]
    v_mfma_f32_16x16x32_bf16 v[56:59], v[184:187], v[132:135], v[56:59]
    s_mov_b32 s88, 1
    s_nop 7
    s_branch L_last
L_y1:
    s_mov_b32 s88, 6
    s_lshl_b32 s64, s88, 8
    s_add_u32 s64, s64, s96
    v_mov_b32 v4, s77
    v_mov_b32 v5, s81
    v_mov_b32 v6, 0
    s_waitcnt vmcnt(0)
    s_mov_b64 exec, 1
    buffer_store_dwordx2 v[4:5], v6, s[44:47], s64 offen sc1
    s_mov_b64 exec, -1
    s_nop 3
    s_add_u32 m0, s82, 0
    s_mov_b32 s67, 0
    buffer_load_dwordx4 v188, s[48:51], s67 offen lds
    s_add_u32 m0, s82, 8192
    s_mov_b32 s67, 65536
    buffer_load_dwordx4 v188, s[48:51], s67 offen lds
    s_add_u32 m0, s82, 16384
    s_mov_b32 s67, 131072
    buffer_load_dwordx4 v188, s[48:51], s67 offen lds
    s_add_u32 m0, s82, 24576
    s_mov_b32 s67, 196608
    buffer_load_dwordx4 v188, s[48:51], s67 offen lds
    s_add_u32 m0, s82, 98304
    s_mov_b32 s67, 262144
    buffer_load_dwordx4 v188, s[48:51], s67 offen lds
    s_add_u32 m0, s82, 106496
    s_mov_b32 s67, 327680
    buffer_load_dwordx4 v188, s[48:51], s67 offen lds
    s_add_u32 m0, s82, 114688
    s_mov_b32 s67, 393216
    buffer_load_dwordx4 v188, s[48:51], s67 offen lds
    s_add_u32 m0, s82, 122880
    s_mov_b32 s67, 458752
    buffer_load_dwordx4 v188, s[48:51], s67 offen lds
    s_add_u32 m0, s82, 131072
    s_mov_b32 s67, 524288
    buffer_load_dwordx4 v188, s[48:51], s67 offen lds
    s_add_u32 m0, s82, 139264
    s_mov_b32 s67, 589824
    buffer_load_dwordx4 v188, s[48:51], s67 offen lds
    s_add_u32 m0, s82, 147456
    s_mov_b32 s67, 655360
    buffer_load_dwordx4 v188, s[48:51], s67 offen lds
    s_lshr_b32 s73, s63, 2
    s_and_b32 s76, s63, 3
    s_lshl_b32 s64, s60, 3
    s_add_u32 s64, s64, s79
    s_lshl_b32 s65, s64, 3
    s_add_u32 s65, s65, s76
    s_lshl_b32 s71, s65, 8
    s_lshl_b32 s66, s73, 7
    s_add_u32 s71, s71, s66
    s_add_u32 s71, s71, 25231360
    v_and_b32 v7, 15, v0
    v_lshlrev_b32 v7, 3, v7
    s_lshl_b32 s70, s65, 16
    s_lshl_b32 s66, s73, 14
    s_add_u32 s70, s70, s66
    s_add_u32 s70, s70, 17039360
    v_add_u32 v192, 0x8000, v1
    s_and_b32 s66, s80, 0
    s_lshl_b32 s66, s66, 10
    s_add_u32 s70, s70, s66
    buffer_load_dwordx2 v[2:3], v7, s[44:47], s71 offen offset:1024 sc1
    s_waitcnt lgkmcnt(0)
    s_mov_b32 s88, 1
    s_branch L_last
L_u2:
    v_add_u32 v4, v198, v1
    ds_read_b128 v[16:19], v4 offset:10240
    ds_read_b128 v[20:23], v4 offset:11264
    ds_read_b128 v[8:11], v4 offset:4096
    ds_read_b128 v[12:15], v4 offset:5120
    s_waitcnt lgkmcnt(2)
    ds_read_b128 v[80:83], v190 offset:0
    ds_read_b128 v[84:87], v190 offset:1024
    s_waitcnt lgkmcnt(1)
    v_mfma_f32_32x32x16_bf16 v[224:239], v[80:83], v[16:19], 0
    s_waitcnt lgkmcnt(0)
    v_mfma_f32_32x32x16_bf16 v[224:239], v[84:87], v[20:23], v[224:239]
    ds_read_b128 v[80:83], v190 offset:2048
    ds_read_b128 v[84:87], v190 offset:3072
    s_waitcnt lgkmcnt(1)
    v_mfma_f32_32x32x16_bf16 v[240:255], v[80:83], v[16:19], 0
    s_nop 7
    s_nop 3
    v_exp_f32 v224, v224
    v_exp_f32 v225, v225
    v_exp_f32 v226, v226
    v_exp_f32 v227, v227
    v_exp_f32 v228, v228
    v_exp_f32 v229, v229
    s_waitcnt lgkmcnt(0)
    v_mfma_f32_32x32x16_bf16 v[240:255], v[84:87], v[20:23], v[240:255]
    ds_read_b128 v[80:83], v190 offset:4096
    ds_read_b128 v[84:87], v190 offset:5120
    v_exp_f32 v230, v230
    v_exp_f32 v231, v231
    v_exp_f32 v232, v232
    ds_read_b128 v[104:107], v191 offset:0
    ds_read_b128 v[108:111], v191 offset:1024
    v_exp_f32 v233, v233
    v_exp_f32 v234, v234
    v_exp_f32 v235, v235
    v_cvt_pk_bf16_f32 v128, v224, v225
    v_cvt_pk_bf16_f32 v129, v226, v227
    v_exp_f32 v236, v236
    v_exp_f32 v237, v237
    v_exp_f32 v238, v238
    v_exp_f32 v239, v239
    v_cvt_pk_bf16_f32 v130, v228, v229
    v_cvt_pk_bf16_f32 v131, v230, v231
    v_cvt_pk_bf16_f32 v132, v232, v233
    v_cvt_pk_bf16_f32 v133, v234, v235
    v_cvt_pk_bf16_f32 v134, v236, v237
    v_cvt_pk_bf16_f32 v135, v238, v239
    s_waitcnt lgkmcnt(3)
    v_mfma_f32_32x32x16_bf16 v[224:239], v[80:83], v[16:19], 0
    v_exp_f32 v240, v240
    v_exp_f32 v241, v241
    v_exp_f32 v242, v242
    s_waitcnt lgkmcnt(1)
    v_mfma_f32_32x32x16_bf16 v[40:55], v[104:107], v[128:131], 0
    v_exp_f32 v243, v243
    v_exp_f32 v244, v244
    v_exp_f32 v245, v245
    v_mfma_f32_32x32x16_bf16 v[224:239], v[84:87], v[20:23], v[224:239]
    ds_read_b128 v[80:83], v190 offset:6144
    ds_read_b128 v[84:87], v190 offset:7168
    v_exp_f32 v246, v246
    v_exp_f32 v247, v247
    v_exp_f32 v248, v248
    s_waitcnt lgkmcnt(2)
    v_mfma_f32_32x32x16_bf16 v[40:55], v[108:111], v[132:135], v[40:55]
    ds_read_b128 v[104:107], v191 offset:2048
    ds_read_b128 v[108:111], v191 offset:3072
    v_exp_f32 v249, v249
    v_exp_f32 v250, v250
    v_exp_f32 v251, v251
    v_cvt_pk_bf16_f32 v152, v240, v241
    v_cvt_pk_bf16_f32 v153, v242, v243
    v_mfma_f32_16x16x32_bf16 v[60:63], v[184:187], v[128:131], 0
    v_exp_f32 v252, v252
    v_exp_f32 v253, v253
    v_exp_f32 v254, v254
    v_exp_f32 v255, v255
    v_cvt_pk_bf16_f32 v154, v244, v245
    v_mfma_f32_16x16x32_bf16 v[60:63], v[184:187], v[132:135], v[60:63]
    v_cvt_pk_bf16_f32 v155, v246, v247
    v_cvt_pk_bf16_f32 v156, v248, v249
    v_cvt_pk_bf16_f32 v157, v250, v251
    v_cvt_pk_bf16_f32 v158, v252, v253
    v_cvt_pk_bf16_f32 v159, v254, v255
    s_waitcnt lgkmcnt(3)
    v_mfma_f32_32x32x16_bf16 v[240:255], v[80:83], v[16:19], 0
    v_exp_f32 v224, v224
    v_exp_f32 v225, v225
    v_exp_f32 v226, v226
    s_waitcnt lgkmcnt(1)
    v_mfma_f32_32x32x16_bf16 v[40:55], v[104:107], v[152:155], v[40:55]
    v_exp_f32 v227, v227
    v_exp_f32 v228, v228
    v_exp_f32 v229, v229
    v_mfma_f32_32x32x16_bf16 v[240:255], v[84:87], v[20:23], v[240:255]
    ds_read_b128 v[80:83], v190 offset:8192
    ds_read_b128 v[84:87], v190 offset:9216
    v_exp_f32 v230, v230
    v_exp_f32 v231, v231
    v_exp_f32 v232, v232
    s_waitcnt lgkmcnt(2)
    v_mfma_f32_32x32x16_bf16 v[40:55], v[108:111], v[156:159], v[40:55]
    ds_read_b128 v[104:107], v191 offset:4096
    ds_read_b128 v[108:111], v191 offset:5120
    v_exp_f32 v233, v233
    v_exp_f32 v234, v234
    v_exp_f32 v235, v235
    v_cvt_pk_bf16_f32 v128, v224, v225
    v_cvt_pk_bf16_f32 v129, v226, v227
    v_mfma_f32_16x16x32_bf16 v[60:63], v[184:187], v[152:155], v[60:63]
    v_exp_f32 v236, v236
    v_exp_f32 v237, v237
    v_exp_f32 v238, v238
    v_exp_f32 v239, v239
    v_cvt_pk_bf16_f32 v130, v228, v229
    v_mfma_f32_16x16x32_bf16 v[60:63], v[184:187], v[156:159], v[60:63]
    v_cvt_pk_bf16_f32 v131, v230, v231
    v_cvt_pk_bf16_f32 v132, v232, v233
    v_cvt_pk_bf16_f32 v133, v234, v235
    v_cvt_pk_bf16_f32 v134, v236, v237
    v_cvt_pk_bf16_f32 v135, v238, v239
    s_waitcnt lgkmcnt(3)
    v_mfma_f32_32x32x16_bf16 v[224:239], v[80:83], v[16:19], 0
    v_exp_f32 v240, v240
    v_exp_f32 v241, v241
    v_exp_f32 v242, v242
    s_waitcnt lgkmcnt(1)
    v_mfma_f32_32x32x16_bf16 v[40:55], v[104:107], v[128:131], v[40:55]
    v_exp_f32 v243, v243
    v_exp_f32 v244, v244
    v_exp_f32 v245, v245
    v_mfma_f32_32x32x16_bf16 v[224:239], v[84:87], v[20:23], v[224:239]
    ds_read_b128 v[80:83], v190 offset:10240
    ds_read_b128 v[84:87], v190 offset:11264
    v_exp_f32 v246, v246
    v_exp_f32 v247, v247
    v_exp_f32 v248, v248
    s_waitcnt lgkmcnt(2)
    v_mfma_f32_32x32x16_bf16 v[40:55], v[108:111], v[132:135], v[40:55]
    ds_read_b128 v[104:107], v191 offset:6144
    ds_read_b128 v[108:111], v191 offset:7168
    v_exp_f32 v249, v249
    v_exp_f32 v250, v250
    v_exp_f32 v251, v251
    v_cvt_pk_bf16_f32 v152, v240, v241
    v_cvt_pk_bf16_f32 v153, v242, v243
    v_mfma_f32_16x16x32_bf16 v[60:63], v[184:187], v[128:131], v[60:63]
    v_exp_f32 v252, v252
    v_exp_f32 v253, v253
    v_exp_f32 v254, v254
    v_exp_f32 v255, v255
    v_cvt_pk_bf16_f32 v154, v244, v245
    v_mfma_f32_16x16x32_bf16 v[60:63], v[184:187], v[132:135], v[60:63]
    v_cvt_pk_bf16_f32 v155, v246, v247
    v_cvt_pk_bf16_f32 v156, v248, v249
    v_cvt_pk_bf16_f32 v157, v250, v251
    v_cvt_pk_bf16_f32 v158, v252, v253
    v_cvt_pk_bf16_f32 v159, v254, v255
    s_waitcnt lgkmcnt(3)
    v_mfma_f32_32x32x16_bf16 v[240:255], v[80:83], v[16:19], v[88:103]
    v_exp_f32 v224, v224
    v_exp_f32 v225, v225
    v_exp_f32 v226, v226
    s_waitcnt lgkmcnt(1)
    v_mfma_f32_32x32x16_bf16 v[40:55], v[104:107], v[152:155], v[40:55]
    v_exp_f32 v227, v227
    v_exp_f32 v228, v228
    v_exp_f32 v229, v229
    v_mfma_f32_32x32x16_bf16 v[240:255], v[84:87], v[20:23], v[240:255]
    v_exp_f32 v230, v230
    v_exp_f32 v231, v231
    v_exp_f32 v232, v232
    s_waitcnt lgkmcnt(0)
    v_mfma_f32_32x32x16_bf16 v[40:55], v[108:111], v[156:159], v[40:55]
    ds_read_b128 v[104:107], v191 offset:8192
    ds_read_b128 v[108:111], v191 offset:9216
    v_exp_f32 v233, v233
    v_exp_f32 v234, v234
    v_exp_f32 v235, v235
    v_cvt_pk_bf16_f32 v128, v224, v225
    v_cvt_pk_bf16_f32 v129, v226, v227
    v_mfma_f32_16x16x32_bf16 v[60:63], v[184:187], v[152:155], v[60:63]
    v_exp_f32 v236, v236
    v_exp_f32 v237, v237
    v_exp_f32 v238, v238
    v_exp_f32 v239, v239
    v_cvt_pk_bf16_f32 v130, v228, v229
    v_mfma_f32_16x16x32_bf16 v[60:63], v[184:187], v[156:159], v[60:63]
    v_cvt_pk_bf16_f32 v131, v230, v231
    v_cvt_pk_bf16_f32 v132, v232, v233
    v_cvt_pk_bf16_f32 v133, v234, v235
    v_cvt_pk_bf16_f32 v134, v236, v237
    v_cvt_pk_bf16_f32 v135, v238, v239
    v_exp_f32 v240, v240
    v_exp_f32 v241, v241
    v_exp_f32 v242, v242
    s_waitcnt lgkmcnt(1)
    v_mfma_f32_32x32x16_bf16 v[40:55], v[104:107], v[128:131], v[40:55]
    v_exp_f32 v243, v243
    v_exp_f32 v244, v244
    v_exp_f32 v245, v245
    v_exp_f32 v246, v246
    v_exp_f32 v247, v247
    v_exp_f32 v248, v248
    s_waitcnt lgkmcnt(0)
    v_mfma_f32_32x32x16_bf16 v[40:55], v[108:111], v[132:135], v[40:55]
    ds_read_b128 v[104:107], v191 offset:10240
    ds_read_b128 v[108:111], v191 offset:11264
    v_exp_f32 v249, v249
    v_exp_f32 v250, v250
    v_exp_f32 v251, v251
    v_cvt_pk_bf16_f32 v152, v240, v241
    v_cvt_pk_bf16_f32 v153, v242, v243
    v_mfma_f32_16x16x32_bf16 v[60:63], v[184:187], v[128:131], v[60:63]
    v_exp_f32 v252, v252
    v_exp_f32 v253, v253
    v_exp_f32 v254, v254
    v_exp_f32 v255, v255
    v_cvt_pk_bf16_f32 v154, v244, v245
    v_mfma_f32_16x16x32_bf16 v[60:63], v[184:187], v[132:135], v[60:63]
    v_cvt_pk_bf16_f32 v155, v246, v247
    v_cvt_pk_bf16_f32 v156, v248, v249
    v_cvt_pk_bf16_f32 v157, v250, v251
    v_cvt_pk_bf16_f32 v158, v252, v253
    v_cvt_pk_bf16_f32 v159, v254, v255
    s_nop 1
    s_waitcnt lgkmcnt(1)
    v_mfma_f32_32x32x16_bf16 v[40:55], v[104:107], v[152:155], v[40:55]
    s_waitcnt lgkmcnt(0)
    v_mfma_f32_32x32x16_bf16 v[40:55], v[108:111], v[156:159], v[40:55]
    v_mfma_f32_16x16x32_bf16 v[60:63], v[184:187], v[152:155], v[60:63]
    v_mfma_f32_16x16x32_bf16 v[60:63], v[184:187], v[156:159], v[60:63]
    s_waitcnt lgkmcnt(0)
    s_cmp_eq_u32 s61, 0
    s_cbranch_scc1 L_z2
    s_mov_b32 s72, 0x400000
L_wl2a:
    ds_read_b64 v[2:3], v198 offset:2048
    s_waitcnt lgkmcnt(0)
    v_readfirstlane_b32 s66, v2
    v_readfirstlane_b32 s67, v3
    s_cmp_eq_u32 s66, s77
    s_cselect_b32 s66, 1, 0
    s_cmp_eq_u32 s67, s81
    s_cselect_b32 s66, s66, 0
    s_cmp_lg_u32 s66, 0
    s_cbranch_scc1 L_wd2a
    s_sub_u32 s72, s72, 1
    s_cmp_eq_u32 s72, 0
    s_cbranch_scc1 L_wd2a
    s_sleep 1
    s_branch L_wl2a
L_wd2a:
    ds_read_b128 v[80:83], v196 offset:20480
    ds_read_b128 v[84:87], v196 offset:21504
    s_waitcnt lgkmcnt(1)
    v_mfma_f32_32x32x16_bf16 v[224:239], v[80:83], v[16:19], v[136:151]
    s_waitcnt lgkmcnt(0)
    v_mfma_f32_32x32x16_bf16 v[224:239], v[84:87], v[20:23], v[224:239]
    ds_read_b128 v[80:83], v196 offset:24576
    ds_read_b128 v[84:87], v196 offset:25600
    s_waitcnt lgkmcnt(1)
    v_mfma_f32_32x32x16_bf16 v[240:255], v[80:83], v[16:19], 0
    s_nop 7
    s_nop 3
    v_exp_f32 v224, v224
    v_exp_f32 v225, v225
    v_exp_f32 v226, v226
    v_exp_f32 v227, v227
    v_exp_f32 v228, v228
    v_exp_f32 v229, v229
    s_waitcnt lgkmcnt(0)
    v_mfma_f32_32x32x16_bf16 v[240:255], v[84:87], v[20:23], v[240:255]
    ds_read_b128 v[80:83], v196 offset:28672
    ds_read_b128 v[84:87], v196 offset:29696
    v_exp_f32 v230, v230
    v_exp_f32 v231, v231
    v_exp_f32 v232, v232
    ds_read_b128 v[104:107], v197 offset:20480
    ds_read_b128 v[108:111], v197 offset:21504
    v_exp_f32 v233, v233
    v_exp_f32 v234, v234
    v_exp_f32 v235, v235
    v_cvt_pk_bf16_f32 v128, v224, v225
    v_cvt_pk_bf16_f32 v129, v226, v227
    v_exp_f32 v236, v236
    v_exp_f32 v237, v237
    v_exp_f32 v238, v238
    v_exp_f32 v239, v239
    v_cvt_pk_bf16_f32 v130, v228, v229
    v_cvt_pk_bf16_f32 v131, v230, v231
    v_cvt_pk_bf16_f32 v132, v232, v233
    v_cvt_pk_bf16_f32 v133, v234, v235
    v_cvt_pk_bf16_f32 v134, v236, v237
    v_cvt_pk_bf16_f32 v135, v238, v239
    s_waitcnt lgkmcnt(3)
    v_mfma_f32_32x32x16_bf16 v[224:239], v[80:83], v[16:19], 0
    v_exp_f32 v240, v240
    v_exp_f32 v241, v241
    v_exp_f32 v242, v242
    s_waitcnt lgkmcnt(1)
    v_mfma_f32_32x32x16_bf16 v[40:55], v[104:107], v[128:131], v[40:55]
    v_exp_f32 v243, v243
    v_exp_f32 v244, v244
    v_exp_f32 v245, v245
    v_mfma_f32_32x32x16_bf16 v[224:239], v[84:87], v[20:23], v[224:239]
    ds_read_b128 v[80:83], v190 offset:0
    ds_read_b128 v[84:87], v190 offset:1024
    v_exp_f32 v246, v246
    v_exp_f32 v247, v247
    v_exp_f32 v248, v248
    s_waitcnt lgkmcnt(2)
    v_mfma_f32_32x32x16_bf16 v[40:55], v[108:111], v[132:135], v[40:55]
    ds_read_b128 v[104:107], v197 offset:24576
    ds_read_b128 v[108:111], v197 offset:25600
    v_exp_f32 v249, v249
    v_exp_f32 v250, v250
    v_exp_f32 v251, v251
    v_cvt_pk_bf16_f32 v152, v240, v241
    v_cvt_pk_bf16_f32 v153, v242, v243
    v_mfma_f32_16x16x32_bf16 v[60:63], v[184:187], v[128:131], v[60:63]
    v_exp_f32 v252, v252
    v_exp_f32 v253, v253
    v_exp_f32 v254, v254
    v_exp_f32 v255, v255
    v_cvt_pk_bf16_f32 v154, v244, v245
    v_mfma_f32_16x16x32_bf16 v[60:63], v[184:187], v[132:135], v[60:63]
    v_cvt_pk_bf16_f32 v155, v246, v247
    v_cvt_pk_bf16_f32 v156, v248, v249
    v_cvt_pk_bf16_f32 v157, v250, v251
    v_cvt_pk_bf16_f32 v158, v252, v253
    v_cvt_pk_bf16_f32 v159, v254, v255
    s_waitcnt lgkmcnt(3)
    v_mfma_f32_32x32x16_bf16 v[240:255], v[80:83], v[8:11], 0
    v_exp_f32 v224, v224
    v_exp_f32 v225, v225
    v_exp_f32 v226, v226
    s_waitcnt lgkmcnt(1)
    v_mfma_f32_32x32x16_bf16 v[40:55], v[104:107], v[152:155], v[40:55]
    v_exp_f32 v227, v227
    v_exp_f32 v228, v228
    v_exp_f32 v229, v229
    v_mfma_f32_32x32x16_bf16 v[240:255], v[84:87], v[12:15], v[240:255]
    ds_read_b128 v[80:83], v190 offset:2048
    ds_read_b128 v[84:87], v190 offset:3072
    v_exp_f32 v230, v230
    v_exp_f32 v231, v231
    v_exp_f32 v232, v232
    s_waitcnt lgkmcnt(2)
    v_mfma_f32_32x32x16_bf16 v[40:55], v[108:111], v[156:159], v[40:55]
    ds_read_b128 v[104:107], v197 offset:28672
    ds_read_b128 v[108:111], v197 offset:29696
    v_exp_f32 v233, v233
    v_exp_f32 v234, v234
    v_exp_f32 v235, v235
    v_cvt_pk_bf16_f32 v128, v224, v225
    v_cvt_pk_bf16_f32 v129, v226, v227
    v_mfma_f32_16x16x32_bf16 v[60:63], v[184:187], v[152:155], v[60:63]
    v_exp_f32 v236, v236
    v_exp_f32 v237, v237
    v_exp_f32 v238, v238
    v_exp_f32 v239, v239
    v_cvt_pk_bf16_f32 v130, v228, v229
    v_mfma_f32_16x16x32_bf16 v[60:63], v[184:187], v[156:159], v[60:63]
    v_cvt_pk_bf16_f32 v131, v230, v231
    v_cvt_pk_bf16_f32 v132, v232, v233
    v_cvt_pk_bf16_f32 v133, v234, v235
    v_cvt_pk_bf16_f32 v134, v236, v237
    v_cvt_pk_bf16_f32 v135, v238, v239
    s_waitcnt lgkmcnt(3)
    v_mfma_f32_32x32x16_bf16 v[224:239], v[80:83], v[8:11], 0
    v_exp_f32 v240, v240
    v_exp_f32 v241, v241
    v_exp_f32 v242, v242
    s_waitcnt lgkmcnt(1)
    v_mfma_f32_32x32x16_bf16 v[40:55], v[104:107], v[128:131], v[40:55]
    v_exp_f32 v243, v243
    v_exp_f32 v244, v244
    v_exp_f32 v245, v245
    v_mfma_f32_32x32x16_bf16 v[224:239], v[84:87], v[12:15], v[224:239]
    ds_read_b128 v[80:83], v190 offset:4096
    ds_read_b128 v[84:87], v190 offset:5120
    v_exp_f32 v246, v246
    v_exp_f32 v247, v247
    v_exp_f32 v248, v248
    s_waitcnt lgkmcnt(2)
    v_mfma_f32_32x32x16_bf16 v[40:55], v[108:111], v[132:135], v[40:55]
    ds_read_b128 v[104:107], v191 offset:0
    ds_read_b128 v[108:111], v191 offset:1024
    v_exp_f32 v249, v249
    v_exp_f32 v250, v250
    v_exp_f32 v251, v251
    v_cvt_pk_bf16_f32 v152, v240, v241
    v_cvt_pk_bf16_f32 v153, v242, v243
    v_mfma_f32_16x16x32_bf16 v[60:63], v[184:187], v[128:131], v[60:63]
    v_exp_f32 v252, v252
    v_exp_f32 v253, v253
    v_exp_f32 v254, v254
    v_exp_f32 v255, v255
    v_cvt_pk_bf16_f32 v154, v244, v245
    v_mfma_f32_16x16x32_bf16 v[60:63], v[184:187], v[132:135], v[60:63]
    v_cvt_pk_bf16_f32 v155, v246, v247
    v_cvt_pk_bf16_f32 v156, v248, v249
    v_cvt_pk_bf16_f32 v157, v250, v251
    v_cvt_pk_bf16_f32 v158, v252, v253
    v_cvt_pk_bf16_f32 v159, v254, v255
    s_mov_b32 s88, 5
    s_nop 3
    v_cmp_le_f32 s[84:85], s34, v60
    v_cmp_ge_f32 s[86:87], s35, v60
    s_lshl_b32 s64, s88, 16
    s_add_u32 s64, s64, s89
    s_and_b64 s[84:85], s[84:85], s[86:87]
    s_cmp_eq_u64 s[84:85], -1
    s_cbranch_scc1 L_ok5
    s_call_b64 s[90:91], L_slowB
L_ok5:
    v_rcp_f32 v61, v60
    s_nop 0
    v_mul_f32 v40, v40, v61
    v_mul_f32 v41, v41, v61
    v_mul_f32 v42, v42, v61
    v_mul_f32 v43, v43, v61
    v_mul_f32 v44, v44, v61
    v_mul_f32 v45, v45, v61
    v_mul_f32 v46, v46, v61
    v_mul_f32 v47, v47, v61
    v_mul_f32 v48, v48, v61
    v_mul_f32 v49, v49, v61
    v_mul_f32 v50, v50, v61
    v_mul_f32 v51, v51, v61
    v_mul_f32 v52, v52, v61
    v_mul_f32 v53, v53, v61
    v_mul_f32 v54, v54, v61
    v_mul_f32 v55, v55, v61
    v_cvt_pk_bf16_f32 v40, v40, v41
    v_cvt_pk_bf16_f32 v41, v42, v43
    v_cvt_pk_bf16_f32 v42, v44, v45
    v_cvt_pk_bf16_f32 v43, v46, v47
    v_cvt_pk_bf16_f32 v44, v48, v49
    v_cvt_pk_bf16_f32 v45, v50, v51
    v_cvt_pk_bf16_f32 v46, v52, v53
    v_cvt_pk_bf16_f32 v47, v54, v55
    buffer_store_dwordx4 v[40:43], v189, s[44:47], s64 offen sc1
    buffer_store_dwordx4 v[44:47], v189, s[44:47], s64 offen offset:512 sc1
    s_waitcnt lgkmcnt(3)
    v_mfma_f32_32x32x16_bf16 v[240:255], v[80:83], v[8:11], v[88:103]
    v_exp_f32 v224, v224
    v_exp_f32 v225, v225
    v_exp_f32 v226, v226
    s_waitcnt lgkmcnt(1)
    v_mfma_f32_32x32x16_bf16 v[24:39], v[104:107], v[152:155], 0
    v_exp_f32 v227, v227
    v_exp_f32 v228, v228
    v_exp_f32 v229, v229
    v_mfma_f32_32x32x16_bf16 v[240:255], v[84:87], v[12:15], v[240:255]
    v_exp_f32 v230, v230
    v_exp_f32 v231, v231
    v_exp_f32 v232, v232
    s_waitcnt lgkmcnt(0)
    v_mfma_f32_32x32x16_bf16 v[24:39], v[108:111], v[156:159], v[24:39]
    ds_read_b128 v[104:107], v191 offset:2048
    ds_read_b128 v[108:111], v191 offset:3072
    v_exp_f32 v233, v233
    v_exp_f32 v234, v234
    v_exp_f32 v235, v235
    v_cvt_pk_bf16_f32 v128, v224, v225
    v_cvt_pk_bf16_f32 v129, v226, v227
    v_mfma_f32_16x16x32_bf16 v[56:59], v[184:187], v[152:155], 0
    v_exp_f32 v236, v236
    v_exp_f32 v237, v237
    v_exp_f32 v238, v238
    v_exp_f32 v239, v239
    v_cvt_pk_bf16_f32 v130, v228, v229
    v_mfma_f32_16x16x32_bf16 v[56:59], v[184:187], v[156:159], v[56:59]
    v_cvt_pk_bf16_f32 v131, v230, v231
    v_cvt_pk_bf16_f32 v132, v232, v233
    v_cvt_pk_bf16_f32 v133, v234, v235
    v_cvt_pk_bf16_f32 v134, v236, v237
    v_cvt_pk_bf16_f32 v135, v238, v239
    v_exp_f32 v240, v240
    v_exp_f32 v241, v241
    v_exp_f32 v242, v242
    s_waitcnt lgkmcnt(1)
    v_mfma_f32_32x32x16_bf16 v[24:39], v[104:107], v[128:131], v[24:39]
    v_exp_f32 v243, v243
    v_exp_f32 v244, v244
    v_exp_f32 v245, v245
    v_exp_f32 v246, v246
    v_exp_f32 v247, v247
    v_exp_f32 v248, v248
    s_waitcnt lgkmcnt(0)
    v_mfma_f32_32x32x16_bf16 v[24:39], v[108:111], v[132:135], v[24:39]
    ds_read_b128 v[104:107], v191 offset:4096
    ds_read_b128 v[108:111], v191 offset:5120
    v_exp_f32 v249, v249
    v_exp_f32 v250, v250
    v_exp_f32 v251, v251
    v_cvt_pk_bf16_f32 v152, v240, v241
    v_cvt_pk_bf16_f32 v153, v242, v243
    v_mfma_f32_16x16x32_bf16 v[56:59], v[184:187], v[128:131], v[56:59]
    v_exp_f32 v252, v252
    v_exp_f32 v253, v253
    v_exp_f32 v254, v254
    v_exp_f32 v255, v255
    v_cvt_pk_bf16_f32 v154, v244, v245
    v_mfma_f32_16x16x32_bf16 v[56:59], v[184:187], v[132:135], v[56:59]
    v_cvt_pk_bf16_f32 v155, v246, v247
    v_cvt_pk_bf16_f32 v156, v248, v249
    v_cvt_pk_bf16_f32 v157, v250, v251
    v_cvt_pk_bf16_f32 v158, v252, v253
    v_cvt_pk_bf16_f32 v159, v254, v255
    s_mov_b32 s88, 5
    s_lshl_b32 s64, s88, 8
    s_add_u32 s64, s64, s96
    v_mov_b32 v4, s77
    v_mov_b32 v5, s81
    v_mov_b32 v6, 0
    s_waitcnt vmcnt(0)
    s_mov_b64 exec, 1
    buffer_store_dwordx2 v[4:5], v6, s[44:47], s64 offen sc1
    s_mov_b64 exec, -1
    s_nop 3
    s_nop 1
    s_waitcnt lgkmcnt(1)
    v_mfma_f32_32x32x16_bf16 v[24:39], v[104:107], v[152:155], v[24:39]
    s_waitcnt lgkmcnt(0)
    v_mfma_f32_32x32x16_bf16 v[24:39], v[108:111], v[156:159], v[24:39]
    v_mfma_f32_16x16x32_bf16 v[56:59], v[184:187], v[152:155], v[56:59]
    v_mfma_f32_16x16x32_bf16 v[56:59], v[184:187], v[156:159], v[56:59]
    s_branch L_w2
L_z2:
    s_nop 7
    s_mov_b32 s88, 5
    s_nop 3
    v_cmp_le_f32 s[84:85], s34, v60
    v_cmp_ge_f32 s[86:87], s35, v60
    s_lshl_b32 s64, s88, 16
    s_add_u32 s64, s64, s89
    s_and_b64 s[84:85], s[84:85], s[86:87]
    s_cmp_eq_u64 s[84:85], -1
    s_cbranch_scc1 L_ok6
    s_call_b64 s[90:91], L_slowB
L_ok6:
    v_rcp_f32 v61, v60
    s_nop 0
    v_mul_f32 v40, v40, v61
    v_mul_f32 v41, v41, v61
    v_mul_f32 v42, v42, v61
    v_mul_f32 v43, v43, v61
    v_mul_f32 v44, v44, v61
    v_mul_f32 v45, v45, v61
    v_mul_f32 v46, v46, v61
    v_mul_f32 v47, v47, v61
    v_mul_f32 v48, v48, v61
    v_mul_f32 v49, v49, v61
    v_mul_f32 v50, v50, v61
    v_mul_f32 v51, v51, v61
    v_mul_f32 v52, v52, v61
    v_mul_f32 v53, v53, v61
    v_mul_f32 v54, v54, v61
    v_mul_f32 v55, v55, v61
    v_cvt_pk_bf16_f32 v40, v40, v41
    v_cvt_pk_bf16_f32 v41, v42, v43
    v_cvt_pk_bf16_f32 v42, v44, v45
    v_cvt_pk_bf16_f32 v43, v46, v47
    v_cvt_pk_bf16_f32 v44, v48, v49
    v_cvt_pk_bf16_f32 v45, v50, v51
    v_cvt_pk_bf16_f32 v46, v52, v53
    v_cvt_pk_bf16_f32 v47, v54, v55
    buffer_store_dwordx4 v[40:43], v189, s[44:47], s64 offen sc1
    buffer_store_dwordx4 v[44:47], v189, s[44:47], s64 offen offset:512 sc1
    ds_read_b128 v[80:83], v190 offset:0
    ds_read_b128 v[84:87], v190 offset:1024
    s_waitcnt lgkmcnt(1)
    v_mfma_f32_32x32x16_bf16 v[224:239], v[80:83], v[8:11], 0
    s_waitcnt lgkmcnt(0)
    v_mfma_f32_32x32x16_bf16 v[224:239], v[84:87], v[12:15], v[224:239]
    ds_read_b128 v[80:83], v190 offset:2048
    ds_read_b128 v[84:87], v190 offset:3072
    s_waitcnt lgkmcnt(1)
    v_mfma_f32_32x32x16_bf16 v[240:255], v[80:83], v[8:11], 0
    s_nop 7
    s_nop 3
    v_exp_f32 v224, v224
    v_exp_f32 v225, v225
    v_exp_f32 v226, v226
    v_exp_f32 v227, v227
    v_exp_f32 v228, v228
    v_exp_f32 v229, v229
    s_waitcnt lgkmcnt(0)
    v_mfma_f32_32x32x16_bf16 v[240:255], v[84:87], v[12:15], v[240:255]
    ds_read_b128 v[80:83], v190 offset:4096
    ds_read_b128 v[84:87], v190 offset:5120
    v_exp_f32 v230, v230
    v_exp_f32 v231, v231
    v_exp_f32 v232, v232
    ds_read_b128 v[104:107], v191 offset:0
    ds_read_b128 v[108:111], v191 offset:1024
    v_exp_f32 v233, v233
    v_exp_f32 v234, v234
    v_exp_f32 v235, v235
    v_cvt_pk_bf16_f32 v128, v224, v225
    v_cvt_pk_bf16_f32 v129, v226, v227
    v_exp_f32 v236, v236
    v_exp_f32 v237, v237
    v_exp_f32 v238, v238
    v_exp_f32 v239, v239
    v_cvt_pk_bf16_f32 v130, v228, v229
    v_cvt_pk_bf16_f32 v131, v230, v231
    v_cvt_pk_bf16_f32 v132, v232, v233
    v_cvt_pk_bf16_f32 v133, v234, v235
    v_cvt_pk_bf16_f32 v134, v236, v237
    v_cvt_pk_bf16_f32 v135, v238, v239
    s_waitcnt lgkmcnt(3)
    v_mfma_f32_32x32x16_bf16 v[224:239], v[80:83], v[8:11], v[88:103]
    v_exp_f32 v240, v240
    v_exp_f32 v241, v241
    v_exp_f32 v242, v242
    s_waitcnt lgkmcnt(1)
    v_mfma_f32_32x32x16_bf16 v[24:39], v[104:107], v[128:131], 0
    v_exp_f32 v243, v243
    v_exp_f32 v244, v244
    v_exp_f32 v245, v245
    v_mfma_f32_32x32x16_bf16 v[224:239], v[84:87], v[12:15], v[224:239]
    v_exp_f32 v246, v246
    v_exp_f32 v247, v247
    v_exp_f32 v248, v248
    s_waitcnt lgkmcnt(0)
    v_mfma_f32_32x32x16_bf16 v[24:39], v[108:111], v[132:135], v[24:39]
    ds_read_b128 v[104:107], v191 offset:2048
    ds_read_b128 v[108:111], v191 offset:3072
    v_exp_f32 v249, v249
    v_exp_f32 v250, v250
    v_exp_f32 v251, v251
    v_cvt_pk_bf16_f32 v152, v240, v241
    v_cvt_pk_bf16_f32 v153, v242, v243
    v_mfma_f32_16x16x32_bf16 v[56:59], v[184:187], v[128:131], 0
    v_exp_f32 v252, v252
    v_exp_f32 v253, v253
    v_exp_f32 v254, v254
    v_exp_f32 v255, v255
    v_cvt_pk_bf16_f32 v154, v244, v245
    v_mfma_f32_16x16x32_bf16 v[56:59], v[184:187], v[132:135], v[56:59]
    v_cvt_pk_bf16_f32 v155, v246, v247
    v_cvt_pk_bf16_f32 v156, v248, v249
    v_cvt_pk_bf16_f32 v157, v250, v251
    v_cvt_pk_bf16_f32 v158, v252, v253
    v_cvt_pk_bf16_f32 v159, v254, v255
    v_exp_f32 v224, v224
    v_exp_f32 v225, v225
    v_exp_f32 v226, v226
    s_waitcnt lgkmcnt(1)
    v_mfma_f32_32x32x16_bf16 v[24:39], v[104:107], v[152:155], v[24:39]
    v_exp_f32 v227, v227
    v_exp_f32 v228, v228
    v_exp_f32 v229, v229
    v_exp_f32 v230, v230
    v_exp_f32 v231, v231
    v_exp_f32 v232, v232
    s_waitcnt lgkmcnt(0)
    v_mfma_f32_32x32x16_bf16 v[24:39], v[108:111], v[156:159], v[24:39]
    ds_read_b128 v[104:107], v191 offset:4096
    ds_read_b128 v[108:111], v191 offset:5120
    v_exp_f32 v233, v233
    v_exp_f32 v234, v234
    v_exp_f32 v235, v235
    v_cvt_pk_bf16_f32 v128, v224, v225
    v_cvt_pk_bf16_f32 v129, v226, v227
    v_mfma_f32_16x16x32_bf16 v[56:59], v[184:187], v[152:155], v[56:59]
    v_exp_f32 v236, v236
    v_exp_f32 v237, v237
    v_exp_f32 v238, v238
    v_exp_f32 v239, v239
    v_cvt_pk_bf16_f32 v130, v228, v229
    v_mfma_f32_16x16x32_bf16 v[56:59], v[184:187], v[156:159], v[56:59]
    v_cvt_pk_bf16_f32 v131, v230, v231
    v_cvt_pk_bf16_f32 v132, v232, v233
    v_cvt_pk_bf16_f32 v133, v234, v235
    v_cvt_pk_bf16_f32 v134, v236, v237
    v_cvt_pk_bf16_f32 v135, v238, v239
    s_nop 1
    s_waitcnt lgkmcnt(1)
    v_mfma_f32_32x32x16_bf16 v[24:39], v[104:107], v[128:131], v[24:39]
    s_waitcnt lgkmcnt(0)
    v_mfma_f32_32x32x16_bf16 v[24:39], v[108:111], v[132:135], v[24:39]
    v_mfma_f32_16x16x32_bf16 v[56:59], v[184:187], v[128:131], v[56:59]
    v_mfma_f32_16x16x32_bf16 v[56:59], v[184:187], v[132:135], v[56:59]
    s_mov_b32 s88, 5
    s_lshl_b32 s64, s88, 8
    s_add_u32 s64, s64, s96
    v_mov_b32 v4, s77
    v_mov_b32 v5, s81
    v_mov_b32 v6, 0
    s_waitcnt vmcnt(0)
    s_mov_b64 exec, 1
    buffer_store_dwordx2 v[4:5], v6, s[44:47], s64 offen sc1
    s_mov_b64 exec, -1
    s_nop 3
L_w2:
    s_waitcnt lgkmcnt(0)
    s_barrier
    s_cmp_eq_u32 s61, 0
    s_cbranch_scc1 L_y2
    ds_read_b128 v[80:83], v196 offset:28672
    ds_read_b128 v[84:87], v196 offset:29696
    s_waitcnt lgkmcnt(1)
    v_mfma_f32_32x32x16_bf16 v[224:239], v[80:83], v[8:11], 0
    s_waitcnt lgkmcnt(0)
    v_mfma_f32_32x32x16_bf16 v[224:239], v[84:87], v[12:15], v[224:239]
    ds_read_b128 v[80:83], v196 offset:24576
    ds_read_b128 v[84:87], v196 offset:25600
    s_add_u32 m0, s82, 0
    s_mov_b32 s67, 0
    buffer_load_dwordx4 v188, s[48:51], s67 offen lds
    s_add_u32 m0, s82, 8192
    s_mov_b32 s67, 65536
    buffer_load_dwordx4 v188, s[48:51], s67 offen lds
    s_add_u32 m0, s82, 16384
    s_mov_b32 s67, 131072
    buffer_load_dwordx4 v188, s[48:51], s67 offen lds
    s_waitcnt lgkmcnt(1)
    v_mfma_f32_32x32x16_bf16 v[240:255], v[80:83], v[8:11], 0
    s_nop 7
    s_nop 3
    v_exp_f32 v224, v224
    v_exp_f32 v225, v225
    v_exp_f32 v226, v226
    v_exp_f32 v227, v227
    v_exp_f32 v228, v228
    v_exp_f32 v229, v229
    s_waitcnt lgkmcnt(0)
    v_mfma_f32_32x32x16_bf16 v[240:255], v[84:87], v[12:15], v[240:255]
    ds_read_b128 v[80:83], v196 offset:20480
    ds_read_b128 v[84:87], v196 offset:21504
    v_exp_f32 v230, v230
    v_exp_f32 v231, v231
    v_exp_f32 v232, v232
    ds_read_b128 v[104:107], v197 offset:28672
    ds_read_b128 v[108:111], v197 offset:29696
    v_exp_f32 v233, v233
    v_exp_f32 v234, v234
    v_exp_f32 v235, v235
    v_cvt_pk_bf16_f32 v128, v224, v225
    v_cvt_pk_bf16_f32 v129, v226, v227
    v_exp_f32 v236, v236
    v_exp_f32 v237, v237
    v_exp_f32 v238, v238
    v_exp_f32 v239, v239
    v_cvt_pk_bf16_f32 v130, v228, v229
    v_cvt_pk_bf16_f32 v131, v230, v231
    v_cvt_pk_bf16_f32 v132, v232, v233
    v_cvt_pk_bf16_f32 v133, v234, v235
    v_cvt_pk_bf16_f32 v134, v236, v237
    v_cvt_pk_bf16_f32 v135, v238, v239
    s_add_u32 m0, s82, 24576
    s_mov_b32 s67, 196608
    buffer_load_dwordx4 v188, s[48:51], s67 offen lds
    s_add_u32 m0, s82, 98304
    s_mov_b32 s67, 262144
    buffer_load_dwordx4 v188, s[48:51], s67 offen lds
    s_add_u32 m0, s82, 106496
    s_mov_b32 s67, 327680
    buffer_load_dwordx4 v188, s[48:51], s67 offen lds
    s_waitcnt lgkmcnt(3)
    v_mfma_f32_32x32x16_bf16 v[224:239], v[80:83], v[8:11], 0
    v_exp_f32 v240, v240
    v_exp_f32 v241, v241
    v_exp_f32 v242, v242
    s_waitcnt lgkmcnt(1)
    v_mfma_f32_32x32x16_bf16 v[24:39], v[104:107], v[128:131], v[24:39]
    v_exp_f32 v243, v243
    v_exp_f32 v244, v244
    v_exp_f32 v245, v245
    v_mfma_f32_32x32x16_bf16 v[224:239], v[84:87], v[12:15], v[224:239]
    ds_read_b128 v[80:83], v196 offset:16384
    ds_read_b128 v[84:87], v196 offset:17408
    v_exp_f32 v246, v246
    v_exp_f32 v247, v247
    v_exp_f32 v248, v248
    s_waitcnt lgkmcnt(2)
    v_mfma_f32_32x32x16_bf16 v[24:39], v[108:111], v[132:135], v[24:39]
    ds_read_b128 v[104:107], v197 offset:24576
    ds_read_b128 v[108:111], v197 offset:25600
    v_exp_f32 v249, v249
    v_exp_f32 v250, v250
    v_exp_f32 v251, v251
    v_cvt_pk_bf16_f32 v152, v240, v241
    v_cvt_pk_bf16_f32 v153, v242, v243
    v_mfma_f32_16x16x32_bf16 v[56:59], v[184:187], v[128:131], v[56:59]
    v_exp_f32 v252, v252
    v_exp_f32 v253, v253
    v_exp_f32 v254, v254
    v_exp_f32 v255, v255
    v_cvt_pk_bf16_f32 v154, v244, v245
    v_mfma_f32_16x16x32_bf16 v[56:59], v[184:187], v[132:135], v[56:59]
    v_cvt_pk_bf16_f32 v155, v246, v247
    v_cvt_pk_bf16_f32 v156, v248, v249
    v_cvt_pk_bf16_f32 v157, v250, v251
    v_cvt_pk_bf16_f32 v158, v252, v253
    v_cvt_pk_bf16_f32 v159, v254, v255
    s_add_u32 m0, s82, 114688
    s_mov_b32 s67, 393216
    buffer_load_dwordx4 v188, s[48:51], s67 offen lds
    s_add_u32 m0, s82, 122880
    s_mov_b32 s67, 458752
    buffer_load_dwordx4 v188, s[48:51], s67 offen lds
    s_add_u32 m0, s82, 131072
    s_mov_b32 s67, 524288
    buffer_load_dwordx4 v188, s[48:51], s67 offen lds
    s_lshl_b32 s66, s74, 3
    s_add_u32 s66, s66, 155648
    v_mov_b32 v198, s66
    s_waitcnt lgkmcnt(0)
    s_mov_b32 s72, 0x400000
L_wl2b:
    ds_read_b64 v[2:3], v198 offset:0
    s_waitcnt lgkmcnt(0)
    v_readfirstlane_b32 s66, v2
    v_readfirstlane_b32 s67, v3
    s_cmp_eq_u32 s66, s77
    s_cselect_b32 s66, 1, 0
    s_cmp_eq_u32 s67, s81
    s_cselect_b32 s66, s66, 0
    s_cmp_lg_u32 s66, 0
    s_cbranch_scc1 L_wd2b
    s_sub_u32 s72, s72, 1
    s_cmp_eq_u32 s72, 0
    s_cbranch_scc1 L_wd2b
    s_sleep 1
    s_branch L_wl2b
L_wd2b:
    v_mfma_f32_32x32x16_bf16 v[240:255], v[80:83], v[8:11], 0
    v_exp_f32 v224, v224
    v_exp_f32 v225, v225
    v_exp_f32 v226, v226
    v_mfma_f32_32x32x16_bf16 v[24:39], v[104:107], v[152:155], v[24:39]
    v_exp_f32 v227, v227
    v_exp_f32 v228, v228
    v_exp_f32 v229, v229
    v_mfma_f32_32x32x16_bf16 v[240:255], v[84:87], v[12:15], v[240:255]
    ds_read_b128 v[80:83], v196 offset:12288
    ds_read_b128 v[84:87], v196 offset:13312
    v_exp_f32 v230, v230
    v_exp_f32 v231, v231
    v_exp_f32 v232, v232
    v_mfma_f32_32x32x16_bf16 v[24:39], v[108:111], v[156:159], v[24:39]
    ds_read_b128 v[104:107], v197 offset:20480
    ds_read_b128 v[108:111], v197 offset:21504
    v_exp_f32 v233, v233
    v_exp_f32 v234, v234
    v_exp_f32 v235, v235
    v_cvt_pk_bf16_f32 v128, v224, v225
    v_cvt_pk_bf16_f32 v129, v226, v227
    v_mfma_f32_16x16x32_bf16 v[56:59], v[184:187], v[152:155], v[56:59]
    v_exp_f32 v236, v236
    v_exp_f32 v237, v237
    v_exp_f32 v238, v238
    v_exp_f32 v239, v239
    v_cvt_pk_bf16_f32 v130, v228, v229
    v_mfma_f32_16x16x32_bf16 v[56:59], v[184:187], v[156:159], v[56:59]
    v_cvt_pk_bf16_f32 v131, v230, v231
    v_cvt_pk_bf16_f32 v132, v232, v233
    v_cvt_pk_bf16_f32 v133, v234, v235
    v_cvt_pk_bf16_f32 v134, v236, v237
    v_cvt_pk_bf16_f32 v135, v238, v239
    s_add_u32 m0, s82, 139264
    s_mov_b32 s67, 589824
    buffer_load_dwordx4 v188, s[48:51], s67 offen lds
    s_add_u32 m0, s82, 147456
    s_mov_b32 s67, 655360
    buffer_load_dwordx4 v188, s[48:51], s67 offen lds
    s_waitcnt lgkmcnt(3)
    v_mfma_f32_32x32x16_bf16 v[224:239], v[80:83], v[8:11], 0
    v_exp_f32 v240, v240
    v_exp_f32 v241, v241
    v_exp_f32 v242, v242
    s_waitcnt lgkmcnt(1)
    v_mfma_f32_32x32x16_bf16 v[24:39], v[104:107], v[128:131], v[24:39]
    v_exp_f32 v243, v243
    v_exp_f32 v244, v244
    v_exp_f32 v245, v245
    v_mfma_f32_32x32x16_bf16 v[224:239], v[84:87], v[12:15], v[224:239]
    ds_read_b128 v[80:83], v196 offset:8192
    ds_read_b128 v[84:87], v196 offset:9216
    v_exp_f32 v246, v246
    v_exp_f32 v247, v247
    v_exp_f32 v248, v248
    s_waitcnt lgkmcnt(2)
    v_mfma_f32_32x32x16_bf16 v[24:39], v[108:111], v[132:135], v[24:39]
    ds_read_b128 v[104:107], v197 offset:16384
    ds_read_b128 v[108:111], v197 offset:17408
    v_exp_f32 v249, v249
    v_exp_f32 v250, v250
    v_exp_f32 v251, v251
    v_cvt_pk_bf16_f32 v152, v240, v241
    v_cvt_pk_bf16_f32 v153, v242, v243
    v_mfma_f32_16x16x32_bf16 v[56:59], v[184:187], v[128:131], v[56:59]
    v_exp_f32 v252, v252
    v_exp_f32 v253, v253
    v_exp_f32 v254, v254
    v_exp_f32 v255, v255
    v_cvt_pk_bf16_f32 v154, v244, v245
    v_mfma_f32_16x16x32_bf16 v[56:59], v[184:187], v[132:135], v[56:59]
    v_cvt_pk_bf16_f32 v155, v246, v247
    v_cvt_pk_bf16_f32 v156, v248, v249
    v_cvt_pk_bf16_f32 v157, v250, v251
    v_cvt_pk_bf16_f32 v158, v252, v253
    v_cvt_pk_bf16_f32 v159, v254, v255
    s_waitcnt lgkmcnt(3)
    v_mfma_f32_32x32x16_bf16 v[240:255], v[80:83], v[8:11], v[136:151]
    v_exp_f32 v224, v224
    v_exp_f32 v225, v225
    v_exp_f32 v226, v226
    s_waitcnt lgkmcnt(1)
    v_mfma_f32_32x32x16_bf16 v[24:39], v[104:107], v[152:155], v[24:39]
    v_exp_f32 v227, v227
    v_exp_f32 v228, v228
    v_exp_f32 v229, v229
    v_mfma_f32_32x32x16_bf16 v[240:255], v[84:87], v[12:15], v[240:255]
    v_exp_f32 v230, v230
    v_exp_f32 v231, v231
    v_exp_f32 v232, v232
    s_waitcnt lgkmcnt(0)
    v_mfma_f32_32x32x16_bf16 v[24:39], v[108:111], v[156:159], v[24:39]
    ds_read_b128 v[104:107], v197 offset:12288
    ds_read_b128 v[108:111], v197 offset:13312
    v_exp_f32 v233, v233
    v_exp_f32 v234, v234
    v_exp_f32 v235, v235
    v_cvt_pk_bf16_f32 v128, v224, v225
    v_cvt_pk_bf16_f32 v129, v226, v227
    v_mfma_f32_16x16x32_bf16 v[56:59], v[184:187], v[152:155], v[56:59]
    v_exp_f32 v236, v236
    v_exp_f32 v237, v237
    v_exp_f32 v238, v238
    v_exp_f32 v239, v239
    v_cvt_pk_bf16_f32 v130, v228, v229
    v_mfma_f32_16x16x32_bf16 v[56:59], v[184:187], v[156:159], v[56:59]
    v_cvt_pk_bf16_f32 v131, v230, v231
    v_cvt_pk_bf16_f32 v132, v232, v233
    v_cvt_pk_bf16_f32 v133, v234, v235
    v_cvt_pk_bf16_f32 v134, v236, v237
    v_cvt_pk_bf16_f32 v135, v238, v239
    s_lshr_b32 s73, s63, 2
    s_and_b32 s76, s63, 3
    s_lshl_b32 s64, s60, 3
    s_add_u32 s64, s64, s79
    s_lshl_b32 s65, s64, 3
    s_add_u32 s65, s65, s76
    s_lshl_b32 s71, s65, 8
    s_lshl_b32 s66, s73, 7
    s_add_u32 s71, s71, s66
    s_add_u32 s71, s71, 25231360
    v_and_b32 v7, 15, v0
    v_lshlrev_b32 v7, 3, v7
    s_lshl_b32 s70, s65, 16
    s_lshl_b32 s66, s73, 14
    s_add_u32 s70, s70, s66
    s_add_u32 s70, s70, 17039360
    v_add_u32 v192, 0x8000, v1
    s_and_b32 s66, s80, 0
    s_lshl_b32 s66, s66, 10
    s_add_u32 s70, s70, s66
    buffer_load_dwordx2 v[2:3], v7, s[44:47], s71 offen offset:1024 sc1
    v_exp_f32 v240, v240
    v_exp_f32 v241, v241
    v_exp_f32 v242, v242
    s_waitcnt lgkmcnt(1)
    v_mfma_f32_32x32x16_bf16 v[24:39], v[104:107], v[128:131], v[24:39]
    v_exp_f32 v243, v243
    v_exp_f32 v244, v244
    v_exp_f32 v245, v245
    v_exp_f32 v246, v246
    v_exp_f32 v247, v247
    v_exp_f32 v248, v248
    s_waitcnt lgkmcnt(0)
    v_mfma_f32_32x32x16_bf16 v[24:39], v[108:111], v[132:135], v[24:39]
    ds_read_b128 v[104:107], v197 offset:8192
    ds_read_b128 v[108:111], v197 offset:9216
    v_exp_f32 v249, v249
    v_exp_f32 v250, v250
    v_exp_f32 v251, v251
    v_cvt_pk_bf16_f32 v152, v240, v241
    v_cvt_pk_bf16_f32 v153, v242, v243
    v_mfma_f32_16x16x32_bf16 v[56:59], v[184:187], v[128:131], v[56:59]
    v_exp_f32 v252, v252
    v_exp_f32 v253, v253
    v_exp_f32 v254, v254
    v_exp_f32 v255, v255
    v_cvt_pk_bf16_f32 v154, v244, v245
    v_mfma_f32_16x16x32_bf16 v[56:59], v[184:187], v[132:135], v[56:59]
    v_cvt_pk_bf16_f32 v155, v246, v247
    v_cvt_pk_bf16_f32 v156, v248, v249
    v_cvt_pk_bf16_f32 v157, v250, v251
    v_cvt_pk_bf16_f32 v158, v252, v253
    v_cvt_pk_bf16_f32 v159, v254, v255
    s_nop 1
    s_waitcnt lgkmcnt(1)
    v_mfma_f32_32x32x16_bf16 v[24:39], v[104:107], v[152:155], v[24:39]
    s_waitcnt lgkmcnt(0)
    v_mfma_f32_32x32x16_bf16 v[24:39], v[108:111], v[156:159], v[24:39]
    v_mfma_f32_16x16x32_bf16 v[56:59], v[184:187], v[152:155], v[56:59]
    v_mfma_f32_16x16x32_bf16 v[56:59], v[184:187], v[156:159], v[56:59]
    s_mov_b32 s88, 2
    s_nop 7
    s_branch L_last
L_y2:
    s_add_u32 m0, s82, 0
    s_mov_b32 s67, 0
    buffer_load_dwordx4 v188, s[48:51], s67 offen lds
    s_add_u32 m0, s82, 8192
    s_mov_b32 s67, 65536
    buffer_load_dwordx4 v188, s[48:51], s67 offen lds
    s_add_u32 m0, s82, 16384
    s_mov_b32 s67, 131072
    buffer_load_dwordx4 v188, s[48:51], s67 offen lds
    s_add_u32 m0, s82, 24576
    s_mov_b32 s67, 196608
    buffer_load_dwordx4 v188, s[48:51], s67 offen lds
    s_add_u32 m0, s82, 98304
    s_mov_b32 s67, 262144
    buffer_load_dwordx4 v188, s[48:51], s67 offen lds
    s_add_u32 m0, s82, 106496
    s_mov_b32 s67, 327680
    buffer_load_dwordx4 v188, s[48:51], s67 offen lds
    s_add_u32 m0, s82, 114688
    s_mov_b32 s67, 393216
    buffer_load_dwordx4 v188, s[48:51], s67 offen lds
    s_add_u32 m0, s82, 122880
    s_mov_b32 s67, 458752
    buffer_load_dwordx4 v188, s[48:51], s67 offen lds
    s_add_u32 m0, s82, 131072
    s_mov_b32 s67, 524288
    buffer_load_dwordx4 v188, s[48:51], s67 offen lds
    s_add_u32 m0, s82, 139264
    s_mov_b32 s67, 589824
    buffer_load_dwordx4 v188, s[48:51], s67 offen lds
    s_add_u32 m0, s82, 147456
    s_mov_b32 s67, 655360
    buffer_load_dwordx4 v188, s[48:51], s67 offen lds
    s_lshr_b32 s73, s63, 2
    s_and_b32 s76, s63, 3
    s_lshl_b32 s64, s60, 3
    s_add_u32 s64, s64, s79
    s_lshl_b32 s65, s64, 3
    s_add_u32 s65, s65, s76
    s_lshl_b32 s71, s65, 8
    s_lshl_b32 s66, s73, 7
    s_add_u32 s71, s71, s66
    s_add_u32 s71, s71, 25231360
    v_and_b32 v7, 15, v0
    v_lshlrev_b32 v7, 3, v7
    s_lshl_b32 s70, s65, 16
    s_lshl_b32 s66, s73, 14
    s_add_u32 s70, s70, s66
    s_add_u32 s70, s70, 17039360
    v_add_u32 v192, 0x8000, v1
    s_and_b32 s66, s80, 0
    s_lshl_b32 s66, s66, 10
    s_add_u32 s70, s70, s66
    buffer_load_dwordx2 v[2:3], v7, s[44:47], s71 offen offset:1024 sc1
    s_waitcnt lgkmcnt(0)
    s_mov_b32 s88, 2
    s_branch L_last
L_u3:
    v_add_u32 v4, v198, v1
    ds_read_b128 v[16:19], v4 offset:8192
    ds_read_b128 v[20:23], v4 offset:9216
    ds_read_b128 v[8:11], v4 offset:6144
    ds_read_b128 v[12:15], v4 offset:7168
    s_waitcnt lgkmcnt(2)
    ds_read_b128 v[80:83], v190 offset:0
    ds_read_b128 v[84:87], v190 offset:1024
    s_waitcnt lgkmcnt(1)
    v_mfma_f32_32x32x16_bf16 v[224:239], v[80:83], v[16:19], 0
    s_waitcnt lgkmcnt(0)
    v_mfma_f32_32x32x16_bf16 v[224:239], v[84:87], v[20:23], v[224:239]
    ds_read_b128 v[80:83], v190 offset:2048
    ds_read_b128 v[84:87], v190 offset:3072
    s_waitcnt lgkmcnt(1)
    v_mfma_f32_32x32x16_bf16 v[240:255], v[80:83], v[16:19], 0
    s_nop 7
    s_nop 3
    v_exp_f32 v224, v224
    v_exp_f32 v225, v225
    v_exp_f32 v226, v226
    v_exp_f32 v227, v227
    v_exp_f32 v228, v228
    v_exp_f32 v229, v229
    s_waitcnt lgkmcnt(0)
    v_mfma_f32_32x32x16_bf16 v[240:255], v[84:87], v[20:23], v[240:255]
    ds_read_b128 v[80:83], v190 offset:4096
    ds_read_b128 v[84:87], v190 offset:5120
    v_exp_f32 v230, v230
    v_exp_f32 v231, v231
    v_exp_f32 v232, v232
    ds_read_b128 v[104:107], v191 offset:0
    ds_read_b128 v[108:111], v191 offset:1024
    v_exp_f32 v233, v233
    v_exp_f32 v234, v234
    v_exp_f32 v235, v235
    v_cvt_pk_bf16_f32 v128, v224, v225
    v_cvt_pk_bf16_f32 v129, v226, v227
    v_exp_f32 v236, v236
    v_exp_f32 v237, v237
    v_exp_f32 v238, v238
    v_exp_f32 v239, v239
    v_cvt_pk_bf16_f32 v130, v228, v229
    v_cvt_pk_bf16_f32 v131, v230, v231
    v_cvt_pk_bf16_f32 v132, v232, v233
    v_cvt_pk_bf16_f32 v133, v234, v235
    v_cvt_pk_bf16_f32 v134, v236, v237
    v_cvt_pk_bf16_f32 v135, v238, v239
    s_waitcnt lgkmcnt(3)
    v_mfma_f32_32x32x16_bf16 v[224:239], v[80:83], v[16:19], 0
    v_exp_f32 v240, v240
    v_exp_f32 v241, v241
    v_exp_f32 v242, v242
    s_waitcnt lgkmcnt(1)
    v_mfma_f32_32x32x16_bf16 v[40:55], v[104:107], v[128:131], 0
    v_exp_f32 v243, v243
    v_exp_f32 v244, v244
    v_exp_f32 v245, v245
    v_mfma_f32_32x32x16_bf16 v[224:239], v[84:87], v[20:23], v[224:239]
    ds_read_b128 v[80:83], v190 offset:6144
    ds_read_b128 v[84:87], v190 offset:7168
    v_exp_f32 v246, v246
    v_exp_f32 v247, v247
    v_exp_f32 v248, v248
    s_waitcnt lgkmcnt(2)
    v_mfma_f32_32x32x16_bf16 v[40:55], v[108:111], v[132:135], v[40:55]
    ds_read_b128 v[104:107], v191 offset:2048
    ds_read_b128 v[108:111], v191 offset:3072
    v_exp_f32 v249, v249
    v_exp_f32 v250, v250
    v_exp_f32 v251, v251
    v_cvt_pk_bf16_f32 v152, v240, v241
    v_cvt_pk_bf16_f32 v153, v242, v243
    v_mfma_f32_16x16x32_bf16 v[60:63], v[184:187], v[128:131], 0
    v_exp_f32 v252, v252
    v_exp_f32 v253, v253
    v_exp_f32 v254, v254
    v_exp_f32 v255, v255
    v_cvt_pk_bf16_f32 v154, v244, v245
    v_mfma_f32_16x16x32_bf16 v[60:63], v[184:187], v[132:135], v[60:63]
    v_cvt_pk_bf16_f32 v155, v246, v247
    v_cvt_pk_bf16_f32 v156, v248, v249
    v_cvt_pk_bf16_f32 v157, v250, v251
    v_cvt_pk_bf16_f32 v158, v252, v253
    v_cvt_pk_bf16_f32 v159, v254, v255
    s_waitcnt lgkmcnt(3)
    v_mfma_f32_32x32x16_bf16 v[240:255], v[80:83], v[16:19], 0
    v_exp_f32 v224, v224
    v_exp_f32 v225, v225
    v_exp_f32 v226, v226
    s_waitcnt lgkmcnt(1)
    v_mfma_f32_32x32x16_bf16 v[40:55], v[104:107], v[152:155], v[40:55]
    v_exp_f32 v227, v227
    v_exp_f32 v228, v228
    v_exp_f32 v229, v229
    v_mfma_f32_32x32x16_bf16 v[240:255], v[84:87], v[20:23], v[240:255]
    ds_read_b128 v[80:83], v190 offset:8192
    ds_read_b128 v[84:87], v190 offset:9216
    v_exp_f32 v230, v230
    v_exp_f32 v231, v231
    v_exp_f32 v232, v232
    s_waitcnt lgkmcnt(2)
    v_mfma_f32_32x32x16_bf16 v[40:55], v[108:111], v[156:159], v[40:55]
    ds_read_b128 v[104:107], v191 offset:4096
    ds_read_b128 v[108:111], v191 offset:5120
    v_exp_f32 v233, v233
    v_exp_f32 v234, v234
    v_exp_f32 v235, v235
    v_cvt_pk_bf16_f32 v128, v224, v225
    v_cvt_pk_bf16_f32 v129, v226, v227
    v_mfma_f32_16x16x32_bf16 v[60:63], v[184:187], v[152:155], v[60:63]
    v_exp_f32 v236, v236
    v_exp_f32 v237, v237
    v_exp_f32 v238, v238
    v_exp_f32 v239, v239
    v_cvt_pk_bf16_f32 v130, v228, v229
    v_mfma_f32_16x16x32_bf16 v[60:63], v[184:187], v[156:159], v[60:63]
    v_cvt_pk_bf16_f32 v131, v230, v231
    v_cvt_pk_bf16_f32 v132, v232, v233
    v_cvt_pk_bf16_f32 v133, v234, v235
    v_cvt_pk_bf16_f32 v134, v236, v237
    v_cvt_pk_bf16_f32 v135, v238, v239
    s_waitcnt lgkmcnt(3)
    v_mfma_f32_32x32x16_bf16 v[224:239], v[80:83], v[16:19], v[88:103]
    v_exp_f32 v240, v240
    v_exp_f32 v241, v241
    v_exp_f32 v242, v242
    s_waitcnt lgkmcnt(1)
    v_mfma_f32_32x32x16_bf16 v[40:55], v[104:107], v[128:131], v[40:55]
    v_exp_f32 v243, v243
    v_exp_f32 v244, v244
    v_exp_f32 v245, v245
    v_mfma_f32_32x32x16_bf16 v[224:239], v[84:87], v[20:23], v[224:239]
    v_exp_f32 v246, v246
    v_exp_f32 v247, v247
    v_exp_f32 v248, v248
    s_waitcnt lgkmcnt(0)
    v_mfma_f32_32x32x16_bf16 v[40:55], v[108:111], v[132:135], v[40:55]
    ds_read_b128 v[104:107], v191 offset:6144
    ds_read_b128 v[108:111], v191 offset:7168
    v_exp_f32 v249, v249
    v_exp_f32 v250, v250
    v_exp_f32 v251, v251
    v_cvt_pk_bf16_f32 v152, v240, v241
    v_cvt_pk_bf16_f32 v153, v242, v243
    v_mfma_f32_16x16x32_bf16 v[60:63], v[184:187], v[128:131], v[60:63]
    v_exp_f32 v252, v252
    v_exp_f32 v253, v253
    v_exp_f32 v254, v254
    v_exp_f32 v255, v255
    v_cvt_pk_bf16_f32 v154, v244, v245
    v_mfma_f32_16x16x32_bf16 v[60:63], v[184:187], v[132:135], v[60:63]
    v_cvt_pk_bf16_f32 v155, v246, v247
    v_cvt_pk_bf16_f32 v156, v248, v249
    v_cvt_pk_bf16_f32 v157, v250, v251
    v_cvt_pk_bf16_f32 v158, v252, v253
    v_cvt_pk_bf16_f32 v159, v254, v255
    v_exp_f32 v224, v224
    v_exp_f32 v225, v225
    v_exp_f32 v226, v226
    s_waitcnt lgkmcnt(1)
    v_mfma_f32_32x32x16_bf16 v[40:55], v[104:107], v[152:155], v[40:55]
    v_exp_f32 v227, v227
    v_exp_f32 v228, v228
    v_exp_f32 v229, v229
    v_exp_f32 v230, v230
    v_exp_f32 v231, v231
    v_exp_f32 v232, v232
    s_waitcnt lgkmcnt(0)
    v_mfma_f32_32x32x16_bf16 v[40:55], v[108:111], v[156:159], v[40:55]
    ds_read_b128 v[104:107], v191 offset:8192
    ds_read_b128 v[108:111], v191 offset:9216
    v_exp_f32 v233, v233
    v_exp_f32 v234, v234
    v_exp_f32 v235, v235
    v_cvt_pk_bf16_f32 v128, v224, v225
    v_cvt_pk_bf16_f32 v129, v226, v227
    v_mfma_f32_16x16x32_bf16 v[60:63], v[184:187], v[152:155], v[60:63]
    v_exp_f32 v236, v236
    v_exp_f32 v237, v237
    v_exp_f32 v238, v238
    v_exp_f32 v239, v239
    v_cvt_pk_bf16_f32 v130, v228, v229
    v_mfma_f32_16x16x32_bf16 v[60:63], v[184:187], v[156:159], v[60:63]
    v_cvt_pk_bf16_f32 v131, v230, v231
    v_cvt_pk_bf16_f32 v132, v232, v233
    v_cvt_pk_bf16_f32 v133, v234, v235
    v_cvt_pk_bf16_f32 v134, v236, v237
    v_cvt_pk_bf16_f32 v135, v238, v239
    s_nop 1
    s_waitcnt lgkmcnt(1)
    v_mfma_f32_32x32x16_bf16 v[40:55], v[104:107], v[128:131], v[40:55]
    s_waitcnt lgkmcnt(0)
    v_mfma_f32_32x32x16_bf16 v[40:55], v[108:111], v[132:135], v[40:55]
    v_mfma_f32_16x16x32_bf16 v[60:63], v[184:187], v[128:131], v[60:63]
    v_mfma_f32_16x16x32_bf16 v[60:63], v[184:187], v[132:135], v[60:63]
    s_waitcnt lgkmcnt(0)
    s_cmp_eq_u32 s61, 0
    s_cbranch_scc1 L_z3
    s_mov_b32 s72, 0x400000
L_wl3a:
    ds_read_b64 v[2:3], v198 offset:2048
    s_waitcnt lgkmcnt(0)
    v_readfirstlane_b32 s66, v2
    v_readfirstlane_b32 s67, v3
    s_cmp_eq_u32 s66, s77
    s_cselect_b32 s66, 1, 0
    s_cmp_eq_u32 s67, s81
    s_cselect_b32 s66, s66, 0
    s_cmp_lg_u32 s66, 0
    s_cbranch_scc1 L_wd3a
    s_sub_u32 s72, s72, 1
    s_cmp_eq_u32 s72, 0
    s_cbranch_scc1 L_wd3a
    s_sleep 1
    s_branch L_wl3a
L_wd3a:
    ds_read_b128 v[80:83], v196 offset:16384
    ds_read_b128 v[84:87], v196 offset:17408
    s_waitcnt lgkmcnt(1)
    v_mfma_f32_32x32x16_bf16 v[224:239], v[80:83], v[16:19], v[136:151]
    s_waitcnt lgkmcnt(0)
    v_mfma_f32_32x32x16_bf16 v[224:239], v[84:87], v[20:23], v[224:239]
    ds_read_b128 v[80:83], v196 offset:20480
    ds_read_b128 v[84:87], v196 offset:21504
    s_waitcnt lgkmcnt(1)
    v_mfma_f32_32x32x16_bf16 v[240:255], v[80:83], v[16:19], 0
    s_nop 7
    s_nop 3
    v_exp_f32 v224, v224
    v_exp_f32 v225, v225
    v_exp_f32 v226, v226
    v_exp_f32 v227, v227
    v_exp_f32 v228, v228
    v_exp_f32 v229, v229
    s_waitcnt lgkmcnt(0)
    v_mfma_f32_32x32x16_bf16 v[240:255], v[84:87], v[20:23], v[240:255]
    ds_read_b128 v[80:83], v196 offset:24576
    ds_read_b128 v[84:87], v196 offset:25600
    v_exp_f32 v230, v230
    v_exp_f32 v231, v231
    v_exp_f32 v232, v232
    ds_read_b128 v[104:107], v197 offset:16384
    ds_read_b128 v[108:111], v197 offset:17408
    v_exp_f32 v233, v233
    v_exp_f32 v234, v234
    v_exp_f32 v235, v235
    v_cvt_pk_bf16_f32 v128, v224, v225
    v_cvt_pk_bf16_f32 v129, v226, v227
    v_exp_f32 v236, v236
    v_exp_f32 v237, v237
    v_exp_f32 v238, v238
    v_exp_f32 v239, v239
    v_cvt_pk_bf16_f32 v130, v228, v229
    v_cvt_pk_bf16_f32 v131, v230, v231
    v_cvt_pk_bf16_f32 v132, v232, v233
    v_cvt_pk_bf16_f32 v133, v234, v235
    v_cvt_pk_bf16_f32 v134, v236, v237
    v_cvt_pk_bf16_f32 v135, v238, v239
    s_waitcnt lgkmcnt(3)
    v_mfma_f32_32x32x16_bf16 v[224:239], v[80:83], v[16:19], 0
    v_exp_f32 v240, v240
    v_exp_f32 v241, v241
    v_exp_f32 v242, v242
    s_waitcnt lgkmcnt(1)
    v_mfma_f32_32x32x16_bf16 v[40:55], v[104:107], v[128:131], v[40:55]
    v_exp_f32 v243, v243
    v_exp_f32 v244, v244
    v_exp_f32 v245, v245
    v_mfma_f32_32x32x16_bf16 v[224:239], v[84:87], v[20:23], v[224:239]
    ds_read_b128 v[80:83], v196 offset:28672
    ds_read_b128 v[84:87], v196 offset:29696
    v_exp_f32 v246, v246
    v_exp_f32 v247, v247
    v_exp_f32 v248, v248
    s_waitcnt lgkmcnt(2)
    v_mfma_f32_32x32x16_bf16 v[40:55], v[108:111], v[132:135], v[40:55]
    ds_read_b128 v[104:107], v197 offset:20480
    ds_read_b128 v[108:111], v197 offset:21504
    v_exp_f32 v249, v249
    v_exp_f32 v250, v250
    v_exp_f32 v251, v251
    v_cvt_pk_bf16_f32 v152, v240, v241
    v_cvt_pk_bf16_f32 v153, v242, v243
    v_mfma_f32_16x16x32_bf16 v[60:63], v[184:187], v[128:131], v[60:63]
    v_exp_f32 v252, v252
    v_exp_f32 v253, v253
    v_exp_f32 v254, v254
    v_exp_f32 v255, v255
    v_cvt_pk_bf16_f32 v154, v244, v245
    v_mfma_f32_16x16x32_bf16 v[60:63], v[184:187], v[132:135], v[60:63]
    v_cvt_pk_bf16_f32 v155, v246, v247
    v_cvt_pk_bf16_f32 v156, v248, v249
    v_cvt_pk_bf16_f32 v157, v250, v251
    v_cvt_pk_bf16_f32 v158, v252, v253
    v_cvt_pk_bf16_f32 v159, v254, v255
    s_waitcnt lgkmcnt(3)
    v_mfma_f32_32x32x16_bf16 v[240:255], v[80:83], v[16:19], 0
    v_exp_f32 v224, v224
    v_exp_f32 v225, v225
    v_exp_f32 v226, v226
    s_waitcnt lgkmcnt(1)
    v_mfma_f32_32x32x16_bf16 v[40:55], v[104:107], v[152:155], v[40:55]
    v_exp_f32 v227, v227
    v_exp_f32 v228, v228
    v_exp_f32 v229, v229
    v_mfma_f32_32x32x16_bf16 v[240:255], v[84:87], v[20:23], v[240:255]
    ds_read_b128 v[80:83], v190 offset:0
    ds_read_b128 v[84:87], v190 offset:1024
    v_exp_f32 v230, v230
    v_exp_f32 v231, v231
    v_exp_f32 v232, v232
    s_waitcnt lgkmcnt(2)
    v_mfma_f32_32x32x16_bf16 v[40:55], v[108:111], v[156:159], v[40:55]
    ds_read_b128 v[104:107], v197 offset:24576
    ds_read_b128 v[108:111], v197 offset:25600
    v_exp_f32 v233, v233
    v_exp_f32 v234, v234
    v_exp_f32 v235, v235
    v_cvt_pk_bf16_f32 v128, v224, v225
    v_cvt_pk_bf16_f32 v129, v226, v227
    v_mfma_f32_16x16x32_bf16 v[60:63], v[184:187], v[152:155], v[60:63]
    v_exp_f32 v236, v236
    v_exp_f32 v237, v237
    v_exp_f32 v238, v238
    v_exp_f32 v239, v239
    v_cvt_pk_bf16_f32 v130, v228, v229
    v_mfma_f32_16x16x32_bf16 v[60:63], v[184:187], v[156:159], v[60:63]
    v_cvt_pk_bf16_f32 v131, v230, v231
    v_cvt_pk_bf16_f32 v132, v232, v233
    v_cvt_pk_bf16_f32 v133, v234, v235
    v_cvt_pk_bf16_f32 v134, v236, v237
    v_cvt_pk_bf16_f32 v135, v238, v239
    s_waitcnt lgkmcnt(3)
    v_mfma_f32_32x32x16_bf16 v[224:239], v[80:83], v[8:11], 0
    v_exp_f32 v240, v240
    v_exp_f32 v241, v241
    v_exp_f32 v242, v242
    s_waitcnt lgkmcnt(1)
    v_mfma_f32_32x32x16_bf16 v[40:55], v[104:107], v[128:131], v[40:55]
    v_exp_f32 v243, v243
    v_exp_f32 v244, v244
    v_exp_f32 v245, v245
    v_mfma_f32_32x32x16_bf16 v[224:239], v[84:87], v[12:15], v[224:239]
    ds_read_b128 v[80:83], v190 offset:2048
    ds_read_b128 v[84:87], v190 offset:3072
    v_exp_f32 v246, v246
    v_exp_f32 v247, v247
    v_exp_f32 v248, v248
    s_waitcnt lgkmcnt(2)
    v_mfma_f32_32x32x16_bf16 v[40:55], v[108:111], v[132:135], v[40:55]
    ds_read_b128 v[104:107], v197 offset:28672
    ds_read_b128 v[108:111], v197 offset:29696
    v_exp_f32 v249, v249
    v_exp_f32 v250, v250
    v_exp_f32 v251, v251
    v_cvt_pk_bf16_f32 v152, v240, v241
    v_cvt_pk_bf16_f32 v153, v242, v243
    v_mfma_f32_16x16x32_bf16 v[60:63], v[184:187], v[128:131], v[60:63]
    v_exp_f32 v252, v252
    v_exp_f32 v253, v253
    v_exp_f32 v254, v254
    v_exp_f32 v255, v255
    v_cvt_pk_bf16_f32 v154, v244, v245
    v_mfma_f32_16x16x32_bf16 v[60:63], v[184:187], v[132:135], v[60:63]
    v_cvt_pk_bf16_f32 v155, v246, v247
    v_cvt_pk_bf16_f32 v156, v248, v249
    v_cvt_pk_bf16_f32 v157, v250, v251
    v_cvt_pk_bf16_f32 v158, v252, v253
    v_cvt_pk_bf16_f32 v159, v254, v255
    s_waitcnt lgkmcnt(3)
    v_mfma_f32_32x32x16_bf16 v[240:255], v[80:83], v[8:11], 0
    v_exp_f32 v224, v224
    v_exp_f32 v225, v225
    v_exp_f32 v226, v226
    s_waitcnt lgkmcnt(1)
    v_mfma_f32_32x32x16_bf16 v[40:55], v[104:107], v[152:155], v[40:55]
    v_exp_f32 v227, v227
    v_exp_f32 v228, v228
    v_exp_f32 v229, v229
    v_mfma_f32_32x32x16_bf16 v[240:255], v[84:87], v[12:15], v[240:255]
    ds_read_b128 v[80:83], v190 offset:4096
    ds_read_b128 v[84:87], v190 offset:5120
    v_exp_f32 v230, v230
    v_exp_f32 v231, v231
    v_exp_f32 v232, v232
    s_waitcnt lgkmcnt(2)
    v_mfma_f32_32x32x16_bf16 v[40:55], v[108:111], v[156:159], v[40:55]
    ds_read_b128 v[104:107], v191 offset:0
    ds_read_b128 v[108:111], v191 offset:1024
    v_exp_f32 v233, v233
    v_exp_f32 v234, v234
    v_exp_f32 v235, v235
    v_cvt_pk_bf16_f32 v128, v224, v225
    v_cvt_pk_bf16_f32 v129, v226, v227
    v_mfma_f32_16x16x32_bf16 v[60:63], v[184:187], v[152:155], v[60:63]
    v_exp_f32 v236, v236
    v_exp_f32 v237, v237
    v_exp_f32 v238, v238
    v_exp_f32 v239, v239
    v_cvt_pk_bf16_f32 v130, v228, v229
    v_mfma_f32_16x16x32_bf16 v[60:63], v[184:187], v[156:159], v[60:63]
    v_cvt_pk_bf16_f32 v131, v230, v231
    v_cvt_pk_bf16_f32 v132, v232, v233
    v_cvt_pk_bf16_f32 v133, v234, v235
    v_cvt_pk_bf16_f32 v134, v236, v237
    v_cvt_pk_bf16_f32 v135, v238, v239
    s_mov_b32 s88, 4
    s_nop 3
    v_cmp_le_f32 s[84:85], s34, v60
    v_cmp_ge_f32 s[86:87], s35, v60
    s_lshl_b32 s64, s88, 16
    s_add_u32 s64, s64, s89
    s_and_b64 s[84:85], s[84:85], s[86:87]
    s_cmp_eq_u64 s[84:85], -1
    s_cbranch_scc1 L_ok7
    s_call_b64 s[90:91], L_slowB
L_ok7:
    v_rcp_f32 v61, v60
    s_nop 0
    v_mul_f32 v40, v40, v61
    v_mul_f32 v41, v41, v61
    v_mul_f32 v42, v42, v61
    v_mul_f32 v43, v43, v61
    v_mul_f32 v44, v44, v61
    v_mul_f32 v45, v45, v61
    v_mul_f32 v46, v46, v61
    v_mul_f32 v47, v47, v61
    v_mul_f32 v48, v48, v61
    v_mul_f32 v49, v49, v61
    v_mul_f32 v50, v50, v61
    v_mul_f32 v51, v51, v61
    v_mul_f32 v52, v52, v61
    v_mul_f32 v53, v53, v61
    v_mul_f32 v54, v54, v61
    v_mul_f32 v55, v55, v61
    v_cvt_pk_bf16_f32 v40, v40, v41
    v_cvt_pk_bf16_f32 v41, v42, v43
    v_cvt_pk_bf16_f32 v42, v44, v45
    v_cvt_pk_bf16_f32 v43, v46, v47
    v_cvt_pk_bf16_f32 v44, v48, v49
    v_cvt_pk_bf16_f32 v45, v50, v51
    v_cvt_pk_bf16_f32 v46, v52, v53
    v_cvt_pk_bf16_f32 v47, v54, v55
    buffer_store_dwordx4 v[40:43], v189, s[44:47], s64 offen sc1
    buffer_store_dwordx4 v[44:47], v189, s[44:47], s64 offen offset:512 sc1
    s_waitcnt lgkmcnt(3)
    v_mfma_f32_32x32x16_bf16 v[224:239], v[80:83], v[8:11], 0
    v_exp_f32 v240, v240
    v_exp_f32 v241, v241
    v_exp_f32 v242, v242
    s_waitcnt lgkmcnt(1)
    v_mfma_f32_32x32x16_bf16 v[24:39], v[104:107], v[128:131], 0
    v_exp_f32 v243, v243
    v_exp_f32 v244, v244
    v_exp_f32 v245, v245
    v_mfma_f32_32x32x16_bf16 v[224:239], v[84:87], v[12:15], v[224:239]
    ds_read_b128 v[80:83], v190 offset:6144
    ds_read_b128 v[84:87], v190 offset:7168
    v_exp_f32 v246, v246
    v_exp_f32 v247, v247
    v_exp_f32 v248, v248
    s_waitcnt lgkmcnt(2)
    v_mfma_f32_32x32x16_bf16 v[24:39], v[108:111], v[132:135], v[24:39]
    ds_read_b128 v[104:107], v191 offset:2048
    ds_read_b128 v[108:111], v191 offset:3072
    v_exp_f32 v249, v249
    v_exp_f32 v250, v250
    v_exp_f32 v251, v251
    v_cvt_pk_bf16_f32 v152, v240, v241
    v_cvt_pk_bf16_f32 v153, v242, v243
    v_mfma_f32_16x16x32_bf16 v[56:59], v[184:187], v[128:131], 0
    v_exp_f32 v252, v252
    v_exp_f32 v253, v253
    v_exp_f32 v254, v254
    v_exp_f32 v255, v255
    v_cvt_pk_bf16_f32 v154, v244, v245
    v_mfma_f32_16x16x32_bf16 v[56:59], v[184:187], v[132:135], v[56:59]
    v_cvt_pk_bf16_f32 v155, v246, v247
    v_cvt_pk_bf16_f32 v156, v248, v249
    v_cvt_pk_bf16_f32 v157, v250, v251
    v_cvt_pk_bf16_f32 v158, v252, v253
    v_cvt_pk_bf16_f32 v159, v254, v255
    s_waitcnt lgkmcnt(3)
    v_mfma_f32_32x32x16_bf16 v[240:255], v[80:83], v[8:11], v[88:103]
    v_exp_f32 v224, v224
    v_exp_f32 v225, v225
    v_exp_f32 v226, v226
    s_waitcnt lgkmcnt(1)
    v_mfma_f32_32x32x16_bf16 v[24:39], v[104:107], v[152:155], v[24:39]
    v_exp_f32 v227, v227
    v_exp_f32 v228, v228
    v_exp_f32 v229, v229
    v_mfma_f32_32x32x16_bf16 v[240:255], v[84:87], v[12:15], v[240:255]
    v_exp_f32 v230, v230
    v_exp_f32 v231, v231
    v_exp_f32 v232, v232
    s_waitcnt lgkmcnt(0)
    v_mfma_f32_32x32x16_bf16 v[24:39], v[108:111], v[156:159], v[24:39]
    ds_read_b128 v[104:107], v191 offset:4096
    ds_read_b128 v[108:111], v191 offset:5120
    v_exp_f32 v233, v233
    v_exp_f32 v234, v234
    v_exp_f32 v235, v235
    v_cvt_pk_bf16_f32 v128, v224, v225
    v_cvt_pk_bf16_f32 v129, v226, v227
    v_mfma_f32_16x16x32_bf16 v[56:59], v[184:187], v[152:155], v[56:59]
    v_exp_f32 v236, v236
    v_exp_f32 v237, v237
    v_exp_f32 v238, v238
    v_exp_f32 v239, v239
    v_cvt_pk_bf16_f32 v130, v228, v229
    v_mfma_f32_16x16x32_bf16 v[56:59], v[184:187], v[156:159], v[56:59]
    v_cvt_pk_bf16_f32 v131, v230, v231
    v_cvt_pk_bf16_f32 v132, v232, v233
    v_cvt_pk_bf16_f32 v133, v234, v235
    v_cvt_pk_bf16_f32 v134, v236, v237
    v_cvt_pk_bf16_f32 v135, v238, v239
    s_mov_b32 s88, 4
    s_lshl_b32 s64, s88, 8
    s_add_u32 s64, s64, s96
    v_mov_b32 v4, s77
    v_mov_b32 v5, s81
    v_mov_b32 v6, 0
    s_waitcnt vmcnt(0)
    s_mov_b64 exec, 1
    buffer_store_dwordx2 v[4:5], v6, s[44:47], s64 offen sc1
    s_mov_b64 exec, -1
    s_nop 3
    v_exp_f32 v240, v240
    v_exp_f32 v241, v241
    v_exp_f32 v242, v242
    s_waitcnt lgkmcnt(1)
    v_mfma_f32_32x32x16_bf16 v[24:39], v[104:107], v[128:131], v[24:39]
    v_exp_f32 v243, v243
    v_exp_f32 v244, v244
    v_exp_f32 v245, v245
    v_exp_f32 v246, v246
    v_exp_f32 v247, v247
    v_exp_f32 v248, v248
    s_waitcnt lgkmcnt(0)
    v_mfma_f32_32x32x16_bf16 v[24:39], v[108:111], v[132:135], v[24:39]
    ds_read_b128 v[104:107], v191 offset:6144
    ds_read_b128 v[108:111], v191 offset:7168
    v_exp_f32 v249, v249
    v_exp_f32 v250, v250
    v_exp_f32 v251, v251
    v_cvt_pk_bf16_f32 v152, v240, v241
    v_cvt_pk_bf16_f32 v153, v242, v243
    v_mfma_f32_16x16x32_bf16 v[56:59], v[184:187], v[128:131], v[56:59]
    v_exp_f32 v252, v252
    v_exp_f32 v253, v253
    v_exp_f32 v254, v254
    v_exp_f32 v255, v255
    v_cvt_pk_bf16_f32 v154, v244, v245
    v_mfma_f32_16x16x32_bf16 v[56:59], v[184:187], v[132:135], v[56:59]
    v_cvt_pk_bf16_f32 v155, v246, v247
    v_cvt_pk_bf16_f32 v156, v248, v249
    v_cvt_pk_bf16_f32 v157, v250, v251
    v_cvt_pk_bf16_f32 v158, v252, v253
    v_cvt_pk_bf16_f32 v159, v254, v255
    s_nop 1
    s_waitcnt lgkmcnt(1)
    v_mfma_f32_32x32x16_bf16 v[24:39], v[104:107], v[152:155], v[24:39]
    s_waitcnt lgkmcnt(0)
    v_mfma_f32_32x32x16_bf16 v[24:39], v[108:111], v[156:159], v[24:39]
    v_mfma_f32_16x16x32_bf16 v[56:59], v[184:187], v[152:155], v[56:59]
    v_mfma_f32_16x16x32_bf16 v[56:59], v[184:187], v[156:159], v[56:59]
    s_branch L_w3
L_z3:
    s_nop 7
    s_mov_b32 s88, 4
    s_nop 3
    v_cmp_le_f32 s[84:85], s34, v60
    v_cmp_ge_f32 s[86:87], s35, v60
    s_lshl_b32 s64, s88, 16
    s_add_u32 s64, s64, s89
    s_and_b64 s[84:85], s[84:85], s[86:87]
    s_cmp_eq_u64 s[84:85], -1
    s_cbranch_scc1 L_ok8
    s_call_b64 s[90:91], L_slowB
L_ok8:
    v_rcp_f32 v61, v60
    s_nop 0
    v_mul_f32 v40, v40, v61
    v_mul_f32 v41, v41, v61
    v_mul_f32 v42, v42, v61
    v_mul_f32 v43, v43, v61
    v_mul_f32 v44, v44, v61
    v_mul_f32 v45, v45, v61
    v_mul_f32 v46, v46, v61
    v_mul_f32 v47, v47, v61
    v_mul_f32 v48, v48, v61
    v_mul_f32 v49, v49, v61
    v_mul_f32 v50, v50, v61
    v_mul_f32 v51, v51, v61
    v_mul_f32 v52, v52, v61
    v_mul_f32 v53, v53, v61
    v_mul_f32 v54, v54, v61
    v_mul_f32 v55, v55, v61
    v_cvt_pk_bf16_f32 v40, v40, v41
    v_cvt_pk_bf16_f32 v41, v42, v43
    v_cvt_pk_bf16_f32 v42, v44, v45
    v_cvt_pk_bf16_f32 v43, v46, v47
    v_cvt_pk_bf16_f32 v44, v48, v49
    v_cvt_pk_bf16_f32 v45, v50, v51
    v_cvt_pk_bf16_f32 v46, v52, v53
    v_cvt_pk_bf16_f32 v47, v54, v55
    buffer_store_dwordx4 v[40:43], v189, s[44:47], s64 offen sc1
    buffer_store_dwordx4 v[44:47], v189, s[44:47], s64 offen offset:512 sc1
    ds_read_b128 v[80:83], v190 offset:0
    ds_read_b128 v[84:87], v190 offset:1024
    s_waitcnt lgkmcnt(1)
    v_mfma_f32_32x32x16_bf16 v[224:239], v[80:83], v[8:11], 0
    s_waitcnt lgkmcnt(0)
    v_mfma_f32_32x32x16_bf16 v[224:239], v[84:87], v[12:15], v[224:239]
    ds_read_b128 v[80:83], v190 offset:2048
    ds_read_b128 v[84:87], v190 offset:3072
    s_waitcnt lgkmcnt(1)
    v_mfma_f32_32x32x16_bf16 v[240:255], v[80:83], v[8:11], 0
    s_nop 7
    s_nop 3
    v_exp_f32 v224, v224
    v_exp_f32 v225, v225
    v_exp_f32 v226, v226
    v_exp_f32 v227, v227
    v_exp_f32 v228, v228
    v_exp_f32 v229, v229
    s_waitcnt lgkmcnt(0)
    v_mfma_f32_32x32x16_bf16 v[240:255], v[84:87], v[12:15], v[240:255]
    ds_read_b128 v[80:83], v190 offset:4096
    ds_read_b128 v[84:87], v190 offset:5120
    v_exp_f32 v230, v230
    v_exp_f32 v231, v231
    v_exp_f32 v232, v232
    ds_read_b128 v[104:107], v191 offset:0
    ds_read_b128 v[108:111], v191 offset:1024
    v_exp_f32 v233, v233
    v_exp_f32 v234, v234
    v_exp_f32 v235, v235
    v_cvt_pk_bf16_f32 v128, v224, v225
    v_cvt_pk_bf16_f32 v129, v226, v227
    v_exp_f32 v236, v236
    v_exp_f32 v237, v237
    v_exp_f32 v238, v238
    v_exp_f32 v239, v239
    v_cvt_pk_bf16_f32 v130, v228, v229
    v_cvt_pk_bf16_f32 v131, v230, v231
    v_cvt_pk_bf16_f32 v132, v232, v233
    v_cvt_pk_bf16_f32 v133, v234, v235
    v_cvt_pk_bf16_f32 v134, v236, v237
    v_cvt_pk_bf16_f32 v135, v238, v239
    s_waitcnt lgkmcnt(3)
    v_mfma_f32_32x32x16_bf16 v[224:239], v[80:83], v[8:11], 0
    v_exp_f32 v240, v240
    v_exp_f32 v241, v241
    v_exp_f32 v242, v242
    s_waitcnt lgkmcnt(1)
    v_mfma_f32_32x32x16_bf16 v[24:39], v[104:107], v[128:131], 0
    v_exp_f32 v243, v243
    v_exp_f32 v244, v244
    v_exp_f32 v245, v245
    v_mfma_f32_32x32x16_bf16 v[224:239], v[84:87], v[12:15], v[224:239]
    ds_read_b128 v[80:83], v190 offset:6144
    ds_read_b128 v[84:87], v190 offset:7168
    v_exp_f32 v246, v246
    v_exp_f32 v247, v247
    v_exp_f32 v248, v248
    s_waitcnt lgkmcnt(2)
    v_mfma_f32_32x32x16_bf16 v[24:39], v[108:111], v[132:135], v[24:39]
    ds_read_b128 v[104:107], v191 offset:2048
    ds_read_b128 v[108:111], v191 offset:3072
    v_exp_f32 v249, v249
    v_exp_f32 v250, v250
    v_exp_f32 v251, v251
    v_cvt_pk_bf16_f32 v152, v240, v241
    v_cvt_pk_bf16_f32 v153, v242, v243
    v_mfma_f32_16x16x32_bf16 v[56:59], v[184:187], v[128:131], 0
    v_exp_f32 v252, v252
    v_exp_f32 v253, v253
    v_exp_f32 v254, v254
    v_exp_f32 v255, v255
    v_cvt_pk_bf16_f32 v154, v244, v245
    v_mfma_f32_16x16x32_bf16 v[56:59], v[184:187], v[132:135], v[56:59]
    v_cvt_pk_bf16_f32 v155, v246, v247
    v_cvt_pk_bf16_f32 v156, v248, v249
    v_cvt_pk_bf16_f32 v157, v250, v251
    v_cvt_pk_bf16_f32 v158, v252, v253
    v_cvt_pk_bf16_f32 v159, v254, v255
    s_waitcnt lgkmcnt(3)
    v_mfma_f32_32x32x16_bf16 v[240:255], v[80:83], v[8:11], v[88:103]
    v_exp_f32 v224, v224
    v_exp_f32 v225, v225
    v_exp_f32 v226, v226
    s_waitcnt lgkmcnt(1)
    v_mfma_f32_32x32x16_bf16 v[24:39], v[104:107], v[152:155], v[24:39]
    v_exp_f32 v227, v227
    v_exp_f32 v228, v228
    v_exp_f32 v229, v229
    v_mfma_f32_32x32x16_bf16 v[240:255], v[84:87], v[12:15], v[240:255]
    v_exp_f32 v230, v230
    v_exp_f32 v231, v231
    v_exp_f32 v232, v232
    s_waitcnt lgkmcnt(0)
    v_mfma_f32_32x32x16_bf16 v[24:39], v[108:111], v[156:159], v[24:39]
    ds_read_b128 v[104:107], v191 offset:4096
    ds_read_b128 v[108:111], v191 offset:5120
    v_exp_f32 v233, v233
    v_exp_f32 v234, v234
    v_exp_f32 v235, v235
    v_cvt_pk_bf16_f32 v128, v224, v225
    v_cvt_pk_bf16_f32 v129, v226, v227
    v_mfma_f32_16x16x32_bf16 v[56:59], v[184:187], v[152:155], v[56:59]
    v_exp_f32 v236, v236
    v_exp_f32 v237, v237
    v_exp_f32 v238, v238
    v_exp_f32 v239, v239
    v_cvt_pk_bf16_f32 v130, v228, v229
    v_mfma_f32_16x16x32_bf16 v[56:59], v[184:187], v[156:159], v[56:59]
    v_cvt_pk_bf16_f32 v131, v230, v231
    v_cvt_pk_bf16_f32 v132, v232, v233
    v_cvt_pk_bf16_f32 v133, v234, v235
    v_cvt_pk_bf16_f32 v134, v236, v237
    v_cvt_pk_bf16_f32 v135, v238, v239
    v_exp_f32 v240, v240
    v_exp_f32 v241, v241
    v_exp_f32 v242, v242
    s_waitcnt lgkmcnt(1)
    v_mfma_f32_32x32x16_bf16 v[24:39], v[104:107], v[128:131], v[24:39]
    v_exp_f32 v243, v243
    v_exp_f32 v244, v244
    v_exp_f32 v245, v245
    v_exp_f32 v246, v246
    v_exp_f32 v247, v247
    v_exp_f32 v248, v248
    s_waitcnt lgkmcnt(0)
    v_mfma_f32_32x32x16_bf16 v[24:39], v[108:111], v[132:135], v[24:39]
    ds_read_b128 v[104:107], v191 offset:6144
    ds_read_b128 v[108:111], v191 offset:7168
    v_exp_f32 v249, v249
    v_exp_f32 v250, v250
    v_exp_f32 v251, v251
    v_cvt_pk_bf16_f32 v152, v240, v241
    v_cvt_pk_bf16_f32 v153, v242, v243
    v_mfma_f32_16x16x32_bf16 v[56:59], v[184:187], v[128:131], v[56:59]
    v_exp_f32 v252, v252
    v_exp_f32 v253, v253
    v_exp_f32 v254, v254
    v_exp_f32 v255, v255
    v_cvt_pk_bf16_f32 v154, v244, v245
    v_mfma_f32_16x16x32_bf16 v[56:59], v[184:187], v[132:135], v[56:59]
    v_cvt_pk_bf16_f32 v155, v246, v247
    v_cvt_pk_bf16_f32 v156, v248, v249
    v_cvt_pk_bf16_f32 v157, v250, v251
    v_cvt_pk_bf16_f32 v158, v252, v253
    v_cvt_pk_bf16_f32 v159, v254, v255
    s_nop 1
    s_waitcnt lgkmcnt(1)
    v_mfma_f32_32x32x16_bf16 v[24:39], v[104:107], v[152:155], v[24:39]
    s_waitcnt lgkmcnt(0)
    v_mfma_f32_32x32x16_bf16 v[24:39], v[108:111], v[156:159], v[24:39]
    v_mfma_f32_16x16x32_bf16 v[56:59], v[184:187], v[152:155], v[56:59]
    v_mfma_f32_16x16x32_bf16 v[56:59], v[184:187], v[156:159], v[56:59]
    s_mov_b32 s88, 4
    s_lshl_b32 s64, s88, 8
    s_add_u32 s64, s64, s96
    v_mov_b32 v4, s77
    v_mov_b32 v5, s81
    v_mov_b32 v6, 0
    s_waitcnt vmcnt(0)
    s_mov_b64 exec, 1
    buffer_store_dwordx2 v[4:5], v6, s[44:47], s64 offen sc1
    s_mov_b64 exec, -1
    s_nop 3
L_w3:
    s_waitcnt lgkmcnt(0)
    s_barrier
    s_cmp_eq_u32 s61, 0
    s_cbranch_scc1 L_y3
    ds_read_b128 v[80:83], v196 offset:28672
    ds_read_b128 v[84:87], v196 offset:29696
    s_waitcnt lgkmcnt(1)
    v_mfma_f32_32x32x16_bf16 v[224:239], v[80:83], v[8:11], 0
    s_waitcnt lgkmcnt(0)
    v_mfma_f32_32x32x16_bf16 v[224:239], v[84:87], v[12:15], v[224:239]
    ds_read_b128 v[80:83], v196 offset:24576
    ds_read_b128 v[84:87], v196 offset:25600
    s_add_u32 m0, s82, 0
    s_mov_b32 s67, 0
    buffer_load_dwordx4 v188, s[48:51], s67 offen lds
    s_add_u32 m0, s82, 8192
    s_mov_b32 s67, 65536
    buffer_load_dwordx4 v188, s[48:51], s67 offen lds
    s_add_u32 m0, s82, 16384
    s_mov_b32 s67, 131072
    buffer_load_dwordx4 v188, s[48:51], s67 offen lds
    s_waitcnt lgkmcnt(1)
    v_mfma_f32_32x32x16_bf16 v[240:255], v[80:83], v[8:11], 0
    s_nop 7
    s_nop 3
    v_exp_f32 v224, v224
    v_exp_f32 v225, v225
    v_exp_f32 v226, v226
    v_exp_f32 v227, v227
    v_exp_f32 v228, v228
    v_exp_f32 v229, v229
    s_waitcnt lgkmcnt(0)
    v_mfma_f32_32x32x16_bf16 v[240:255], v[84:87], v[12:15], v[240:255]
    ds_read_b128 v[80:83], v196 offset:20480
    ds_read_b128 v[84:87], v196 offset:21504
    v_exp_f32 v230, v230
    v_exp_f32 v231, v231
    v_exp_f32 v232, v232
    ds_read_b128 v[104:107], v197 offset:28672
    ds_read_b128 v[108:111], v197 offset:29696
    v_exp_f32 v233, v233
    v_exp_f32 v234, v234
    v_exp_f32 v235, v235
    v_cvt_pk_bf16_f32 v128, v224, v225
    v_cvt_pk_bf16_f32 v129, v226, v227
    v_exp_f32 v236, v236
    v_exp_f32 v237, v237
    v_exp_f32 v238, v238
    v_exp_f32 v239, v239
    v_cvt_pk_bf16_f32 v130, v228, v229
    v_cvt_pk_bf16_f32 v131, v230, v231
    v_cvt_pk_bf16_f32 v132, v232, v233
    v_cvt_pk_bf16_f32 v133, v234, v235
    v_cvt_pk_bf16_f32 v134, v236, v237
    v_cvt_pk_bf16_f32 v135, v238, v239
    s_add_u32 m0, s82, 24576
    s_mov_b32 s67, 196608
    buffer_load_dwordx4 v188, s[48:51], s67 offen lds
    s_add_u32 m0, s82, 98304
    s_mov_b32 s67, 262144
    buffer_load_dwordx4 v188, s[48:51], s67 offen lds
    s_add_u32 m0, s82, 106496
    s_mov_b32 s67, 327680
    buffer_load_dwordx4 v188, s[48:51], s67 offen lds
    s_waitcnt lgkmcnt(3)
    v_mfma_f32_32x32x16_bf16 v[224:239], v[80:83], v[8:11], 0
    v_exp_f32 v240, v240
    v_exp_f32 v241, v241
    v_exp_f32 v242, v242
    s_waitcnt lgkmcnt(1)
    v_mfma_f32_32x32x16_bf16 v[24:39], v[104:107], v[128:131], v[24:39]
    v_exp_f32 v243, v243
    v_exp_f32 v244, v244
    v_exp_f32 v245, v245
    v_mfma_f32_32x32x16_bf16 v[224:239], v[84:87], v[12:15], v[224:239]
    ds_read_b128 v[80:83], v196 offset:16384
    ds_read_b128 v[84:87], v196 offset:17408
    v_exp_f32 v246, v246
    v_exp_f32 v247, v247
    v_exp_f32 v248, v248
    s_waitcnt lgkmcnt(2)
    v_mfma_f32_32x32x16_bf16 v[24:39], v[108:111], v[132:135], v[24:39]
    ds_read_b128 v[104:107], v197 offset:24576
    ds_read_b128 v[108:111], v197 offset:25600
    v_exp_f32 v249, v249
    v_exp_f32 v250, v250
    v_exp_f32 v251, v251
    v_cvt_pk_bf16_f32 v152, v240, v241
    v_cvt_pk_bf16_f32 v153, v242, v243
    v_mfma_f32_16x16x32_bf16 v[56:59], v[184:187], v[128:131], v[56:59]
    v_exp_f32 v252, v252
    v_exp_f32 v253, v253
    v_exp_f32 v254, v254
    v_exp_f32 v255, v255
    v_cvt_pk_bf16_f32 v154, v244, v245
    v_mfma_f32_16x16x32_bf16 v[56:59], v[184:187], v[132:135], v[56:59]
    v_cvt_pk_bf16_f32 v155, v246, v247
    v_cvt_pk_bf16_f32 v156, v248, v249
    v_cvt_pk_bf16_f32 v157, v250, v251
    v_cvt_pk_bf16_f32 v158, v252, v253
    v_cvt_pk_bf16_f32 v159, v254, v255
    s_add_u32 m0, s82, 114688
    s_mov_b32 s67, 393216
    buffer_load_dwordx4 v188, s[48:51], s67 offen lds
    s_add_u32 m0, s82, 122880
    s_mov_b32 s67, 458752
    buffer_load_dwordx4 v188, s[48:51], s67 offen lds
    s_add_u32 m0, s82, 131072
    s_mov_b32 s67, 524288
    buffer_load_dwordx4 v188, s[48:51], s67 offen lds
    s_lshl_b32 s66, s74, 3
    s_add_u32 s66, s66, 155648
    v_mov_b32 v198, s66
    s_waitcnt lgkmcnt(0)
    s_mov_b32 s72, 0x400000
L_wl3b:
    ds_read_b64 v[2:3], v198 offset:0
    s_waitcnt lgkmcnt(0)
    v_readfirstlane_b32 s66, v2
    v_readfirstlane_b32 s67, v3
    s_cmp_eq_u32 s66, s77
    s_cselect_b32 s66, 1, 0
    s_cmp_eq_u32 s67, s81
    s_cselect_b32 s66, s66, 0
    s_cmp_lg_u32 s66, 0
    s_cbranch_scc1 L_wd3b
    s_sub_u32 s72, s72, 1
    s_cmp_eq_u32 s72, 0
    s_cbranch_scc1 L_wd3b
    s_sleep 1
    s_branch L_wl3b
L_wd3b:
    v_mfma_f32_32x32x16_bf16 v[240:255], v[80:83], v[8:11], 0
    v_exp_f32 v224, v224
    v_exp_f32 v225, v225
    v_exp_f32 v226, v226
    v_mfma_f32_32x32x16_bf16 v[24:39], v[104:107], v[152:155], v[24:39]
    v_exp_f32 v227, v227
    v_exp_f32 v228, v228
    v_exp_f32 v229, v229
    v_mfma_f32_32x32x16_bf16 v[240:255], v[84:87], v[12:15], v[240:255]
    ds_read_b128 v[80:83], v196 offset:12288
    ds_read_b128 v[84:87], v196 offset:13312
    v_exp_f32 v230, v230
    v_exp_f32 v231, v231
    v_exp_f32 v232, v232
    v_mfma_f32_32x32x16_bf16 v[24:39], v[108:111], v[156:159], v[24:39]
    ds_read_b128 v[104:107], v197 offset:20480
    ds_read_b128 v[108:111], v197 offset:21504
    v_exp_f32 v233, v233
    v_exp_f32 v234, v234
    v_exp_f32 v235, v235
    v_cvt_pk_bf16_f32 v128, v224, v225
    v_cvt_pk_bf16_f32 v129, v226, v227
    v_mfma_f32_16x16x32_bf16 v[56:59], v[184:187], v[152:155], v[56:59]
    v_exp_f32 v236, v236
    v_exp_f32 v237, v237
    v_exp_f32 v238, v238
    v_exp_f32 v239, v239
    v_cvt_pk_bf16_f32 v130, v228, v229
    v_mfma_f32_16x16x32_bf16 v[56:59], v[184:187], v[156:159], v[56:59]
    v_cvt_pk_bf16_f32 v131, v230, v231
    v_cvt_pk_bf16_f32 v132, v232, v233
    v_cvt_pk_bf16_f32 v133, v234, v235
    v_cvt_pk_bf16_f32 v134, v236, v237
    v_cvt_pk_bf16_f32 v135, v238, v239
    s_add_u32 m0, s82, 139264
    s_mov_b32 s67, 589824
    buffer_load_dwordx4 v188, s[48:51], s67 offen lds
    s_add_u32 m0, s82, 147456
    s_mov_b32 s67, 655360
    buffer_load_dwordx4 v188, s[48:51], s67 offen lds
    s_waitcnt lgkmcnt(3)
    v_mfma_f32_32x32x16_bf16 v[224:239], v[80:83], v[8:11], v[136:151]
    v_exp_f32 v240, v240
    v_exp_f32 v241, v241
    v_exp_f32 v242, v242
    s_waitcnt lgkmcnt(1)
    v_mfma_f32_32x32x16_bf16 v[24:39], v[104:107], v[128:131], v[24:39]
    v_exp_f32 v243, v243
    v_exp_f32 v244, v244
    v_exp_f32 v245, v245
    v_mfma_f32_32x32x16_bf16 v[224:239], v[84:87], v[12:15], v[224:239]
    v_exp_f32 v246, v246
    v_exp_f32 v247, v247
    v_exp_f32 v248, v248
    s_waitcnt lgkmcnt(0)
    v_mfma_f32_32x32x16_bf16 v[24:39], v[108:111], v[132:135], v[24:39]
    ds_read_b128 v[104:107], v197 offset:16384
    ds_read_b128 v[108:111], v197 offset:17408
    v_exp_f32 v249, v249
    v_exp_f32 v250, v250
    v_exp_f32 v251, v251
    v_cvt_pk_bf16_f32 v152, v240, v241
    v_cvt_pk_bf16_f32 v153, v242, v243
    v_mfma_f32_16x16x32_bf16 v[56:59], v[184:187], v[128:131], v[56:59]
    v_exp_f32 v252, v252
    v_exp_f32 v253, v253
    v_exp_f32 v254, v254
    v_exp_f32 v255, v255
    v_cvt_pk_bf16_f32 v154, v244, v245
    v_mfma_f32_16x16x32_bf16 v[56:59], v[184:187], v[132:135], v[56:59]
    v_cvt_pk_bf16_f32 v155, v246, v247
    v_cvt_pk_bf16_f32 v156, v248, v249
    v_cvt_pk_bf16_f32 v157, v250, v251
    v_cvt_pk_bf16_f32 v158, v252, v253
    v_cvt_pk_bf16_f32 v159, v254, v255
    s_lshr_b32 s73, s63, 2
    s_and_b32 s76, s63, 3
    s_lshl_b32 s64, s60, 3
    s_add_u32 s64, s64, s79
    s_lshl_b32 s65, s64, 3
    s_add_u32 s65, s65, s76
    s_lshl_b32 s71, s65, 8
    s_lshl_b32 s66, s73, 7
    s_add_u32 s71, s71, s66
    s_add_u32 s71, s71, 25231360
    v_and_b32 v7, 15, v0
    v_lshlrev_b32 v7, 3, v7
    s_lshl_b32 s70, s65, 16
    s_lshl_b32 s66, s73, 14
    s_add_u32 s70, s70, s66
    s_add_u32 s70, s70, 17039360
    v_add_u32 v192, 0x8000, v1
    s_and_b32 s66, s80, 0
    s_lshl_b32 s66, s66, 10
    s_add_u32 s70, s70, s66
    buffer_load_dwordx2 v[2:3], v7, s[44:47], s71 offen offset:1024 sc1
    v_exp_f32 v224, v224
    v_exp_f32 v225, v225
    v_exp_f32 v226, v226
    s_waitcnt lgkmcnt(1)
    v_mfma_f32_32x32x16_bf16 v[24:39], v[104:107], v[152:155], v[24:39]
    v_exp_f32 v227, v227
    v_exp_f32 v228, v228
    v_exp_f32 v229, v229
    v_exp_f32 v230, v230
    v_exp_f32 v231, v231
    v_exp_f32 v232, v232
    s_waitcnt lgkmcnt(0)
    v_mfma_f32_32x32x16_bf16 v[24:39], v[108:111], v[156:159], v[24:39]
    ds_read_b128 v[104:107], v197 offset:12288
    ds_read_b128 v[108:111], v197 offset:13312
    v_exp_f32 v233, v233
    v_exp_f32 v234, v234
    v_exp_f32 v235, v235
    v_cvt_pk_bf16_f32 v128, v224, v225
    v_cvt_pk_bf16_f32 v129, v226, v227
    v_mfma_f32_16x16x32_bf16 v[56:59], v[184:187], v[152:155], v[56:59]
    v_exp_f32 v236, v236
    v_exp_f32 v237, v237
    v_exp_f32 v238, v238
    v_exp_f32 v239, v239
    v_cvt_pk_bf16_f32 v130, v228, v229
    v_mfma_f32_16x16x32_bf16 v[56:59], v[184:187], v[156:159], v[56:59]
    v_cvt_pk_bf16_f32 v131, v230, v231
    v_cvt_pk_bf16_f32 v132, v232, v233
    v_cvt_pk_bf16_f32 v133, v234, v235
    v_cvt_pk_bf16_f32 v134, v236, v237
    v_cvt_pk_bf16_f32 v135, v238, v239
    s_nop 1
    s_waitcnt lgkmcnt(1)
    v_mfma_f32_32x32x16_bf16 v[24:39], v[104:107], v[128:131], v[24:39]
    s_waitcnt lgkmcnt(0)
    v_mfma_f32_32x32x16_bf16 v[24:39], v[108:111], v[132:135], v[24:39]
    v_mfma_f32_16x16x32_bf16 v[56:59], v[184:187], v[128:131], v[56:59]
    v_mfma_f32_16x16x32_bf16 v[56:59], v[184:187], v[132:135], v[56:59]
    s_mov_b32 s88, 3
    s_nop 7
    s_branch L_last
L_y3:
    s_add_u32 m0, s82, 0
    s_mov_b32 s67, 0
    buffer_load_dwordx4 v188, s[48:51], s67 offen lds
    s_add_u32 m0, s82, 8192
    s_mov_b32 s67, 65536
    buffer_load_dwordx4 v188, s[48:51], s67 offen lds
    s_add_u32 m0, s82, 16384
    s_mov_b32 s67, 131072
    buffer_load_dwordx4 v188, s[48:51], s67 offen lds
    s_add_u32 m0, s82, 24576
    s_mov_b32 s67, 196608
    buffer_load_dwordx4 v188, s[48:51], s67 offen lds
    s_add_u32 m0, s82, 98304
    s_mov_b32 s67, 262144
    buffer_load_dwordx4 v188, s[48:51], s67 offen lds
    s_add_u32 m0, s82, 106496
    s_mov_b32 s67, 327680
    buffer_load_dwordx4 v188, s[48:51], s67 offen lds
    s_add_u32 m0, s82, 114688
    s_mov_b32 s67, 393216
    buffer_load_dwordx4 v188, s[48:51], s67 offen lds
    s_add_u32 m0, s82, 122880
    s_mov_b32 s67, 458752
    buffer_load_dwordx4 v188, s[48:51], s67 offen lds
    s_add_u32 m0, s82, 131072
    s_mov_b32 s67, 524288
    buffer_load_dwordx4 v188, s[48:51], s67 offen lds
    s_add_u32 m0, s82, 139264
    s_mov_b32 s67, 589824
    buffer_load_dwordx4 v188, s[48:51], s67 offen lds
    s_add_u32 m0, s82, 147456
    s_mov_b32 s67, 655360
    buffer_load_dwordx4 v188, s[48:51], s67 offen lds
    s_lshr_b32 s73, s63, 2
    s_and_b32 s76, s63, 3
    s_lshl_b32 s64, s60, 3
    s_add_u32 s64, s64, s79
    s_lshl_b32 s65, s64, 3
    s_add_u32 s65, s65, s76
    s_lshl_b32 s71, s65, 8
    s_lshl_b32 s66, s73, 7
    s_add_u32 s71, s71, s66
    s_add_u32 s71, s71, 25231360
    v_and_b32 v7, 15, v0
    v_lshlrev_b32 v7, 3, v7
    s_lshl_b32 s70, s65, 16
    s_lshl_b32 s66, s73, 14
    s_add_u32 s70, s70, s66
    s_add_u32 s70, s70, 17039360
    v_add_u32 v192, 0x8000, v1
    s_and_b32 s66, s80, 0
    s_lshl_b32 s66, s66, 10
    s_add_u32 s70, s70, s66
    buffer_load_dwordx2 v[2:3], v7, s[44:47], s71 offen offset:1024 sc1
    s_waitcnt lgkmcnt(0)
    s_mov_b32 s88, 3
L_last:
    s_nop 3
    v_cmp_le_f32 s[84:85], s34, v56
    v_cmp_ge_f32 s[86:87], s35, v56
    s_lshl_b32 s64, s88, 16
    s_add_u32 s64, s64, s89
    s_and_b64 s[84:85], s[84:85], s[86:87]
    s_cmp_eq_u64 s[84:85], -1
    s_cbranch_scc1 L_ok9
    s_call_b64 s[90:91], L_slowA
L_ok9:
    v_rcp_f32 v57, v56
    s_nop 0
    v_mul_f32 v24, v24, v57
    v_mul_f32 v25, v25, v57
    v_mul_f32 v26, v26, v57
    v_mul_f32 v27, v27, v57
    v_mul_f32 v28, v28, v57
    v_mul_f32 v29, v29, v57
    v_mul_f32 v30, v30, v57
    v_mul_f32 v31, v31, v57
    v_mul_f32 v32, v32, v57
    v_mul_f32 v33, v33, v57
    v_mul_f32 v34, v34, v57
    v_mul_f32 v35, v35, v57
    v_mul_f32 v36, v36, v57
    v_mul_f32 v37, v37, v57
    v_mul_f32 v38, v38, v57
    v_mul_f32 v39, v39, v57
    v_cvt_pk_bf16_f32 v24, v24, v25
    v_cvt_pk_bf16_f32 v25, v26, v27
    v_cvt_pk_bf16_f32 v26, v28, v29
    v_cvt_pk_bf16_f32 v27, v30, v31
    v_cvt_pk_bf16_f32 v28, v32, v33
    v_cvt_pk_bf16_f32 v29, v34, v35
    v_cvt_pk_bf16_f32 v30, v36, v37
    v_cvt_pk_bf16_f32 v31, v38, v39
    buffer_store_dwordx4 v[24:27], v189, s[44:47], s64 offen sc1
    buffer_store_dwordx4 v[28:31], v189, s[44:47], s64 offen offset:512 sc1
    s_waitcnt vmcnt(2)
    v_cmp_eq_u32 s[84:85], s77, v2
    v_cmp_eq_u32 s[86:87], s81, v3
    s_nop 1
    s_and_b64 s[84:85], s[84:85], s[86:87]
    s_cmp_eq_u64 s[84:85], -1
    s_cbranch_scc0 L_late
    buffer_load_dwordx4 v[64:67], v1, s[44:47], s70 offen offset:0 sc1
    buffer_load_dwordx4 v[68:71], v192, s[44:47], s70 offen offset:0 sc1
    buffer_load_dwordx4 v[72:75], v1, s[44:47], s70 offen offset:1024 sc1
    buffer_load_dwordx4 v[76:79], v192, s[44:47], s70 offen offset:1024 sc1
    buffer_load_dwordx4 v[112:115], v1, s[44:47], s70 offen offset:2048 sc1
    buffer_load_dwordx4 v[116:119], v192, s[44:47], s70 offen offset:2048 sc1
    buffer_load_dwordx4 v[120:123], v1, s[44:47], s70 offen offset:3072 sc1
    buffer_load_dwordx4 v[124:127], v192, s[44:47], s70 offen offset:3072 sc1
    s_add_u32 s70, s70, 4096
    buffer_load_dwordx4 v[160:163], v1, s[44:47], s70 offen offset:0 sc1
    buffer_load_dwordx4 v[164:167], v192, s[44:47], s70 offen offset:0 sc1
    buffer_load_dwordx4 v[168:171], v1, s[44:47], s70 offen offset:1024 sc1
    buffer_load_dwordx4 v[172:175], v192, s[44:47], s70 offen offset:1024 sc1
    s_lshl_b32 s64, s88, 8
    s_add_u32 s64, s64, s96
    v_mov_b32 v4, s77
    v_mov_b32 v5, s81
    v_mov_b32 v6, 0
    s_waitcnt vmcnt(12)
    s_mov_b64 exec, 1
    buffer_store_dwordx2 v[4:5], v6, s[44:47], s64 offen sc1
    s_mov_b64 exec, -1
    s_nop 3
    s_branch L_p3
L_late:
    s_lshl_b32 s64, s88, 8
    s_add_u32 s64, s64, s96
    v_mov_b32 v4, s77
    v_mov_b32 v5, s81
    v_mov_b32 v6, 0
    s_waitcnt vmcnt(0)
    s_mov_b64 exec, 1
    buffer_store_dwordx2 v[4:5], v6, s[44:47], s64 offen sc1
    s_mov_b64 exec, -1
    s_nop 3
    buffer_load_dwordx2 v[2:3], v7, s[44:47], s71 offen offset:1024 sc1
    s_waitcnt vmcnt(0)
    s_mov_b32 s72, 0x40000
L_op1:
    v_cmp_eq_u32 s[84:85], s77, v2
    v_cmp_eq_u32 s[86:87], s81, v3
    s_nop 1
    s_and_b64 s[84:85], s[84:85], s[86:87]
    s_cmp_eq_u64 s[84:85], -1
    s_cbranch_scc1 L_og1
    s_sub_u32 s72, s72, 1
    s_cmp_eq_u32 s72, 0
    s_cbranch_scc1 L_og1
    s_sleep 1
    buffer_load_dwordx2 v[2:3], v7, s[44:47], s71 offen offset:1024 sc1
    s_waitcnt vmcnt(0)
    s_branch L_op1
L_og1:
    buffer_load_dwordx4 v[64:67], v1, s[44:47], s70 offen offset:0 sc1
    buffer_load_dwordx4 v[68:71], v192, s[44:47], s70 offen offset:0 sc1
    buffer_load_dwordx4 v[72:75], v1, s[44:47], s70 offen offset:1024 sc1
    buffer_load_dwordx4 v[76:79], v192, s[44:47], s70 offen offset:1024 sc1
    buffer_load_dwordx4 v[112:115], v1, s[44:47], s70 offen offset:2048 sc1
    buffer_load_dwordx4 v[116:119], v192, s[44:47], s70 offen offset:2048 sc1
    buffer_load_dwordx4 v[120:123], v1, s[44:47], s70 offen offset:3072 sc1
    buffer_load_dwordx4 v[124:127], v192, s[44:47], s70 offen offset:3072 sc1
    s_add_u32 s70, s70, 4096
    buffer_load_dwordx4 v[160:163], v1, s[44:47], s70 offen offset:0 sc1
    buffer_load_dwordx4 v[164:167], v192, s[44:47], s70 offen offset:0 sc1
    buffer_load_dwordx4 v[168:171], v1, s[44:47], s70 offen offset:1024 sc1
    buffer_load_dwordx4 v[172:175], v192, s[44:47], s70 offen offset:1024 sc1
    s_waitcnt vmcnt(0)
L_p3:
    v_bfe_u32 v5, v0, 2, 2
    v_bfe_u32 v6, v0, 4, 1
    v_lshl_add_u32 v5, v6, 2, v5
    v_lshlrev_b32 v8, 7, v5
    v_bfe_u32 v6, v5, 1, 2
    v_lshl_add_u32 v8, v6, 5, v8
    v_and_b32 v6, 3, v0
    v_lshl_add_u32 v8, v6, 3, v8
    v_lshrrev_b32 v6, 5, v0
    v_lshl_add_u32 v8, v6, 11, v8
    s_lshl_b32 s64, s73, 12
    v_add_u32 v8, s64, v8
    s_lshl_b32 s64, s73, 6
    v_xor_b32 v8, s64, v8
    v_xor_b32 v9, 32, v8
    v_xor_b32 v10, 64, v8
    v_xor_b32 v11, 0x60, v8
    v_mov_b32 v12, v7
    v_mov_b32 v14, v192
    v_mov_b32 v7, v188
    s_barrier
    s_add_u32 m0, s82, 155648
    s_mov_b32 s67, 720896
    buffer_load_dwordx4 v7, s[48:51], s67 offen lds
    s_add_u32 m0, s82, 32768
    s_mov_b32 s67, 786432
    buffer_load_dwordx4 v7, s[48:51], s67 offen lds
    s_add_u32 m0, s82, 40960
    s_mov_b32 s67, 851968
    buffer_load_dwordx4 v7, s[48:51], s67 offen lds
    s_add_u32 m0, s82, 49152
    s_mov_b32 s67, 917504
    buffer_load_dwordx4 v7, s[48:51], s67 offen lds
    s_add_u32 m0, s82, 57344
    s_mov_b32 s67, 983040
    buffer_load_dwordx4 v7, s[48:51], s67 offen lds
    v_and_b32 v13, 15, v0
    v_lshlrev_b32 v13, 12, v13
    v_bfe_u32 v6, v0, 4, 1
    v_lshl_add_u32 v13, v6, 5, v13
    v_lshrrev_b32 v6, 5, v0
    v_lshl_add_u32 v13, v6, 4, v13
    s_lshl_b32 s64, s79, 8
    s_lshl_b32 s65, s76, 5
    s_add_u32 s64, s64, s65
    s_lshl_b32 s64, s64, 12
    s_lshl_b32 s65, s60, 11
    s_add_u32 s64, s64, s65
    s_lshl_b32 s65, s80, 7
    s_add_u32 s64, s64, s65
    s_lshl_b32 s65, s73, 6
    s_add_u32 s75, s64, s65
    s_lshl_b32 s64, s63, 12
    s_add_u32 s64, s64, 65536
    v_add_u32 v15, s64, v1
    s_xor_b32 s64, s64, 0x4000
    v_add_u32 v4, s64, v1
    ds_read_b64_tr_b16 v[16:17], v8 offset:0
    ds_read_b64_tr_b16 v[18:19], v8 offset:1024
    ds_read_b64_tr_b16 v[20:21], v9 offset:0
    ds_read_b64_tr_b16 v[22:23], v9 offset:1024
    ds_read_b64_tr_b16 v[24:25], v10 offset:0
    ds_read_b64_tr_b16 v[26:27], v10 offset:1024
    ds_read_b64_tr_b16 v[28:29], v11 offset:0
    ds_read_b64_tr_b16 v[30:31], v11 offset:1024
    s_waitcnt vmcnt(16)
    s_waitcnt lgkmcnt(0)
    v_mfma_f32_16x16x32_bf16 v[224:227], v[16:19], v[64:67], 0
    ds_read_b64_tr_b16 v[32:33], v8 offset:8192
    v_mfma_f32_16x16x32_bf16 v[228:231], v[16:19], v[68:71], 0
    ds_read_b64_tr_b16 v[34:35], v8 offset:9216
    v_mfma_f32_16x16x32_bf16 v[232:235], v[20:23], v[64:67], 0
    ds_read_b64_tr_b16 v[36:37], v9 offset:8192
    v_mfma_f32_16x16x32_bf16 v[236:239], v[20:23], v[68:71], 0
    ds_read_b64_tr_b16 v[38:39], v9 offset:9216
    buffer_load_dwordx4 v[176:179], v1, s[44:47], s70 offen offset:2048 sc1
    buffer_load_dwordx4 v[180:183], v14, s[44:47], s70 offen offset:2048 sc1
    v_mfma_f32_16x16x32_bf16 v[240:243], v[24:27], v[64:67], 0
    ds_read_b64_tr_b16 v[40:41], v10 offset:8192
    v_mfma_f32_16x16x32_bf16 v[244:247], v[24:27], v[68:71], 0
    ds_read_b64_tr_b16 v[42:43], v10 offset:9216
    v_mfma_f32_16x16x32_bf16 v[248:251], v[28:31], v[64:67], 0
    ds_read_b64_tr_b16 v[44:45], v11 offset:8192
    v_mfma_f32_16x16x32_bf16 v[252:255], v[28:31], v[68:71], 0
    ds_read_b64_tr_b16 v[46:47], v11 offset:9216
    buffer_load_dwordx4 v[200:203], v1, s[44:47], s70 offen offset:3072 sc1
    buffer_load_dwordx4 v[204:207], v14, s[44:47], s70 offen offset:3072 sc1
    s_waitcnt vmcnt(18)
    s_waitcnt lgkmcnt(0)
    v_mfma_f32_16x16x32_bf16 v[224:227], v[32:35], v[72:75], v[224:227]
    ds_read_b64_tr_b16 v[16:17], v8 offset:16384
    v_mfma_f32_16x16x32_bf16 v[228:231], v[32:35], v[76:79], v[228:231]
    ds_read_b64_tr_b16 v[18:19], v8 offset:17408
    v_mfma_f32_16x16x32_bf16 v[232:235], v[36:39], v[72:75], v[232:235]
    ds_read_b64_tr_b16 v[20:21], v9 offset:16384
    v_mfma_f32_16x16x32_bf16 v[236:239], v[36:39], v[76:79], v[236:239]
    ds_read_b64_tr_b16 v[22:23], v9 offset:17408
    s_add_u32 s70, s70, 4096
    buffer_load_dwordx4 v[208:211], v1, s[44:47], s70 offen offset:0 sc1
    buffer_load_dwordx4 v[212:215], v14, s[44:47], s70 offen offset:0 sc1
    v_mfma_f32_16x16x32_bf16 v[240:243], v[40:43], v[72:75], v[240:243]
    ds_read_b64_tr_b16 v[24:25], v10 offset:16384
    v_mfma_f32_16x16x32_bf16 v[244:247], v[40:43], v[76:79], v[244:247]
    ds_read_b64_tr_b16 v[26:27], v10 offset:17408
    v_mfma_f32_16x16x32_bf16 v[248:251], v[44:47], v[72:75], v[248:251]
    ds_read_b64_tr_b16 v[28:29], v11 offset:16384
    v_mfma_f32_16x16x32_bf16 v[252:255], v[44:47], v[76:79], v[252:255]
    ds_read_b64_tr_b16 v[30:31], v11 offset:17408
    buffer_load_dwordx4 v[216:219], v1, s[44:47], s70 offen offset:1024 sc1
    buffer_load_dwordx4 v[220:223], v14, s[44:47], s70 offen offset:1024 sc1
    s_waitcnt vmcnt(20)
    s_waitcnt lgkmcnt(0)
    v_mfma_f32_16x16x32_bf16 v[224:227], v[16:19], v[112:115], v[224:227]
    ds_read_b64_tr_b16 v[32:33], v8 offset:24576
    v_mfma_f32_16x16x32_bf16 v[228:231], v[16:19], v[116:119], v[228:231]
    ds_read_b64_tr_b16 v[34:35], v8 offset:25600
    v_mfma_f32_16x16x32_bf16 v[232:235], v[20:23], v[112:115], v[232:235]
    ds_read_b64_tr_b16 v[36:37], v9 offset:24576
    v_mfma_f32_16x16x32_bf16 v[236:239], v[20:23], v[116:119], v[236:239]
    ds_read_b64_tr_b16 v[38:39], v9 offset:25600
    buffer_load_dwordx4 v[64:67], v1, s[44:47], s70 offen offset:2048 sc1
    buffer_load_dwordx4 v[68:71], v14, s[44:47], s70 offen offset:2048 sc1
    v_mfma_f32_16x16x32_bf16 v[240:243], v[24:27], v[112:115], v[240:243]
    ds_read_b64_tr_b16 v[40:41], v10 offset:24576
    v_mfma_f32_16x16x32_bf16 v[244:247], v[24:27], v[116:119], v[244:247]
    ds_read_b64_tr_b16 v[42:43], v10 offset:25600
    v_mfma_f32_16x16x32_bf16 v[248:251], v[28:31], v[112:115], v[248:251]
    ds_read_b64_tr_b16 v[44:45], v11 offset:24576
    v_mfma_f32_16x16x32_bf16 v[252:255], v[28:31], v[116:119], v[252:255]
    ds_read_b64_tr_b16 v[46:47], v11 offset:25600
    s_waitcnt vmcnt(20)
    v_add_u32 v8, 0x10000, v8
    v_add_u32 v9, 0x10000, v9
    v_add_u32 v10, 0x10000, v10
    v_add_u32 v11, 0x10000, v11
    s_waitcnt lgkmcnt(0)
    v_mfma_f32_16x16x32_bf16 v[224:227], v[32:35], v[120:123], v[224:227]
    ds_read_b64_tr_b16 v[16:17], v8 offset:32768
    v_mfma_f32_16x16x32_bf16 v[228:231], v[32:35], v[124:127], v[228:231]
    ds_read_b64_tr_b16 v[18:19], v8 offset:33792
    v_mfma_f32_16x16x32_bf16 v[232:235], v[36:39], v[120:123], v[232:235]
    ds_read_b64_tr_b16 v[20:21], v9 offset:32768
    v_mfma_f32_16x16x32_bf16 v[236:239], v[36:39], v[124:127], v[236:239]
    ds_read_b64_tr_b16 v[22:23], v9 offset:33792
    buffer_load_dwordx4 v[72:75], v1, s[44:47], s70 offen offset:3072 sc1
    buffer_load_dwordx4 v[76:79], v14, s[44:47], s70 offen offset:3072 sc1
    v_mfma_f32_16x16x32_bf16 v[240:243], v[40:43], v[120:123], v[240:243]
    ds_read_b64_tr_b16 v[24:25], v10 offset:32768
    v_mfma_f32_16x16x32_bf16 v[244:247], v[40:43], v[124:127], v[244:247]
    ds_read_b64_tr_b16 v[26:27], v10 offset:33792
    v_mfma_f32_16x16x32_bf16 v[248:251], v[44:47], v[120:123], v[248:251]
    ds_read_b64_tr_b16 v[28:29], v11 offset:32768
    v_mfma_f32_16x16x32_bf16 v[252:255], v[44:47], v[124:127], v[252:255]
    ds_read_b64_tr_b16 v[30:31], v11 offset:33792
    s_waitcnt vmcnt(20)
    s_waitcnt lgkmcnt(0)
    v_mfma_f32_16x16x32_bf16 v[224:227], v[16:19], v[160:163], v[224:227]
    ds_read_b64_tr_b16 v[32:33], v8 offset:40960
    v_mfma_f32_16x16x32_bf16 v[228:231], v[16:19], v[164:167], v[228:231]
    ds_read_b64_tr_b16 v[34:35], v8 offset:41984
    v_mfma_f32_16x16x32_bf16 v[232:235], v[20:23], v[160:163], v[232:235]
    ds_read_b64_tr_b16 v[36:37], v9 offset:40960
    v_mfma_f32_16x16x32_bf16 v[236:239], v[20:23], v[164:167], v[236:239]
    ds_read_b64_tr_b16 v[38:39], v9 offset:41984
    s_add_u32 s70, s70, 4096
    buffer_load_dwordx4 v[112:115], v1, s[44:47], s70 offen offset:0 sc1
    buffer_load_dwordx4 v[116:119], v14, s[44:47], s70 offen offset:0 sc1
    v_mfma_f32_16x16x32_bf16 v[240:243], v[24:27], v[160:163], v[240:243]
    ds_read_b64_tr_b16 v[40:41], v10 offset:40960
    v_mfma_f32_16x16x32_bf16 v[244:247], v[24:27], v[164:167], v[244:247]
    ds_read_b64_tr_b16 v[42:43], v10 offset:41984
    v_mfma_f32_16x16x32_bf16 v[248:251], v[28:31], v[160:163], v[248:251]
    ds_read_b64_tr_b16 v[44:45], v11 offset:40960
    v_mfma_f32_16x16x32_bf16 v[252:255], v[28:31], v[164:167], v[252:255]
    ds_read_b64_tr_b16 v[46:47], v11 offset:41984
    s_waitcnt vmcnt(20)
    s_waitcnt lgkmcnt(0)
    v_mfma_f32_16x16x32_bf16 v[224:227], v[32:35], v[168:171], v[224:227]
    ds_read_b64_tr_b16 v[16:17], v8 offset:49152
    v_mfma_f32_16x16x32_bf16 v[228:231], v[32:35], v[172:175], v[228:231]
    ds_read_b64_tr_b16 v[18:19], v8 offset:50176
    v_mfma_f32_16x16x32_bf16 v[232:235], v[36:39], v[168:171], v[232:235]
    ds_read_b64_tr_b16 v[20:21], v9 offset:49152
    v_mfma_f32_16x16x32_bf16 v[236:239], v[36:39], v[172:175], v[236:239]
    ds_read_b64_tr_b16 v[22:23], v9 offset:50176
    buffer_load_dwordx4 v[120:123], v1, s[44:47], s70 offen offset:1024 sc1
    buffer_load_dwordx4 v[124:127], v14, s[44:47], s70 offen offset:1024 sc1
    v_mfma_f32_16x16x32_bf16 v[240:243], v[40:43], v[168:171], v[240:243]
    ds_read_b64_tr_b16 v[24:25], v10 offset:49152
    v_mfma_f32_16x16x32_bf16 v[244:247], v[40:43], v[172:175], v[244:247]
    ds_read_b64_tr_b16 v[26:27], v10 offset:50176
    v_mfma_f32_16x16x32_bf16 v[248:251], v[44:47], v[168:171], v[248:251]
    ds_read_b64_tr_b16 v[28:29], v11 offset:49152
    v_mfma_f32_16x16x32_bf16 v[252:255], v[44:47], v[172:175], v[252:255]
    ds_read_b64_tr_b16 v[30:31], v11 offset:50176
    s_waitcnt vmcnt(14)
    s_waitcnt lgkmcnt(0)
    v_mfma_f32_16x16x32_bf16 v[224:227], v[16:19], v[176:179], v[224:227]
    ds_read_b64_tr_b16 v[32:33], v8 offset:57344
    v_mfma_f32_16x16x32_bf16 v[228:231], v[16:19], v[180:183], v[228:231]
    ds_read_b64_tr_b16 v[34:35], v8 offset:58368
    v_mfma_f32_16x16x32_bf16 v[232:235], v[20:23], v[176:179], v[232:235]
    ds_read_b64_tr_b16 v[36:37], v9 offset:57344
    v_mfma_f32_16x16x32_bf16 v[236:239], v[20:23], v[180:183], v[236:239]
    ds_read_b64_tr_b16 v[38:39], v9 offset:58368
    buffer_load_dwordx4 v[160:163], v1, s[44:47], s70 offen offset:2048 sc1
    buffer_load_dwordx4 v[164:167], v14, s[44:47], s70 offen offset:2048 sc1
    v_mfma_f32_16x16x32_bf16 v[240:243], v[24:27], v[176:179], v[240:243]
    ds_read_b64_tr_b16 v[40:41], v10 offset:57344
    v_mfma_f32_16x16x32_bf16 v[244:247], v[24:27], v[180:183], v[244:247]
    ds_read_b64_tr_b16 v[42:43], v10 offset:58368
    v_mfma_f32_16x16x32_bf16 v[248:251], v[28:31], v[176:179], v[248:251]
    ds_read_b64_tr_b16 v[44:45], v11 offset:57344
    v_mfma_f32_16x16x32_bf16 v[252:255], v[28:31], v[180:183], v[252:255]
    ds_read_b64_tr_b16 v[46:47], v11 offset:58368
    s_waitcnt vmcnt(14)
    v_add_u32 v8, 0x10000, v8
    v_add_u32 v9, 0x10000, v9
    v_add_u32 v10, 0x10000, v10
    v_add_u32 v11, 0x10000, v11
    s_waitcnt lgkmcnt(0)
    v_mfma_f32_16x16x32_bf16 v[224:227], v[32:35], v[200:203], v[224:227]
    ds_read_b64_tr_b16 v[16:17], v8 offset:0
    v_mfma_f32_16x16x32_bf16 v[228:231], v[32:35], v[204:207], v[228:231]
    ds_read_b64_tr_b16 v[18:19], v8 offset:1024
    v_mfma_f32_16x16x32_bf16 v[232:235], v[36:39], v[200:203], v[232:235]
    ds_read_b64_tr_b16 v[20:21], v9 offset:0
    v_mfma_f32_16x16x32_bf16 v[236:239], v[36:39], v[204:207], v[236:239]
    ds_read_b64_tr_b16 v[22:23], v9 offset:1024
    buffer_load_dwordx4 v[168:171], v1, s[44:47], s70 offen offset:3072 sc1
    buffer_load_dwordx4 v[172:175], v14, s[44:47], s70 offen offset:3072 sc1
    v_mfma_f32_16x16x32_bf16 v[240:243], v[40:43], v[200:203], v[240:243]
    ds_read_b64_tr_b16 v[24:25], v10 offset:0
    v_mfma_f32_16x16x32_bf16 v[244:247], v[40:43], v[204:207], v[244:247]
    ds_read_b64_tr_b16 v[26:27], v10 offset:1024
    v_mfma_f32_16x16x32_bf16 v[248:251], v[44:47], v[200:203], v[248:251]
    ds_read_b64_tr_b16 v[28:29], v11 offset:0
    v_mfma_f32_16x16x32_bf16 v[252:255], v[44:47], v[204:207], v[252:255]
    ds_read_b64_tr_b16 v[30:31], v11 offset:1024
    s_waitcnt vmcnt(14)
    s_waitcnt lgkmcnt(0)
    v_mfma_f32_16x16x32_bf16 v[224:227], v[16:19], v[208:211], v[224:227]
    ds_read_b64_tr_b16 v[32:33], v8 offset:8192
    v_mfma_f32_16x16x32_bf16 v[228:231], v[16:19], v[212:215], v[228:231]
    ds_read_b64_tr_b16 v[34:35], v8 offset:9216
    v_mfma_f32_16x16x32_bf16 v[232:235], v[20:23], v[208:211], v[232:235]
    ds_read_b64_tr_b16 v[36:37], v9 offset:8192
    v_mfma_f32_16x16x32_bf16 v[236:239], v[20:23], v[212:215], v[236:239]
    ds_read_b64_tr_b16 v[38:39], v9 offset:9216
    v_mfma_f32_16x16x32_bf16 v[240:243], v[24:27], v[208:211], v[240:243]
    ds_read_b64_tr_b16 v[40:41], v10 offset:8192
    v_mfma_f32_16x16x32_bf16 v[244:247], v[24:27], v[212:215], v[244:247]
    ds_read_b64_tr_b16 v[42:43], v10 offset:9216
    v_mfma_f32_16x16x32_bf16 v[248:251], v[28:31], v[208:211], v[248:251]
    ds_read_b64_tr_b16 v[44:45], v11 offset:8192
    v_mfma_f32_16x16x32_bf16 v[252:255], v[28:31], v[212:215], v[252:255]
    ds_read_b64_tr_b16 v[46:47], v11 offset:9216
    s_barrier
    buffer_load_dwordx2 v[2:3], v12, s[44:47], s71 offen sc1
    s_waitcnt vmcnt(13)
    s_waitcnt lgkmcnt(0)
    v_mfma_f32_16x16x32_bf16 v[224:227], v[32:35], v[216:219], v[224:227]
    ds_read_b64_tr_b16 v[16:17], v8 offset:16384
    v_mfma_f32_16x16x32_bf16 v[228:231], v[32:35], v[220:223], v[228:231]
    ds_read_b64_tr_b16 v[18:19], v8 offset:17408
    v_mfma_f32_16x16x32_bf16 v[232:235], v[36:39], v[216:219], v[232:235]
    ds_read_b64_tr_b16 v[20:21], v9 offset:16384
    v_mfma_f32_16x16x32_bf16 v[236:239], v[36:39], v[220:223], v[236:239]
    ds_read_b64_tr_b16 v[22:23], v9 offset:17408
    v_mfma_f32_16x16x32_bf16 v[240:243], v[40:43], v[216:219], v[240:243]
    ds_read_b64_tr_b16 v[24:25], v10 offset:16384
    v_mfma_f32_16x16x32_bf16 v[244:247], v[40:43], v[220:223], v[244:247]
    ds_read_b64_tr_b16 v[26:27], v10 offset:17408
    v_mfma_f32_16x16x32_bf16 v[248:251], v[44:47], v[216:219], v[248:251]
    ds_read_b64_tr_b16 v[28:29], v11 offset:16384
    v_mfma_f32_16x16x32_bf16 v[252:255], v[44:47], v[220:223], v[252:255]
    ds_read_b64_tr_b16 v[30:31], v11 offset:17408
    s_waitcnt vmcnt(11)
    s_waitcnt lgkmcnt(0)
    v_mfma_f32_16x16x32_bf16 v[224:227], v[16:19], v[64:67], v[224:227]
    ds_read_b64_tr_b16 v[32:33], v8 offset:24576
    v_mfma_f32_16x16x32_bf16 v[228:231], v[16:19], v[68:71], v[228:231]
    ds_read_b64_tr_b16 v[34:35], v8 offset:25600
    v_mfma_f32_16x16x32_bf16 v[232:235], v[20:23], v[64:67], v[232:235]
    ds_read_b64_tr_b16 v[36:37], v9 offset:24576
    v_mfma_f32_16x16x32_bf16 v[236:239], v[20:23], v[68:71], v[236:239]
    ds_read_b64_tr_b16 v[38:39], v9 offset:25600
    v_mfma_f32_16x16x32_bf16 v[240:243], v[24:27], v[64:67], v[240:243]
    ds_read_b64_tr_b16 v[40:41], v10 offset:24576
    v_mfma_f32_16x16x32_bf16 v[244:247], v[24:27], v[68:71], v[244:247]
    ds_read_b64_tr_b16 v[42:43], v10 offset:25600
    v_mfma_f32_16x16x32_bf16 v[248:251], v[28:31], v[64:67], v[248:251]
    ds_read_b64_tr_b16 v[44:45], v11 offset:24576
    v_mfma_f32_16x16x32_bf16 v[252:255], v[28:31], v[68:71], v[252:255]
    ds_read_b64_tr_b16 v[46:47], v11 offset:25600
    s_waitcnt vmcnt(0)
    s_mov_b32 s72, 0x40000
L_op0:
    v_cmp_eq_u32 s[84:85], s77, v2
    v_cmp_eq_u32 s[86:87], s81, v3
    s_nop 1
    s_and_b64 s[84:85], s[84:85], s[86:87]
    s_cmp_eq_u64 s[84:85], -1
    s_cbranch_scc1 L_og0
    s_sub_u32 s72, s72, 1
    s_cmp_eq_u32 s72, 0
    s_cbranch_scc1 L_og0
    s_sleep 1
    buffer_load_dwordx2 v[2:3], v12, s[44:47], s71 offen offset:0 sc1
    s_waitcnt vmcnt(0)
    s_branch L_op0
L_og0:
    v_add_u32 v8, 0xfffe0000, v8
    v_add_u32 v9, 0xfffe0000, v9
    v_add_u32 v10, 0xfffe0000, v10
    v_add_u32 v11, 0xfffe0000, v11
    s_waitcnt lgkmcnt(0)
    v_mfma_f32_16x16x32_bf16 v[224:227], v[32:35], v[72:75], v[224:227]
    ds_read_b64_tr_b16 v[16:17], v8 offset:32768
    v_mfma_f32_16x16x32_bf16 v[228:231], v[32:35], v[76:79], v[228:231]
    ds_read_b64_tr_b16 v[18:19], v8 offset:33792
    v_mfma_f32_16x16x32_bf16 v[232:235], v[36:39], v[72:75], v[232:235]
    ds_read_b64_tr_b16 v[20:21], v9 offset:32768
    v_mfma_f32_16x16x32_bf16 v[236:239], v[36:39], v[76:79], v[236:239]
    ds_read_b64_tr_b16 v[22:23], v9 offset:33792
    s_sub_u32 s70, s70, 274432
    buffer_load_dwordx4 v[176:179], v1, s[44:47], s70 offen offset:0 sc1
    buffer_load_dwordx4 v[180:183], v14, s[44:47], s70 offen offset:0 sc1
    v_mfma_f32_16x16x32_bf16 v[240:243], v[40:43], v[72:75], v[240:243]
    ds_read_b64_tr_b16 v[24:25], v10 offset:32768
    v_mfma_f32_16x16x32_bf16 v[244:247], v[40:43], v[76:79], v[244:247]
    ds_read_b64_tr_b16 v[26:27], v10 offset:33792
    v_mfma_f32_16x16x32_bf16 v[248:251], v[44:47], v[72:75], v[248:251]
    ds_read_b64_tr_b16 v[28:29], v11 offset:32768
    v_mfma_f32_16x16x32_bf16 v[252:255], v[44:47], v[76:79], v[252:255]
    ds_read_b64_tr_b16 v[30:31], v11 offset:33792
    buffer_load_dwordx4 v[200:203], v1, s[44:47], s70 offen offset:1024 sc1
    buffer_load_dwordx4 v[204:207], v14, s[44:47], s70 offen offset:1024 sc1
    s_waitcnt lgkmcnt(0)
    v_mfma_f32_16x16x32_bf16 v[224:227], v[16:19], v[112:115], v[224:227]
    ds_read_b64_tr_b16 v[32:33], v8 offset:40960
    v_mfma_f32_16x16x32_bf16 v[228:231], v[16:19], v[116:119], v[228:231]
    ds_read_b64_tr_b16 v[34:35], v8 offset:41984
    v_mfma_f32_16x16x32_bf16 v[232:235], v[20:23], v[112:115], v[232:235]
    ds_read_b64_tr_b16 v[36:37], v9 offset:40960
    v_mfma_f32_16x16x32_bf16 v[236:239], v[20:23], v[116:119], v[236:239]
    ds_read_b64_tr_b16 v[38:39], v9 offset:41984
    buffer_load_dwordx4 v[208:211], v1, s[44:47], s70 offen offset:2048 sc1
    buffer_load_dwordx4 v[212:215], v14, s[44:47], s70 offen offset:2048 sc1
    v_mfma_f32_16x16x32_bf16 v[240:243], v[24:27], v[112:115], v[240:243]
    ds_read_b64_tr_b16 v[40:41], v10 offset:40960
    v_mfma_f32_16x16x32_bf16 v[244:247], v[24:27], v[116:119], v[244:247]
    ds_read_b64_tr_b16 v[42:43], v10 offset:41984
    v_mfma_f32_16x16x32_bf16 v[248:251], v[28:31], v[112:115], v[248:251]
    ds_read_b64_tr_b16 v[44:45], v11 offset:40960
    v_mfma_f32_16x16x32_bf16 v[252:255], v[28:31], v[116:119], v[252:255]
    ds_read_b64_tr_b16 v[46:47], v11 offset:41984
    buffer_load_dwordx4 v[216:219], v1, s[44:47], s70 offen offset:3072 sc1
    buffer_load_dwordx4 v[220:223], v14, s[44:47], s70 offen offset:3072 sc1
    s_waitcnt lgkmcnt(0)
    v_mfma_f32_16x16x32_bf16 v[224:227], v[32:35], v[120:123], v[224:227]
    ds_read_b64_tr_b16 v[16:17], v8 offset:49152
    v_mfma_f32_16x16x32_bf16 v[228:231], v[32:35], v[124:127], v[228:231]
    ds_read_b64_tr_b16 v[18:19], v8 offset:50176
    v_mfma_f32_16x16x32_bf16 v[232:235], v[36:39], v[120:123], v[232:235]
    ds_read_b64_tr_b16 v[20:21], v9 offset:49152
    v_mfma_f32_16x16x32_bf16 v[236:239], v[36:39], v[124:127], v[236:239]
    ds_read_b64_tr_b16 v[22:23], v9 offset:50176
    s_add_u32 s70, s70, 4096
    buffer_load_dwordx4 v[64:67], v1, s[44:47], s70 offen offset:0 sc1
    buffer_load_dwordx4 v[68:71], v14, s[44:47], s70 offen offset:0 sc1
    v_mfma_f32_16x16x32_bf16 v[240:243], v[40:43], v[120:123], v[240:243]
    ds_read_b64_tr_b16 v[24:25], v10 offset:49152
    v_mfma_f32_16x16x32_bf16 v[244:247], v[40:43], v[124:127], v[244:247]
    ds_read_b64_tr_b16 v[26:27], v10 offset:50176
    v_mfma_f32_16x16x32_bf16 v[248:251], v[44:47], v[120:123], v[248:251]
    ds_read_b64_tr_b16 v[28:29], v11 offset:49152
    v_mfma_f32_16x16x32_bf16 v[252:255], v[44:47], v[124:127], v[252:255]
    ds_read_b64_tr_b16 v[30:31], v11 offset:50176
    buffer_load_dwordx4 v[72:75], v1, s[44:47], s70 offen offset:1024 sc1
    buffer_load_dwordx4 v[76:79], v14, s[44:47], s70 offen offset:1024 sc1
    s_waitcnt lgkmcnt(0)
    v_mfma_f32_16x16x32_bf16 v[224:227], v[16:19], v[160:163], v[224:227]
    ds_read_b64_tr_b16 v[32:33], v8 offset:57344
    v_mfma_f32_16x16x32_bf16 v[228:231], v[16:19], v[164:167], v[228:231]
    ds_read_b64_tr_b16 v[34:35], v8 offset:58368
    v_mfma_f32_16x16x32_bf16 v[232:235], v[20:23], v[160:163], v[232:235]
    ds_read_b64_tr_b16 v[36:37], v9 offset:57344
    v_mfma_f32_16x16x32_bf16 v[236:239], v[20:23], v[164:167], v[236:239]
    ds_read_b64_tr_b16 v[38:39], v9 offset:58368
    buffer_load_dwordx4 v[112:115], v1, s[44:47], s70 offen offset:2048 sc1
    buffer_load_dwordx4 v[116:119], v14, s[44:47], s70 offen offset:2048 sc1
    v_mfma_f32_16x16x32_bf16 v[240:243], v[24:27], v[160:163], v[240:243]
    ds_read_b64_tr_b16 v[40:41], v10 offset:57344
    v_mfma_f32_16x16x32_bf16 v[244:247], v[24:27], v[164:167], v[244:247]
    ds_read_b64_tr_b16 v[42:43], v10 offset:58368
    v_mfma_f32_16x16x32_bf16 v[248:251], v[28:31], v[160:163], v[248:251]
    ds_read_b64_tr_b16 v[44:45], v11 offset:57344
    v_mfma_f32_16x16x32_bf16 v[252:255], v[28:31], v[164:167], v[252:255]
    ds_read_b64_tr_b16 v[46:47], v11 offset:58368
    s_waitcnt lgkmcnt(0)
    v_mfma_f32_16x16x32_bf16 v[224:227], v[32:35], v[168:171], v[224:227]
    ds_read_b64_tr_b16 v[16:17], v8 offset:0
    v_mfma_f32_16x16x32_bf16 v[228:231], v[32:35], v[172:175], v[228:231]
    ds_read_b64_tr_b16 v[18:19], v8 offset:1024
    v_mfma_f32_16x16x32_bf16 v[232:235], v[36:39], v[168:171], v[232:235]
    ds_read_b64_tr_b16 v[20:21], v9 offset:0
    v_mfma_f32_16x16x32_bf16 v[236:239], v[36:39], v[172:175], v[236:239]
    ds_read_b64_tr_b16 v[22:23], v9 offset:1024
    buffer_load_dwordx4 v[120:123], v1, s[44:47], s70 offen offset:3072 sc1
    buffer_load_dwordx4 v[124:127], v14, s[44:47], s70 offen offset:3072 sc1
    v_mfma_f32_16x16x32_bf16 v[240:243], v[40:43], v[168:171], v[240:243]
    ds_read_b64_tr_b16 v[24:25], v10 offset:0
    v_mfma_f32_16x16x32_bf16 v[244:247], v[40:43], v[172:175], v[244:247]
    ds_read_b64_tr_b16 v[26:27], v10 offset:1024
    v_mfma_f32_16x16x32_bf16 v[248:251], v[44:47], v[168:171], v[248:251]
    ds_read_b64_tr_b16 v[28:29], v11 offset:0
    v_mfma_f32_16x16x32_bf16 v[252:255], v[44:47], v[172:175], v[252:255]
    ds_read_b64_tr_b16 v[30:31], v11 offset:1024
    s_waitcnt vmcnt(14)
    s_waitcnt lgkmcnt(0)
    v_mfma_f32_16x16x32_bf16 v[128:131], v[16:19], v[176:179], 0
    ds_read_b64_tr_b16 v[32:33], v8 offset:8192
    v_mfma_f32_16x16x32_bf16 v[132:135], v[16:19], v[180:183], 0
    ds_read_b64_tr_b16 v[34:35], v8 offset:9216
    v_mfma_f32_16x16x32_bf16 v[136:139], v[20:23], v[176:179], 0
    ds_read_b64_tr_b16 v[36:37], v9 offset:8192
    v_mfma_f32_16x16x32_bf16 v[140:143], v[20:23], v[180:183], 0
    ds_read_b64_tr_b16 v[38:39], v9 offset:9216
    s_add_u32 s70, s70, 4096
    buffer_load_dwordx4 v[160:163], v1, s[44:47], s70 offen offset:0 sc1
    buffer_load_dwordx4 v[164:167], v14, s[44:47], s70 offen offset:0 sc1
    v_mfma_f32_16x16x32_bf16 v[144:147], v[24:27], v[176:179], 0
    ds_read_b64_tr_b16 v[40:41], v10 offset:8192
    v_mfma_f32_16x16x32_bf16 v[148:151], v[24:27], v[180:183], 0
    ds_read_b64_tr_b16 v[42:43], v10 offset:9216
    v_mfma_f32_16x16x32_bf16 v[152:155], v[28:31], v[176:179], 0
    ds_read_b64_tr_b16 v[44:45], v11 offset:8192
    v_mfma_f32_16x16x32_bf16 v[156:159], v[28:31], v[180:183], 0
    ds_read_b64_tr_b16 v[46:47], v11 offset:9216
    s_waitcnt vmcnt(14)
    s_waitcnt lgkmcnt(0)
    v_mfma_f32_16x16x32_bf16 v[128:131], v[32:35], v[200:203], v[128:131]
    ds_read_b64_tr_b16 v[16:17], v8 offset:16384
    ds_write_b128 v15, v[240:243] offset:0
    ds_write_b128 v15, v[244:247] offset:1024
    v_mfma_f32_16x16x32_bf16 v[132:135], v[32:35], v[204:207], v[132:135]
    ds_read_b64_tr_b16 v[18:19], v8 offset:17408
    ds_write_b128 v15, v[248:251] offset:2048
    ds_write_b128 v15, v[252:255] offset:3072
    v_mfma_f32_16x16x32_bf16 v[136:139], v[36:39], v[200:203], v[136:139]
    ds_read_b64_tr_b16 v[20:21], v9 offset:16384
    v_mfma_f32_16x16x32_bf16 v[140:143], v[36:39], v[204:207], v[140:143]
    ds_read_b64_tr_b16 v[22:23], v9 offset:17408
    buffer_load_dwordx4 v[168:171], v1, s[44:47], s70 offen offset:1024 sc1
    buffer_load_dwordx4 v[172:175], v14, s[44:47], s70 offen offset:1024 sc1
    v_mfma_f32_16x16x32_bf16 v[144:147], v[40:43], v[200:203], v[144:147]
    ds_read_b64_tr_b16 v[24:25], v10 offset:16384
    v_mfma_f32_16x16x32_bf16 v[148:151], v[40:43], v[204:207], v[148:151]
    ds_read_b64_tr_b16 v[26:27], v10 offset:17408
    v_mfma_f32_16x16x32_bf16 v[152:155], v[44:47], v[200:203], v[152:155]
    ds_read_b64_tr_b16 v[28:29], v11 offset:16384
    v_mfma_f32_16x16x32_bf16 v[156:159], v[44:47], v[204:207], v[156:159]
    ds_read_b64_tr_b16 v[30:31], v11 offset:17408
    s_waitcnt vmcnt(14)
    s_waitcnt lgkmcnt(0)
    v_mfma_f32_16x16x32_bf16 v[128:131], v[16:19], v[208:211], v[128:131]
    ds_read_b64_tr_b16 v[32:33], v8 offset:24576
    v_mfma_f32_16x16x32_bf16 v[132:135], v[16:19], v[212:215], v[132:135]
    ds_read_b64_tr_b16 v[34:35], v8 offset:25600
    v_mfma_f32_16x16x32_bf16 v[136:139], v[20:23], v[208:211], v[136:139]
    ds_read_b64_tr_b16 v[36:37], v9 offset:24576
    v_mfma_f32_16x16x32_bf16 v[140:143], v[20:23], v[212:215], v[140:143]
    ds_read_b64_tr_b16 v[38:39], v9 offset:25600
    buffer_load_dwordx4 v[176:179], v1, s[44:47], s70 offen offset:2048 sc1
    buffer_load_dwordx4 v[180:183], v14, s[44:47], s70 offen offset:2048 sc1
    v_mfma_f32_16x16x32_bf16 v[144:147], v[24:27], v[208:211], v[144:147]
    ds_read_b64_tr_b16 v[40:41], v10 offset:24576
    v_mfma_f32_16x16x32_bf16 v[148:151], v[24:27], v[212:215], v[148:151]
    ds_read_b64_tr_b16 v[42:43], v10 offset:25600
    v_mfma_f32_16x16x32_bf16 v[152:155], v[28:31], v[208:211], v[152:155]
    ds_read_b64_tr_b16 v[44:45], v11 offset:24576
    v_mfma_f32_16x16x32_bf16 v[156:159], v[28:31], v[212:215], v[156:159]
    ds_read_b64_tr_b16 v[46:47], v11 offset:25600
    s_barrier
    s_waitcnt vmcnt(14)
    v_add_u32 v8, 0x10000, v8
    v_add_u32 v9, 0x10000, v9
    v_add_u32 v10, 0x10000, v10
    v_add_u32 v11, 0x10000, v11
    s_waitcnt lgkmcnt(0)
    v_mfma_f32_16x16x32_bf16 v[128:131], v[32:35], v[216:219], v[128:131]
    ds_read_b64_tr_b16 v[16:17], v8 offset:32768
    ds_read_b128 v[48:51], v4 offset:0
    ds_read_b128 v[52:55], v4 offset:1024
    v_mfma_f32_16x16x32_bf16 v[132:135], v[32:35], v[220:223], v[132:135]
    ds_read_b64_tr_b16 v[18:19], v8 offset:33792
    ds_read_b128 v[56:59], v4 offset:2048
    ds_read_b128 v[60:63], v4 offset:3072
    v_mfma_f32_16x16x32_bf16 v[136:139], v[36:39], v[216:219], v[136:139]
    ds_read_b64_tr_b16 v[20:21], v9 offset:32768
    s_waitcnt lgkmcnt(5)
    v_add_f32 v224, v224, v48
    v_mfma_f32_16x16x32_bf16 v[140:143], v[36:39], v[220:223], v[140:143]
    ds_read_b64_tr_b16 v[22:23], v9 offset:33792
    v_add_f32 v225, v225, v49
    v_add_f32 v226, v226, v50
    buffer_load_dwordx4 v[200:203], v1, s[44:47], s70 offen offset:3072 sc1
    buffer_load_dwordx4 v[204:207], v14, s[44:47], s70 offen offset:3072 sc1
    v_mfma_f32_16x16x32_bf16 v[144:147], v[40:43], v[216:219], v[144:147]
    ds_read_b64_tr_b16 v[24:25], v10 offset:32768
    v_add_f32 v227, v227, v51
    s_waitcnt lgkmcnt(6)
    v_mfma_f32_16x16x32_bf16 v[148:151], v[40:43], v[220:223], v[148:151]
    ds_read_b64_tr_b16 v[26:27], v10 offset:33792
    v_add_f32 v228, v228, v52
    v_add_f32 v229, v229, v53
    v_mfma_f32_16x16x32_bf16 v[152:155], v[44:47], v[216:219], v[152:155]
    ds_read_b64_tr_b16 v[28:29], v11 offset:32768
    v_add_f32 v230, v230, v54
    v_add_f32 v231, v231, v55
    v_mfma_f32_16x16x32_bf16 v[156:159], v[44:47], v[220:223], v[156:159]
    ds_read_b64_tr_b16 v[30:31], v11 offset:33792
    s_waitcnt lgkmcnt(7)
    v_add_f32 v232, v232, v56
    s_waitcnt vmcnt(14)
    s_waitcnt lgkmcnt(0)
    v_mfma_f32_16x16x32_bf16 v[128:131], v[16:19], v[64:67], v[128:131]
    ds_read_b64_tr_b16 v[32:33], v8 offset:40960
    v_add_f32 v233, v233, v57
    v_add_f32 v234, v234, v58
    v_mfma_f32_16x16x32_bf16 v[132:135], v[16:19], v[68:71], v[132:135]
    ds_read_b64_tr_b16 v[34:35], v8 offset:41984
    v_add_f32 v235, v235, v59
    v_mfma_f32_16x16x32_bf16 v[136:139], v[20:23], v[64:67], v[136:139]
    ds_read_b64_tr_b16 v[36:37], v9 offset:40960
    v_add_f32 v236, v236, v60
    v_add_f32 v237, v237, v61
    v_mfma_f32_16x16x32_bf16 v[140:143], v[20:23], v[68:71], v[140:143]
    ds_read_b64_tr_b16 v[38:39], v9 offset:41984
    v_add_f32 v238, v238, v62
    v_add_f32 v239, v239, v63
    s_add_u32 s70, s70, 4096
    buffer_load_dwordx4 v[208:211], v1, s[44:47], s70 offen offset:0 sc1
    buffer_load_dwordx4 v[212:215], v14, s[44:47], s70 offen offset:0 sc1
    v_mfma_f32_16x16x32_bf16 v[144:147], v[24:27], v[64:67], v[144:147]
    ds_read_b64_tr_b16 v[40:41], v10 offset:40960
    v_cvt_pk_bf16_f32 v48, v224, v225
    v_cvt_pk_bf16_f32 v49, v226, v227
    v_mfma_f32_16x16x32_bf16 v[148:151], v[24:27], v[68:71], v[148:151]
    ds_read_b64_tr_b16 v[42:43], v10 offset:41984
    v_cvt_pk_bf16_f32 v50, v232, v233
    v_cvt_pk_bf16_f32 v51, v234, v235
    v_mfma_f32_16x16x32_bf16 v[152:155], v[28:31], v[64:67], v[152:155]
    ds_read_b64_tr_b16 v[44:45], v11 offset:40960
    v_cvt_pk_bf16_f32 v52, v228, v229
    v_cvt_pk_bf16_f32 v53, v230, v231
    v_mfma_f32_16x16x32_bf16 v[156:159], v[28:31], v[68:71], v[156:159]
    ds_read_b64_tr_b16 v[46:47], v11 offset:41984
    v_cvt_pk_bf16_f32 v54, v236, v237
    v_cvt_pk_bf16_f32 v55, v238, v239
    s_waitcnt vmcnt(14)
    s_waitcnt lgkmcnt(0)
    v_mfma_f32_16x16x32_bf16 v[128:131], v[32:35], v[72:75], v[128:131]
    ds_read_b64_tr_b16 v[16:17], v8 offset:49152
    s_add_u32 s64, s75, 524288
    s_add_u32 s65, s64, 0x10000
    v_mfma_f32_16x16x32_bf16 v[132:135], v[32:35], v[76:79], v[132:135]
    ds_read_b64_tr_b16 v[18:19], v8 offset:50176
    v_permlane16_swap_b32 v48, v50
    v_permlane16_swap_b32 v49, v51
    v_mfma_f32_16x16x32_bf16 v[136:139], v[36:39], v[72:75], v[136:139]
    ds_read_b64_tr_b16 v[20:21], v9 offset:49152
    v_permlane16_swap_b32 v52, v54
    v_permlane16_swap_b32 v53, v55
    v_mfma_f32_16x16x32_bf16 v[140:143], v[36:39], v[76:79], v[140:143]
    ds_read_b64_tr_b16 v[22:23], v9 offset:50176
    s_nop 0
    buffer_store_dwordx4 v[48:51], v13, s[52:55], s64 offen sc1
    buffer_load_dwordx4 v[216:219], v1, s[44:47], s70 offen offset:1024 sc1
    buffer_load_dwordx4 v[220:223], v14, s[44:47], s70 offen offset:1024 sc1
    v_mfma_f32_16x16x32_bf16 v[144:147], v[40:43], v[72:75], v[144:147]
    ds_read_b64_tr_b16 v[24:25], v10 offset:49152
    buffer_store_dwordx4 v[52:55], v13, s[52:55], s65 offen sc1
    v_mfma_f32_16x16x32_bf16 v[148:151], v[40:43], v[76:79], v[148:151]
    ds_read_b64_tr_b16 v[26:27], v10 offset:50176
    v_mfma_f32_16x16x32_bf16 v[152:155], v[44:47], v[72:75], v[152:155]
    ds_read_b64_tr_b16 v[28:29], v11 offset:49152
    v_mfma_f32_16x16x32_bf16 v[156:159], v[44:47], v[76:79], v[156:159]
    ds_read_b64_tr_b16 v[30:31], v11 offset:50176
    s_waitcnt vmcnt(16)
    s_waitcnt lgkmcnt(0)
    v_mfma_f32_16x16x32_bf16 v[128:131], v[16:19], v[112:115], v[128:131]
    ds_read_b64_tr_b16 v[32:33], v8 offset:57344
    v_mfma_f32_16x16x32_bf16 v[132:135], v[16:19], v[116:119], v[132:135]
    ds_read_b64_tr_b16 v[34:35], v8 offset:58368
    v_mfma_f32_16x16x32_bf16 v[136:139], v[20:23], v[112:115], v[136:139]
    ds_read_b64_tr_b16 v[36:37], v9 offset:57344
    v_mfma_f32_16x16x32_bf16 v[140:143], v[20:23], v[116:119], v[140:143]
    ds_read_b64_tr_b16 v[38:39], v9 offset:58368
    buffer_load_dwordx4 v[64:67], v1, s[44:47], s70 offen offset:2048 sc1
    buffer_load_dwordx4 v[68:71], v14, s[44:47], s70 offen offset:2048 sc1
    v_mfma_f32_16x16x32_bf16 v[144:147], v[24:27], v[112:115], v[144:147]
    ds_read_b64_tr_b16 v[40:41], v10 offset:57344
    v_mfma_f32_16x16x32_bf16 v[148:151], v[24:27], v[116:119], v[148:151]
    ds_read_b64_tr_b16 v[42:43], v10 offset:58368
    v_mfma_f32_16x16x32_bf16 v[152:155], v[28:31], v[112:115], v[152:155]
    ds_read_b64_tr_b16 v[44:45], v11 offset:57344
    v_mfma_f32_16x16x32_bf16 v[156:159], v[28:31], v[116:119], v[156:159]
    ds_read_b64_tr_b16 v[46:47], v11 offset:58368
    s_waitcnt vmcnt(16)
    v_add_u32 v8, 0x10000, v8
    v_add_u32 v9, 0x10000, v9
    v_add_u32 v10, 0x10000, v10
    v_add_u32 v11, 0x10000, v11
    s_waitcnt lgkmcnt(0)
    v_mfma_f32_16x16x32_bf16 v[128:131], v[32:35], v[120:123], v[128:131]
    ds_read_b64_tr_b16 v[16:17], v8 offset:0
    v_mfma_f32_16x16x32_bf16 v[132:135], v[32:35], v[124:127], v[132:135]
    ds_read_b64_tr_b16 v[18:19], v8 offset:1024
    v_mfma_f32_16x16x32_bf16 v[136:139], v[36:39], v[120:123], v[136:139]
    ds_read_b64_tr_b16 v[20:21], v9 offset:0
    v_mfma_f32_16x16x32_bf16 v[140:143], v[36:39], v[124:127], v[140:143]
    ds_read_b64_tr_b16 v[22:23], v9 offset:1024
    buffer_load_dwordx4 v[72:75], v1, s[44:47], s70 offen offset:3072 sc1
    buffer_load_dwordx4 v[76:79], v14, s[44:47], s70 offen offset:3072 sc1
    v_mfma_f32_16x16x32_bf16 v[144:147], v[40:43], v[120:123], v[144:147]
    ds_read_b64_tr_b16 v[24:25], v10 offset:0
    v_mfma_f32_16x16x32_bf16 v[148:151], v[40:43], v[124:127], v[148:151]
    ds_read_b64_tr_b16 v[26:27], v10 offset:1024
    v_mfma_f32_16x16x32_bf16 v[152:155], v[44:47], v[120:123], v[152:155]
    ds_read_b64_tr_b16 v[28:29], v11 offset:0
    v_mfma_f32_16x16x32_bf16 v[156:159], v[44:47], v[124:127], v[156:159]
    ds_read_b64_tr_b16 v[30:31], v11 offset:1024
    s_waitcnt vmcnt(16)
    s_waitcnt lgkmcnt(0)
    v_mfma_f32_16x16x32_bf16 v[128:131], v[16:19], v[160:163], v[128:131]
    ds_read_b64_tr_b16 v[32:33], v8 offset:8192
    v_mfma_f32_16x16x32_bf16 v[132:135], v[16:19], v[164:167], v[132:135]
    ds_read_b64_tr_b16 v[34:35], v8 offset:9216
    v_mfma_f32_16x16x32_bf16 v[136:139], v[20:23], v[160:163], v[136:139]
    ds_read_b64_tr_b16 v[36:37], v9 offset:8192
    v_mfma_f32_16x16x32_bf16 v[140:143], v[20:23], v[164:167], v[140:143]
    ds_read_b64_tr_b16 v[38:39], v9 offset:9216
    v_mfma_f32_16x16x32_bf16 v[144:147], v[24:27], v[160:163], v[144:147]
    ds_read_b64_tr_b16 v[40:41], v10 offset:8192
    v_mfma_f32_16x16x32_bf16 v[148:151], v[24:27], v[164:167], v[148:151]
    ds_read_b64_tr_b16 v[42:43], v10 offset:9216
    v_mfma_f32_16x16x32_bf16 v[152:155], v[28:31], v[160:163], v[152:155]
    ds_read_b64_tr_b16 v[44:45], v11 offset:8192
    v_mfma_f32_16x16x32_bf16 v[156:159], v[28:31], v[164:167], v[156:159]
    ds_read_b64_tr_b16 v[46:47], v11 offset:9216
    s_waitcnt vmcnt(14)
    s_waitcnt lgkmcnt(0)
    v_mfma_f32_16x16x32_bf16 v[128:131], v[32:35], v[168:171], v[128:131]
    ds_read_b64_tr_b16 v[16:17], v8 offset:16384
    v_mfma_f32_16x16x32_bf16 v[132:135], v[32:35], v[172:175], v[132:135]
    ds_read_b64_tr_b16 v[18:19], v8 offset:17408
    v_mfma_f32_16x16x32_bf16 v[136:139], v[36:39], v[168:171], v[136:139]
    ds_read_b64_tr_b16 v[20:21], v9 offset:16384
    v_mfma_f32_16x16x32_bf16 v[140:143], v[36:39], v[172:175], v[140:143]
    ds_read_b64_tr_b16 v[22:23], v9 offset:17408
    v_mfma_f32_16x16x32_bf16 v[144:147], v[40:43], v[168:171], v[144:147]
    ds_read_b64_tr_b16 v[24:25], v10 offset:16384
    v_mfma_f32_16x16x32_bf16 v[148:151], v[40:43], v[172:175], v[148:151]
    ds_read_b64_tr_b16 v[26:27], v10 offset:17408
    v_mfma_f32_16x16x32_bf16 v[152:155], v[44:47], v[168:171], v[152:155]
    ds_read_b64_tr_b16 v[28:29], v11 offset:16384
    v_mfma_f32_16x16x32_bf16 v[156:159], v[44:47], v[172:175], v[156:159]
    ds_read_b64_tr_b16 v[30:31], v11 offset:17408
    s_waitcnt vmcnt(12)
    s_waitcnt lgkmcnt(0)
    v_mfma_f32_16x16x32_bf16 v[128:131], v[16:19], v[176:179], v[128:131]
    ds_read_b64_tr_b16 v[32:33], v8 offset:24576
    v_mfma_f32_16x16x32_bf16 v[132:135], v[16:19], v[180:183], v[132:135]
    ds_read_b64_tr_b16 v[34:35], v8 offset:25600
    v_mfma_f32_16x16x32_bf16 v[136:139], v[20:23], v[176:179], v[136:139]
    ds_read_b64_tr_b16 v[36:37], v9 offset:24576
    v_mfma_f32_16x16x32_bf16 v[140:143], v[20:23], v[180:183], v[140:143]
    ds_read_b64_tr_b16 v[38:39], v9 offset:25600
    v_mfma_f32_16x16x32_bf16 v[144:147], v[24:27], v[176:179], v[144:147]
    ds_read_b64_tr_b16 v[40:41], v10 offset:24576
    v_mfma_f32_16x16x32_bf16 v[148:151], v[24:27], v[180:183], v[148:151]
    ds_read_b64_tr_b16 v[42:43], v10 offset:25600
    v_mfma_f32_16x16x32_bf16 v[152:155], v[28:31], v[176:179], v[152:155]
    ds_read_b64_tr_b16 v[44:45], v11 offset:24576
    v_mfma_f32_16x16x32_bf16 v[156:159], v[28:31], v[180:183], v[156:159]
    ds_read_b64_tr_b16 v[46:47], v11 offset:25600
    s_barrier
    s_waitcnt vmcnt(10)
    v_add_u32 v8, 0xfffe0000, v8
    v_add_u32 v9, 0xfffe0000, v9
    v_add_u32 v10, 0xfffe0000, v10
    v_add_u32 v11, 0xfffe0000, v11
    s_waitcnt lgkmcnt(0)
    v_mfma_f32_16x16x32_bf16 v[128:131], v[32:35], v[200:203], v[128:131]
    ds_read_b64_tr_b16 v[16:17], v8 offset:32768
    v_mfma_f32_16x16x32_bf16 v[132:135], v[32:35], v[204:207], v[132:135]
    ds_read_b64_tr_b16 v[18:19], v8 offset:33792
    v_mfma_f32_16x16x32_bf16 v[136:139], v[36:39], v[200:203], v[136:139]
    ds_read_b64_tr_b16 v[20:21], v9 offset:32768
    v_mfma_f32_16x16x32_bf16 v[140:143], v[36:39], v[204:207], v[140:143]
    ds_read_b64_tr_b16 v[22:23], v9 offset:33792
    v_mfma_f32_16x16x32_bf16 v[144:147], v[40:43], v[200:203], v[144:147]
    ds_read_b64_tr_b16 v[24:25], v10 offset:32768
    v_mfma_f32_16x16x32_bf16 v[148:151], v[40:43], v[204:207], v[148:151]
    ds_read_b64_tr_b16 v[26:27], v10 offset:33792
    v_mfma_f32_16x16x32_bf16 v[152:155], v[44:47], v[200:203], v[152:155]
    ds_read_b64_tr_b16 v[28:29], v11 offset:32768
    v_mfma_f32_16x16x32_bf16 v[156:159], v[44:47], v[204:207], v[156:159]
    ds_read_b64_tr_b16 v[30:31], v11 offset:33792
    s_waitcnt vmcnt(8)
    s_waitcnt lgkmcnt(0)
    v_mfma_f32_16x16x32_bf16 v[128:131], v[16:19], v[208:211], v[128:131]
    ds_read_b64_tr_b16 v[32:33], v8 offset:40960
    v_mfma_f32_16x16x32_bf16 v[132:135], v[16:19], v[212:215], v[132:135]
    ds_read_b64_tr_b16 v[34:35], v8 offset:41984
    v_mfma_f32_16x16x32_bf16 v[136:139], v[20:23], v[208:211], v[136:139]
    ds_read_b64_tr_b16 v[36:37], v9 offset:40960
    v_mfma_f32_16x16x32_bf16 v[140:143], v[20:23], v[212:215], v[140:143]
    ds_read_b64_tr_b16 v[38:39], v9 offset:41984
    v_mfma_f32_16x16x32_bf16 v[144:147], v[24:27], v[208:211], v[144:147]
    ds_read_b64_tr_b16 v[40:41], v10 offset:40960
    v_mfma_f32_16x16x32_bf16 v[148:151], v[24:27], v[212:215], v[148:151]
    ds_read_b64_tr_b16 v[42:43], v10 offset:41984
    v_mfma_f32_16x16x32_bf16 v[152:155], v[28:31], v[208:211], v[152:155]
    ds_read_b64_tr_b16 v[44:45], v11 offset:40960
    v_mfma_f32_16x16x32_bf16 v[156:159], v[28:31], v[212:215], v[156:159]
    ds_read_b64_tr_b16 v[46:47], v11 offset:41984
    s_waitcnt vmcnt(5)
    s_waitcnt lgkmcnt(0)
    v_mfma_f32_16x16x32_bf16 v[128:131], v[32:35], v[216:219], v[128:131]
    ds_read_b64_tr_b16 v[16:17], v8 offset:49152
    v_mfma_f32_16x16x32_bf16 v[132:135], v[32:35], v[220:223], v[132:135]
    ds_read_b64_tr_b16 v[18:19], v8 offset:50176
    v_mfma_f32_16x16x32_bf16 v[136:139], v[36:39], v[216:219], v[136:139]
    ds_read_b64_tr_b16 v[20:21], v9 offset:49152
    v_mfma_f32_16x16x32_bf16 v[140:143], v[36:39], v[220:223], v[140:143]
    ds_read_b64_tr_b16 v[22:23], v9 offset:50176
    v_mfma_f32_16x16x32_bf16 v[144:147], v[40:43], v[216:219], v[144:147]
    ds_read_b64_tr_b16 v[24:25], v10 offset:49152
    v_mfma_f32_16x16x32_bf16 v[148:151], v[40:43], v[220:223], v[148:151]
    ds_read_b64_tr_b16 v[26:27], v10 offset:50176
    v_mfma_f32_16x16x32_bf16 v[152:155], v[44:47], v[216:219], v[152:155]
    ds_read_b64_tr_b16 v[28:29], v11 offset:49152
    v_mfma_f32_16x16x32_bf16 v[156:159], v[44:47], v[220:223], v[156:159]
    ds_read_b64_tr_b16 v[30:31], v11 offset:50176
    s_waitcnt vmcnt(2)
    s_waitcnt lgkmcnt(0)
    v_mfma_f32_16x16x32_bf16 v[128:131], v[16:19], v[64:67], v[128:131]
    ds_read_b64_tr_b16 v[32:33], v8 offset:57344
    v_mfma_f32_16x16x32_bf16 v[132:135], v[16:19], v[68:71], v[132:135]
    ds_read_b64_tr_b16 v[34:35], v8 offset:58368
    v_mfma_f32_16x16x32_bf16 v[136:139], v[20:23], v[64:67], v[136:139]
    ds_read_b64_tr_b16 v[36:37], v9 offset:57344
    v_mfma_f32_16x16x32_bf16 v[140:143], v[20:23], v[68:71], v[140:143]
    ds_read_b64_tr_b16 v[38:39], v9 offset:58368
    v_mfma_f32_16x16x32_bf16 v[144:147], v[24:27], v[64:67], v[144:147]
    ds_read_b64_tr_b16 v[40:41], v10 offset:57344
    v_mfma_f32_16x16x32_bf16 v[148:151], v[24:27], v[68:71], v[148:151]
    ds_read_b64_tr_b16 v[42:43], v10 offset:58368
    v_mfma_f32_16x16x32_bf16 v[152:155], v[28:31], v[64:67], v[152:155]
    ds_read_b64_tr_b16 v[44:45], v11 offset:57344
    v_mfma_f32_16x16x32_bf16 v[156:159], v[28:31], v[68:71], v[156:159]
    ds_read_b64_tr_b16 v[46:47], v11 offset:58368
    s_waitcnt vmcnt(0)
    s_waitcnt lgkmcnt(0)
    v_mfma_f32_16x16x32_bf16 v[128:131], v[32:35], v[72:75], v[128:131]
    v_mfma_f32_16x16x32_bf16 v[132:135], v[32:35], v[76:79], v[132:135]
    v_mfma_f32_16x16x32_bf16 v[136:139], v[36:39], v[72:75], v[136:139]
    v_mfma_f32_16x16x32_bf16 v[140:143], v[36:39], v[76:79], v[140:143]
    v_mfma_f32_16x16x32_bf16 v[144:147], v[40:43], v[72:75], v[144:147]
    v_mfma_f32_16x16x32_bf16 v[148:151], v[40:43], v[76:79], v[148:151]
    v_mfma_f32_16x16x32_bf16 v[152:155], v[44:47], v[72:75], v[152:155]
    v_mfma_f32_16x16x32_bf16 v[156:159], v[44:47], v[76:79], v[156:159]
    s_nop 7
    ds_write_b128 v15, v[144:147] offset:0
    ds_write_b128 v15, v[148:151] offset:1024
    ds_write_b128 v15, v[152:155] offset:2048
    ds_write_b128 v15, v[156:159] offset:3072
    s_waitcnt lgkmcnt(0)
    s_barrier
    ds_read_b128 v[48:51], v4 offset:0
    ds_read_b128 v[52:55], v4 offset:1024
    ds_read_b128 v[56:59], v4 offset:2048
    ds_read_b128 v[60:63], v4 offset:3072
    s_waitcnt lgkmcnt(3)
    v_add_f32 v128, v128, v48
    v_add_f32 v129, v129, v49
    v_add_f32 v130, v130, v50
    v_add_f32 v131, v131, v51
    s_waitcnt lgkmcnt(2)
    v_add_f32 v132, v132, v52
    v_add_f32 v133, v133, v53
    v_add_f32 v134, v134, v54
    v_add_f32 v135, v135, v55
    s_waitcnt lgkmcnt(1)
    v_add_f32 v136, v136, v56
    v_add_f32 v137, v137, v57
    v_add_f32 v138, v138, v58
    v_add_f32 v139, v139, v59
    s_waitcnt lgkmcnt(0)
    v_add_f32 v140, v140, v60
    v_add_f32 v141, v141, v61
    v_add_f32 v142, v142, v62
    v_add_f32 v143, v143, v63
    v_cvt_pk_bf16_f32 v48, v128, v129
    v_cvt_pk_bf16_f32 v49, v130, v131
    v_cvt_pk_bf16_f32 v50, v136, v137
    v_cvt_pk_bf16_f32 v51, v138, v139
    v_cvt_pk_bf16_f32 v52, v132, v133
    v_cvt_pk_bf16_f32 v53, v134, v135
    v_cvt_pk_bf16_f32 v54, v140, v141
    v_cvt_pk_bf16_f32 v55, v142, v143
    s_add_u32 s64, s75, 0
    s_add_u32 s65, s64, 0x10000
    v_permlane16_swap_b32 v48, v50
    v_permlane16_swap_b32 v49, v51
    v_permlane16_swap_b32 v52, v54
    v_permlane16_swap_b32 v53, v55
    s_nop 0
    buffer_store_dwordx4 v[48:51], v13, s[52:55], s64 offen sc1
    buffer_store_dwordx4 v[52:55], v13, s[52:55], s65 offen sc1
    s_cmp_lg_u32 s63, 0
    s_cbranch_scc1 L_end
    v_mov_b32 v4, 1
    v_mov_b32 v7, 0
    s_mov_b64 exec, 1
    buffer_atomic_add v4, v7, s[56:59], 0 offen sc0
    s_waitcnt vmcnt(0)
    v_readfirstlane_b32 s64, v4
    s_cmp_lg_u32 s64, 255
    s_cbranch_scc1 L_end
    v_mov_b32 v4, s77
    s_mov_b32 s65, 25165824
    buffer_store_dword v4, v7, s[44:47], s65 offen sc1
L_end:
    s_endpgm
L_slowA:
    v_and_b32 v242, 0x33, v0
    v_bfe_u32 v243, v0, 2, 1
    v_lshl_or_b32 v242, v243, 3, v242
    v_bfe_u32 v243, v0, 3, 1
    v_lshl_or_b32 v242, v243, 2, v242
    v_lshlrev_b32 v242, 4, v242
    v_mov_b32 v240, 0xff800000
    s_mov_b32 s97, 0
L_spA:
    s_mov_b32 s98, 0
    s_cmp_eq_u32 s61, 0
    s_cbranch_scc0 L_stA
    s_sub_u32 s98, 8, s88
L_stA:
    s_add_u32 s99, s98, s88
    s_lshl_b32 s99, s99, 12
    s_add_u32 s99, s99, s78
    s_sub_u32 s99, s99, 0x8000
    buffer_load_dwordx4 v[80:83], v242, s[44:47], s99 offen sc1
    buffer_load_dwordx4 v[84:87], v242, s[44:47], s99 offen offset:1024 sc1
    buffer_load_dwordx4 v[104:107], v1, s[44:47], s99 offen offset:2048 sc1
    buffer_load_dwordx4 v[108:111], v1, s[44:47], s99 offen offset:3072 sc1
    s_waitcnt vmcnt(0)
    s_cmp_eq_u32 s98, 0
    s_cbranch_scc1 L_sfA
    s_cmp_eq_u32 s98, 8
    s_cbranch_scc1 L_sdA
    v_mfma_f32_32x32x16_bf16 v[224:239], v[80:83], v[8:11], 0
    s_branch L_sjA
L_sfA:
    v_mfma_f32_32x32x16_bf16 v[224:239], v[80:83], v[8:11], v[136:151]
    s_branch L_sjA
L_sdA:
    v_mfma_f32_32x32x16_bf16 v[224:239], v[80:83], v[8:11], v[88:103]
L_sjA:
    v_mfma_f32_32x32x16_bf16 v[224:239], v[84:87], v[12:15], v[224:239]
    s_nop 7
    s_nop 7
    s_cmp_eq_u32 s97, 0
    s_cbranch_scc0 L_s2A
    v_max_f32 v240, v240, v224
    v_max_f32 v240, v240, v225
    v_max_f32 v240, v240, v226
    v_max_f32 v240, v240, v227
    v_max_f32 v240, v240, v228
    v_max_f32 v240, v240, v229
    v_max_f32 v240, v240, v230
    v_max_f32 v240, v240, v231
    v_max_f32 v240, v240, v232
    v_max_f32 v240, v240, v233
    v_max_f32 v240, v240, v234
    v_max_f32 v240, v240, v235
    v_max_f32 v240, v240, v236
    v_max_f32 v240, v240, v237
    v_max_f32 v240, v240, v238
    v_max_f32 v240, v240, v239
    s_branch L_snA
L_s2A:
    v_sub_f32 v224, v224, v240
    v_sub_f32 v225, v225, v240
    v_sub_f32 v226, v226, v240
    v_sub_f32 v227, v227, v240
    v_sub_f32 v228, v228, v240
    v_sub_f32 v229, v229, v240
    v_sub_f32 v230, v230, v240
    v_sub_f32 v231, v231, v240
    v_sub_f32 v232, v232, v240
    v_sub_f32 v233, v233, v240
    v_sub_f32 v234, v234, v240
    v_sub_f32 v235, v235, v240
    v_sub_f32 v236, v236, v240
    v_sub_f32 v237, v237, v240
    v_sub_f32 v238, v238, v240
    v_sub_f32 v239, v239, v240
    v_exp_f32 v224, v224
    v_exp_f32 v225, v225
    v_exp_f32 v226, v226
    v_exp_f32 v227, v227
    v_exp_f32 v228, v228
    v_exp_f32 v229, v229
    v_exp_f32 v230, v230
    v_exp_f32 v231, v231
    v_exp_f32 v232, v232
    v_exp_f32 v233, v233
    v_exp_f32 v234, v234
    v_exp_f32 v235, v235
    v_exp_f32 v236, v236
    v_exp_f32 v237, v237
    v_exp_f32 v238, v238
    v_exp_f32 v239, v239
    s_nop 0
    v_cvt_pk_bf16_f32 v128, v224, v225
    v_cvt_pk_bf16_f32 v129, v226, v227
    v_cvt_pk_bf16_f32 v130, v228, v229
    v_cvt_pk_bf16_f32 v131, v230, v231
    v_cvt_pk_bf16_f32 v132, v232, v233
    v_cvt_pk_bf16_f32 v133, v234, v235
    v_cvt_pk_bf16_f32 v134, v236, v237
    v_cvt_pk_bf16_f32 v135, v238, v239
    s_nop 1
    v_mfma_f32_32x32x16_bf16 v[24:39], v[104:107], v[128:131], v[24:39]
    v_mfma_f32_32x32x16_bf16 v[24:39], v[108:111], v[132:135], v[24:39]
    v_mfma_f32_16x16x32_bf16 v[56:59], v[184:187], v[128:131], v[56:59]
    v_mfma_f32_16x16x32_bf16 v[56:59], v[184:187], v[132:135], v[56:59]
    s_nop 7
    s_nop 7
L_snA:
    s_add_u32 s98, s98, 1
    s_cmp_le_u32 s98, 8
    s_cbranch_scc1 L_stA
    s_cmp_eq_u32 s97, 0
    s_cbranch_scc0 L_sxA
    v_mov_b32 v241, v240
    s_nop 1
    v_permlane32_swap_b32 v241, v240
    s_nop 1
    v_max_f32 v240, v240, v241
    v_mov_b32 v24, 0
    v_mov_b32 v25, 0
    v_mov_b32 v26, 0
    v_mov_b32 v27, 0
    v_mov_b32 v28, 0
    v_mov_b32 v29, 0
    v_mov_b32 v30, 0
    v_mov_b32 v31, 0
    v_mov_b32 v32, 0
    v_mov_b32 v33, 0
    v_mov_b32 v34, 0
    v_mov_b32 v35, 0
    v_mov_b32 v36, 0
    v_mov_b32 v37, 0
    v_mov_b32 v38, 0
    v_mov_b32 v39, 0
    v_mov_b32 v56, 0
    v_mov_b32 v57, 0
    v_mov_b32 v58, 0
    v_mov_b32 v59, 0
    s_mov_b32 s97, 1
    s_branch L_spA
L_sxA:
    s_setpc_b64 s[90:91]
L_slowB:
    v_and_b32 v170, 0x33, v0
    v_bfe_u32 v171, v0, 2, 1
    v_lshl_or_b32 v170, v171, 3, v170
    v_bfe_u32 v171, v0, 3, 1
    v_lshl_or_b32 v170, v171, 2, v170
    v_lshlrev_b32 v170, 4, v170
    v_mov_b32 v168, 0xff800000
    s_mov_b32 s97, 0
L_spB:
    s_mov_b32 s98, 0
    s_cmp_eq_u32 s61, 0
    s_cbranch_scc0 L_stB
    s_sub_u32 s98, 8, s88
L_stB:
    s_add_u32 s99, s98, s88
    s_lshl_b32 s99, s99, 12
    s_add_u32 s99, s99, s78
    s_sub_u32 s99, s99, 0x8000
    buffer_load_dwordx4 v[120:123], v170, s[44:47], s99 offen sc1
    buffer_load_dwordx4 v[124:127], v170, s[44:47], s99 offen offset:1024 sc1
    buffer_load_dwordx4 v[160:163], v1, s[44:47], s99 offen offset:2048 sc1
    buffer_load_dwordx4 v[164:167], v1, s[44:47], s99 offen offset:3072 sc1
    s_waitcnt vmcnt(0)
    s_cmp_eq_u32 s98, 0
    s_cbranch_scc1 L_sfB
    s_cmp_eq_u32 s98, 8
    s_cbranch_scc1 L_sdB
    v_mfma_f32_32x32x16_bf16 v[64:79], v[120:123], v[16:19], 0
    s_branch L_sjB
L_sfB:
    v_mfma_f32_32x32x16_bf16 v[64:79], v[120:123], v[16:19], v[136:151]
    s_branch L_sjB
L_sdB:
    v_mfma_f32_32x32x16_bf16 v[64:79], v[120:123], v[16:19], v[88:103]
L_sjB:
    v_mfma_f32_32x32x16_bf16 v[64:79], v[124:127], v[20:23], v[64:79]
    s_nop 7
    s_nop 7
    s_cmp_eq_u32 s97, 0
    s_cbranch_scc0 L_s2B
    v_max_f32 v168, v168, v64
    v_max_f32 v168, v168, v65
    v_max_f32 v168, v168, v66
    v_max_f32 v168, v168, v67
    v_max_f32 v168, v168, v68
    v_max_f32 v168, v168, v69
    v_max_f32 v168, v168, v70
    v_max_f32 v168, v168, v71
    v_max_f32 v168, v168, v72
    v_max_f32 v168, v168, v73
    v_max_f32 v168, v168, v74
    v_max_f32 v168, v168, v75
    v_max_f32 v168, v168, v76
    v_max_f32 v168, v168, v77
    v_max_f32 v168, v168, v78
    v_max_f32 v168, v168, v79
    s_branch L_snB
L_s2B:
    v_sub_f32 v64, v64, v168
    v_sub_f32 v65, v65, v168
    v_sub_f32 v66, v66, v168
    v_sub_f32 v67, v67, v168
    v_sub_f32 v68, v68, v168
    v_sub_f32 v69, v69, v168
    v_sub_f32 v70, v70, v168
    v_sub_f32 v71, v71, v168
    v_sub_f32 v72, v72, v168
    v_sub_f32 v73, v73, v168
    v_sub_f32 v74, v74, v168
    v_sub_f32 v75, v75, v168
    v_sub_f32 v76, v76, v168
    v_sub_f32 v77, v77, v168
    v_sub_f32 v78, v78, v168
    v_sub_f32 v79, v79, v168
    v_exp_f32 v64, v64
    v_exp_f32 v65, v65
    v_exp_f32 v66, v66
    v_exp_f32 v67, v67
    v_exp_f32 v68, v68
    v_exp_f32 v69, v69
    v_exp_f32 v70, v70
    v_exp_f32 v71, v71
    v_exp_f32 v72, v72
    v_exp_f32 v73, v73
    v_exp_f32 v74, v74
    v_exp_f32 v75, v75
    v_exp_f32 v76, v76
    v_exp_f32 v77, v77
    v_exp_f32 v78, v78
    v_exp_f32 v79, v79
    s_nop 0
    v_cvt_pk_bf16_f32 v112, v64, v65
    v_cvt_pk_bf16_f32 v113, v66, v67
    v_cvt_pk_bf16_f32 v114, v68, v69
    v_cvt_pk_bf16_f32 v115, v70, v71
    v_cvt_pk_bf16_f32 v116, v72, v73
    v_cvt_pk_bf16_f32 v117, v74, v75
    v_cvt_pk_bf16_f32 v118, v76, v77
    v_cvt_pk_bf16_f32 v119, v78, v79
    s_nop 1
    v_mfma_f32_32x32x16_bf16 v[40:55], v[160:163], v[112:115], v[40:55]
    v_mfma_f32_32x32x16_bf16 v[40:55], v[164:167], v[116:119], v[40:55]
    v_mfma_f32_16x16x32_bf16 v[60:63], v[184:187], v[112:115], v[60:63]
    v_mfma_f32_16x16x32_bf16 v[60:63], v[184:187], v[116:119], v[60:63]
    s_nop 7
    s_nop 7
L_snB:
    s_add_u32 s98, s98, 1
    s_cmp_le_u32 s98, 8
    s_cbranch_scc1 L_stB
    s_cmp_eq_u32 s97, 0
    s_cbranch_scc0 L_sxB
    v_mov_b32 v169, v168
    s_nop 1
    v_permlane32_swap_b32 v169, v168
    s_nop 1
    v_max_f32 v168, v168, v169
    v_mov_b32 v40, 0
    v_mov_b32 v41, 0
    v_mov_b32 v42, 0
    v_mov_b32 v43, 0
    v_mov_b32 v44, 0
    v_mov_b32 v45, 0
    v_mov_b32 v46, 0
    v_mov_b32 v47, 0
    v_mov_b32 v48, 0
    v_mov_b32 v49, 0
    v_mov_b32 v50, 0
    v_mov_b32 v51, 0
    v_mov_b32 v52, 0
    v_mov_b32 v53, 0
    v_mov_b32 v54, 0
    v_mov_b32 v55, 0
    v_mov_b32 v60, 0
    v_mov_b32 v61, 0
    v_mov_b32 v62, 0
    v_mov_b32 v63, 0
    s_mov_b32 s97, 1
    s_branch L_spB
L_sxB:
    s_setpc_b64 s[90:91]
L_codeend:

.section .rodata,"a"
.p2align 6
.amdhsa_kernel concat_heads__sliding_block__sliding_block__prompt_kernel
  .amdhsa_next_free_vgpr 256
  .amdhsa_next_free_sgpr 102
  .amdhsa_accum_offset 256
  .amdhsa_group_segment_fixed_size 0
  .amdhsa_kernarg_size 72
  .amdhsa_user_sgpr_count 2
  .amdhsa_user_sgpr_kernarg_segment_ptr 1
  .amdhsa_system_sgpr_workgroup_id_x 1
.end_amdhsa_kernel
```
